```python
import torch

def _softmax(x, axis=-1):
    return torch.softmax(x, dim=axis)

def _gelu(x):
    return torch.nn.functional.gelu(x, approximate='tanh')

def _silu(x):
    return torch.nn.functional.silu(x)

def _sigmoid(x):
    return torch.sigmoid(x)

def _layernorm(x, axis=-1, eps=1e-05):
    m = x.mean(dim=axis, keepdim=True)
    v = x.var(dim=axis, keepdim=True, unbiased=False)
    return (x - m) / torch.sqrt(v + eps)

def _scatter_add(tgt, idx, src, axis=0):
    return tgt.clone().index_add_(axis, idx, src)

def _segment_sum(src, seg, n):
    out = torch.zeros((n,) + src.shape[1:], dtype=src.dtype)
    return out.index_add_(0, seg, src)

def _pad(x, pw):
    flat = tuple((v for pair in reversed(pw) for v in pair))
    return torch.nn.functional.pad(x, flat)
kernel_name = 'parallel_sum__memory_aug_recurrent_mem_tr__glu_gated_swiglu__prompt'

def setup_inputs():

    _w = lambda a: (lambda t: t.to(torch.bfloat16) if t.is_floating_point() else t)(torch.as_tensor(a))

    def _A_setup():
        B, S, Dm = (1, 2048, 1024)
        H, Dh = (32, 128)
        M, seg = (8, 32)
        seg = min(seg, S)
        S = S // seg * seg
        return {'x': _w((lambda *s: torch.randn(*s, dtype=torch.bfloat16) * 0.05)(B, S, Dm)), 'mem0': _w((lambda *s: torch.randn(*s, dtype=torch.bfloat16) * 0.2)(B, M, Dm)), 'Wq': _w((lambda *s: torch.randn(*s, dtype=torch.bfloat16) * 1.6)(Dm, H, Dh) * Dm ** (-0.5)), 'Wk': _w((lambda *s: torch.randn(*s, dtype=torch.bfloat16) * 1.6)(Dm, H, Dh) * Dm ** (-0.5)), 'Wv': _w((lambda *s: torch.randn(*s, dtype=torch.bfloat16) * 0.2)(Dm, H, Dh) * Dm ** (-0.5)), 'Wo': _w((lambda *s: torch.randn(*s, dtype=torch.bfloat16) * 0.2)(H, Dh, Dm) * (H * Dh) ** (-0.5)), 'seg_len': seg}
    _A_in = _A_setup()

    def _B_setup():
        B, S, D, F = (1, 2048, 1024, 3584)
        return {'x': _w((lambda *s: torch.randn(*s, dtype=torch.bfloat16) * 0.05)(B, S, D)), 'w1': _w((lambda *s: torch.randn(*s, dtype=torch.bfloat16) * 0.2)(D, F) * (2.0 / D) ** 0.5), 'w3': _w((lambda *s: torch.randn(*s, dtype=torch.bfloat16) * 0.2)(D, F) * (2.0 / D) ** 0.5), 'w2': _w((lambda *s: torch.randn(*s, dtype=torch.bfloat16) * 0.2)(F, D) * (2.0 / F) ** 0.5)}
    _B_in = _B_setup()
    return {'A_x': _A_in['x'], 'A_mem0': _A_in['mem0'], 'A_Wq': _A_in['Wq'], 'A_Wk': _A_in['Wk'], 'A_Wv': _A_in['Wv'], 'A_Wo': _A_in['Wo'], 'A_seg_len': _A_in['seg_len'], 'B_x': _B_in['x'], 'B_w1': _B_in['w1'], 'B_w3': _B_in['w3'], 'B_w2': _B_in['w2']}

def reference(A_x, A_mem0, A_Wq, A_Wk, A_Wv, A_Wo, A_seg_len, B_x, B_w1, B_w3, B_w2):

    def _A_ref(x, mem0, Wq, Wk, Wv, Wo, seg_len):
        B, S, Dm = x.shape
        H, Dh = (Wq.shape[1], Wq.shape[2])
        M = mem0.shape[1]
        scale = Dh ** (-0.5)
        n_seg = S // seg_len
        L = M + seg_len
        idx = torch.arange(L)
        mask = (idx[:, None] < M) | (idx[:, None] >= idx[None, :])
        mem = mem0
        outs = []
        for s in range(n_seg):
            xs = x[:, s * seg_len:(s + 1) * seg_len, :].clone()
            h = torch.concatenate([mem, xs], axis=1)
            q = torch.einsum('btd,dhe->bhte', h, Wq)
            k = torch.einsum('btd,dhe->bhte', h, Wk)
            v = torch.einsum('btd,dhe->bhte', h, Wv)
            scores = torch.einsum('bhqe,bhke->bhqk', q, k) * scale
            scores = torch.where(mask[None, None], scores, -1000000000.0)
            p = _softmax(scores, axis=-1)
            o = torch.einsum('bhqk,bhke->bhqe', p, v)
            o = torch.einsum('bhte,hed->btd', o, Wo)
            mem = o[:, :M, :].clone()
            outs.append(o[:, M:, :])
        return torch.concatenate(outs, axis=1)

    def _B_ref(x, w1, w3, w2):
        gate = torch.einsum('bsd,df->bsf', x, w1)
        up = torch.einsum('bsd,df->bsf', x, w3)
        h = _silu(gate) * up
        out = torch.einsum('bsf,fd->bsd', h, w2)
        return out
    x = A_x
    xn = _layernorm(x, axis=-1)
    return x + _A_ref(xn, A_mem0, A_Wq, A_Wk, A_Wv, A_Wo, A_seg_len) + _B_ref(xn, B_w1, B_w3, B_w2)
```

```asm
; @launch grid=(256,1,1) block=(256,1,1) lds=163840
.amdgcn_target "amdgcn-amd-amdhsa--gfx950"
.text
.globl parallel_sum__memory_aug_recurrent_mem_tr__glu_gated_swiglu__prompt_kernel
.p2align 8
.type parallel_sum__memory_aug_recurrent_mem_tr__glu_gated_swiglu__prompt_kernel,@function
parallel_sum__memory_aug_recurrent_mem_tr__glu_gated_swiglu__prompt_kernel:
  s_cmp_ge_u32 s2, 256
  s_cbranch_scc1 L_exit
  s_load_dwordx4 s[56:59], s[0:1], 0
  s_load_dwordx8 s[60:67], s[0:1], 16
  s_load_dwordx8 s[72:79], s[0:1], 64
  s_load_dwordx4 s[80:83], s[0:1], 96
  v_lshrrev_b32 v18, 6, v0
  s_mov_b32 s88, s2
  v_readfirstlane_b32 s27, v18
  s_lshr_b32 s28, s27, 1
  s_and_b32 s29, s27, 1
  s_getreg_b32 s89, hwreg(HW_REG_XCC_ID, 0, 3)
  s_sub_u32 s89, s89, s2
  s_and_b32 s89, s89, 7
  s_waitcnt lgkmcnt(0)
  s_mov_b32 s8, s82
  s_mov_b32 s9, s83
  s_mov_b32 s10, 0x10000000
  s_mov_b32 s11, 0x20000
  s_mov_b32 s68, s80
  s_mov_b32 s69, s81
  s_mov_b32 s70, 0x100
  s_mov_b32 s71, 0x20000
  s_or_b32 s3, s2, s27
  s_cmp_lg_u32 s3, 0
  s_cbranch_scc1 L_role
  s_add_u32 s3, s89, 1
  v_mov_b32 v18, s3
  s_mov_b64 exec, 1
  buffer_store_dword v18, off, s[68:71], 0 offset:136 sc1
  s_mov_b64 exec, -1
  s_branch L_role
L_redo:
  s_mov_b32 s89, s3
  s_waitcnt vmcnt(0) lgkmcnt(0)
  s_barrier
  v_mbcnt_lo_u32_b32 v0, -1, 0
  v_mbcnt_hi_u32_b32 v0, -1, v0
L_role:
  s_add_u32 s3, s88, s89
  s_and_b32 s3, s3, 7
  s_andn2_b32 s2, s88, 7
  s_or_b32 s2, s2, s3
  s_getpc_b64 s[38:39]
PC_0:
  v_and_b32 v18, 63, v0
  v_lshlrev_b32 v18, 7, v18
  s_bfe_u32 s3, s88, 0x10003
  s_lshl_b32 s3, s3, 2
  s_add_u32 s3, s3, s27
  s_lshl_b32 s3, s3, 13
  v_add_u32 v18, s3, v18
  v_min_u32 v18, TABLE_0-PC_0, v18
  global_load_dword v255, v18, s[38:39]
  s_add_u32 s38, s38, TABLE_0-PC_0
  s_addc_u32 s39, s39, 0
  s_mul_i32 s3, s2, 64
  s_add_u32 s38, s38, s3
  s_addc_u32 s39, s39, 0
  s_load_dword s31, s[38:39], 0
  s_and_b32 s3, s2, 7
  s_lshr_b32 s34, s2, 3
  s_mov_b32 s33, 0
  s_cmp_eq_u32 s3, 1
  s_cbranch_scc1 L_chain
  s_mov_b32 s33, 1
  s_cmp_lg_u32 s3, 3
  s_cbranch_scc1 L_bulk
L_chain:
  s_waitcnt lgkmcnt(0)
  s_cmp_lt_u32 s34, 16
  s_cbranch_scc1 L_chainP
  s_branch L_chainV
L_bulk:
  v_and_b32 v18, 63, v0
  v_lshlrev_b32 v0, 4, v18
  v_lshrrev_b32 v19, 2, v18
  v_and_b32 v20, 7, v19
  v_lshlrev_b32 v19, 8, v19
  v_and_b32 v21, 3, v18
  v_lshl_add_u32 v19, v21, 3, v19
  s_lshl_b32 s3, s29, 2
  v_xor_b32 v20, s3, v20
  v_xor_b32 v21, 0, v20
  v_lshl_add_u32 v2, v21, 5, v19
  v_xor_b32 v21, 1, v20
  v_lshl_add_u32 v3, v21, 5, v19
  v_xor_b32 v21, 2, v20
  v_lshl_add_u32 v4, v21, 5, v19
  v_xor_b32 v21, 3, v20
  v_lshl_add_u32 v5, v21, 5, v19
  v_lshrrev_b32 v19, 4, v18
  s_lshl_b32 s3, s29, 4
  v_add_u32 v16, s3, v19
  v_bfe_u32 v20, v18, 1, 3
  v_xor_b32 v20, v20, v19
  v_and_b32 v21, 1, v18
  v_lshlrev_b32 v21, 4, v21
  v_lshl_add_u32 v17, v20, 5, v21
  s_mov_b32 s16, s8
  s_mov_b32 s17, s9
  s_mov_b32 s18, s10
  s_mov_b32 s19, 0x20000
  s_mov_b32 s12, s8
  s_mov_b32 s13, s9
  s_mov_b32 s14, 0
  s_mov_b32 s15, 0x20000
  s_mov_b32 s35, 0
  s_mov_b32 s87, 0
  s_bitcmp1_b32 s2, 2
  s_cbranch_scc0 ST_misc
  s_mov_b32 s44, s56
  s_mov_b32 s45, s57
  s_mov_b32 s46, 0x400000
  s_mov_b32 s47, 0x20000
  s_lshr_b32 s23, s2, 3
  s_lshl_b32 s23, s23, 2
  s_and_b32 s3, s2, 3
  s_add_u32 s23, s23, s3
  v_lshrrev_b32 v23, 8, v0
  v_bfe_u32 v24, v0, 4, 4
  v_lshlrev_b32 v25, 11, v24
  v_lshl_add_u32 v25, v23, 3, v25
  s_lshl_b32 s3, s23, 15
  s_lshl_b32 s4, s27, 9
  s_add_u32 s3, s3, s4
  buffer_load_dwordx2 v[32:33], v25, s[44:47], s3 offen offset:0
  buffer_load_dwordx2 v[34:35], v25, s[44:47], s3 offen offset:32
  buffer_load_dwordx2 v[36:37], v25, s[44:47], s3 offen offset:64
  buffer_load_dwordx2 v[38:39], v25, s[44:47], s3 offen offset:96
  buffer_load_dwordx2 v[40:41], v25, s[44:47], s3 offen offset:128
  buffer_load_dwordx2 v[42:43], v25, s[44:47], s3 offen offset:160
  buffer_load_dwordx2 v[44:45], v25, s[44:47], s3 offen offset:192
  buffer_load_dwordx2 v[46:47], v25, s[44:47], s3 offen offset:224
  buffer_load_dwordx2 v[48:49], v25, s[44:47], s3 offen offset:256
  buffer_load_dwordx2 v[50:51], v25, s[44:47], s3 offen offset:288
  buffer_load_dwordx2 v[52:53], v25, s[44:47], s3 offen offset:320
  buffer_load_dwordx2 v[54:55], v25, s[44:47], s3 offen offset:352
  buffer_load_dwordx2 v[56:57], v25, s[44:47], s3 offen offset:384
  buffer_load_dwordx2 v[58:59], v25, s[44:47], s3 offen offset:416
  buffer_load_dwordx2 v[60:61], v25, s[44:47], s3 offen offset:448
  buffer_load_dwordx2 v[62:63], v25, s[44:47], s3 offen offset:480
  v_lshlrev_b32 v26, 6, v24
  v_add_u32 v26, 131072, v26
  s_lshl_b32 s3, s27, 4
  v_lshl_add_u32 v27, v23, 2, v26
  v_add_u32 v27, s3, v27
  s_waitcnt vmcnt(15)
  v_lshlrev_b32 v64, 16, v32
  v_and_b32 v65, 0xffff0000, v32
  v_lshlrev_b32 v66, 16, v33
  v_and_b32 v67, 0xffff0000, v33
  s_waitcnt vmcnt(14)
  v_lshlrev_b32 v68, 16, v34
  v_and_b32 v69, 0xffff0000, v34
  v_lshlrev_b32 v70, 16, v35
  v_and_b32 v71, 0xffff0000, v35
  s_waitcnt vmcnt(13)
  v_lshlrev_b32 v72, 16, v36
  v_and_b32 v73, 0xffff0000, v36
  v_lshlrev_b32 v74, 16, v37
  v_and_b32 v75, 0xffff0000, v37
  s_waitcnt vmcnt(12)
  v_lshlrev_b32 v76, 16, v38
  v_and_b32 v77, 0xffff0000, v38
  v_lshlrev_b32 v78, 16, v39
  v_and_b32 v79, 0xffff0000, v39
  s_waitcnt vmcnt(11)
  v_lshlrev_b32 v80, 16, v40
  v_and_b32 v81, 0xffff0000, v40
  v_lshlrev_b32 v82, 16, v41
  v_and_b32 v83, 0xffff0000, v41
  s_waitcnt vmcnt(10)
  v_lshlrev_b32 v84, 16, v42
  v_and_b32 v85, 0xffff0000, v42
  v_lshlrev_b32 v86, 16, v43
  v_and_b32 v87, 0xffff0000, v43
  s_waitcnt vmcnt(9)
  v_lshlrev_b32 v88, 16, v44
  v_and_b32 v89, 0xffff0000, v44
  v_lshlrev_b32 v90, 16, v45
  v_and_b32 v91, 0xffff0000, v45
  s_waitcnt vmcnt(8)
  v_lshlrev_b32 v92, 16, v46
  v_and_b32 v93, 0xffff0000, v46
  v_lshlrev_b32 v94, 16, v47
  v_and_b32 v95, 0xffff0000, v47
  s_waitcnt vmcnt(7)
  v_lshlrev_b32 v96, 16, v48
  v_and_b32 v97, 0xffff0000, v48
  v_lshlrev_b32 v98, 16, v49
  v_and_b32 v99, 0xffff0000, v49
  s_waitcnt vmcnt(6)
  v_lshlrev_b32 v100, 16, v50
  v_and_b32 v101, 0xffff0000, v50
  v_lshlrev_b32 v102, 16, v51
  v_and_b32 v103, 0xffff0000, v51
  s_waitcnt vmcnt(5)
  v_lshlrev_b32 v104, 16, v52
  v_and_b32 v105, 0xffff0000, v52
  v_lshlrev_b32 v106, 16, v53
  v_and_b32 v107, 0xffff0000, v53
  s_waitcnt vmcnt(4)
  v_lshlrev_b32 v108, 16, v54
  v_and_b32 v109, 0xffff0000, v54
  v_lshlrev_b32 v110, 16, v55
  v_and_b32 v111, 0xffff0000, v55
  s_waitcnt vmcnt(3)
  v_lshlrev_b32 v112, 16, v56
  v_and_b32 v113, 0xffff0000, v56
  v_lshlrev_b32 v114, 16, v57
  v_and_b32 v115, 0xffff0000, v57
  s_waitcnt vmcnt(2)
  v_lshlrev_b32 v116, 16, v58
  v_and_b32 v117, 0xffff0000, v58
  v_lshlrev_b32 v118, 16, v59
  v_and_b32 v119, 0xffff0000, v59
  s_waitcnt vmcnt(1)
  v_lshlrev_b32 v120, 16, v60
  v_and_b32 v121, 0xffff0000, v60
  v_lshlrev_b32 v122, 16, v61
  v_and_b32 v123, 0xffff0000, v61
  s_waitcnt vmcnt(0)
  v_lshlrev_b32 v124, 16, v62
  v_and_b32 v125, 0xffff0000, v62
  v_lshlrev_b32 v126, 16, v63
  v_and_b32 v127, 0xffff0000, v63
  buffer_load_dword v21, off, s[68:71], 0 offset:136 sc1
  v_pk_add_f32 v[28:29], v[64:65], v[66:67]
  v_pk_add_f32 v[30:31], v[68:69], v[70:71]
  v_pk_add_f32 v[28:29], v[28:29], v[72:73]
  v_pk_add_f32 v[30:31], v[30:31], v[74:75]
  v_pk_add_f32 v[28:29], v[28:29], v[76:77]
  v_pk_add_f32 v[30:31], v[30:31], v[78:79]
  v_pk_add_f32 v[28:29], v[28:29], v[80:81]
  v_pk_add_f32 v[30:31], v[30:31], v[82:83]
  v_pk_add_f32 v[28:29], v[28:29], v[84:85]
  v_pk_add_f32 v[30:31], v[30:31], v[86:87]
  v_pk_add_f32 v[28:29], v[28:29], v[88:89]
  v_pk_add_f32 v[30:31], v[30:31], v[90:91]
  v_pk_add_f32 v[28:29], v[28:29], v[92:93]
  v_pk_add_f32 v[30:31], v[30:31], v[94:95]
  v_pk_add_f32 v[28:29], v[28:29], v[96:97]
  v_pk_add_f32 v[30:31], v[30:31], v[98:99]
  v_pk_add_f32 v[28:29], v[28:29], v[100:101]
  v_pk_add_f32 v[30:31], v[30:31], v[102:103]
  v_pk_add_f32 v[28:29], v[28:29], v[104:105]
  v_pk_add_f32 v[30:31], v[30:31], v[106:107]
  v_pk_add_f32 v[28:29], v[28:29], v[108:109]
  v_pk_add_f32 v[30:31], v[30:31], v[110:111]
  v_pk_add_f32 v[28:29], v[28:29], v[112:113]
  v_pk_add_f32 v[30:31], v[30:31], v[114:115]
  v_pk_add_f32 v[28:29], v[28:29], v[116:117]
  v_pk_add_f32 v[30:31], v[30:31], v[118:119]
  v_pk_add_f32 v[28:29], v[28:29], v[120:121]
  v_pk_add_f32 v[30:31], v[30:31], v[122:123]
  v_pk_add_f32 v[28:29], v[28:29], v[124:125]
  v_pk_add_f32 v[30:31], v[30:31], v[126:127]
  v_pk_add_f32 v[28:29], v[28:29], v[30:31]
  v_add_f32 v28, v28, v29
  ds_write_b32 v27, v28 offset:0
  s_waitcnt lgkmcnt(0)
  s_barrier
  ds_read_b128 v[32:35], v26 offset:0
  ds_read_b128 v[36:39], v26 offset:16
  ds_read_b128 v[40:43], v26 offset:32
  ds_read_b128 v[44:47], v26 offset:48
  s_waitcnt lgkmcnt(0)
  v_pk_add_f32 v[28:29], v[32:33], v[34:35]
  v_pk_add_f32 v[30:31], v[36:37], v[38:39]
  v_pk_add_f32 v[28:29], v[28:29], v[40:41]
  v_pk_add_f32 v[30:31], v[30:31], v[42:43]
  v_pk_add_f32 v[28:29], v[28:29], v[44:45]
  v_pk_add_f32 v[30:31], v[30:31], v[46:47]
  v_pk_add_f32 v[28:29], v[28:29], v[30:31]
  v_add_f32 v28, v28, v29
  v_mul_f32 v28, 0x3a800000, v28
  v_mov_b32 v22, v28
  v_pk_add_f32 v[24:25], v[64:65], v[22:23] op_sel_hi:[1,0] neg_lo:[0,1] neg_hi:[0,1]
  v_pk_mul_f32 v[28:29], v[24:25], v[24:25]
  v_pk_add_f32 v[24:25], v[66:67], v[22:23] op_sel_hi:[1,0] neg_lo:[0,1] neg_hi:[0,1]
  v_pk_mul_f32 v[30:31], v[24:25], v[24:25]
  v_pk_add_f32 v[24:25], v[68:69], v[22:23] op_sel_hi:[1,0] neg_lo:[0,1] neg_hi:[0,1]
  v_pk_fma_f32 v[28:29], v[24:25], v[24:25], v[28:29]
  v_pk_add_f32 v[24:25], v[70:71], v[22:23] op_sel_hi:[1,0] neg_lo:[0,1] neg_hi:[0,1]
  v_pk_fma_f32 v[30:31], v[24:25], v[24:25], v[30:31]
  v_pk_add_f32 v[24:25], v[72:73], v[22:23] op_sel_hi:[1,0] neg_lo:[0,1] neg_hi:[0,1]
  v_pk_fma_f32 v[28:29], v[24:25], v[24:25], v[28:29]
  v_pk_add_f32 v[24:25], v[74:75], v[22:23] op_sel_hi:[1,0] neg_lo:[0,1] neg_hi:[0,1]
  v_pk_fma_f32 v[30:31], v[24:25], v[24:25], v[30:31]
  v_pk_add_f32 v[24:25], v[76:77], v[22:23] op_sel_hi:[1,0] neg_lo:[0,1] neg_hi:[0,1]
  v_pk_fma_f32 v[28:29], v[24:25], v[24:25], v[28:29]
  v_pk_add_f32 v[24:25], v[78:79], v[22:23] op_sel_hi:[1,0] neg_lo:[0,1] neg_hi:[0,1]
  v_pk_fma_f32 v[30:31], v[24:25], v[24:25], v[30:31]
  v_pk_add_f32 v[24:25], v[80:81], v[22:23] op_sel_hi:[1,0] neg_lo:[0,1] neg_hi:[0,1]
  v_pk_fma_f32 v[28:29], v[24:25], v[24:25], v[28:29]
  v_pk_add_f32 v[24:25], v[82:83], v[22:23] op_sel_hi:[1,0] neg_lo:[0,1] neg_hi:[0,1]
  v_pk_fma_f32 v[30:31], v[24:25], v[24:25], v[30:31]
  v_pk_add_f32 v[24:25], v[84:85], v[22:23] op_sel_hi:[1,0] neg_lo:[0,1] neg_hi:[0,1]
  v_pk_fma_f32 v[28:29], v[24:25], v[24:25], v[28:29]
  v_pk_add_f32 v[24:25], v[86:87], v[22:23] op_sel_hi:[1,0] neg_lo:[0,1] neg_hi:[0,1]
  v_pk_fma_f32 v[30:31], v[24:25], v[24:25], v[30:31]
  v_pk_add_f32 v[24:25], v[88:89], v[22:23] op_sel_hi:[1,0] neg_lo:[0,1] neg_hi:[0,1]
  v_pk_fma_f32 v[28:29], v[24:25], v[24:25], v[28:29]
  v_pk_add_f32 v[24:25], v[90:91], v[22:23] op_sel_hi:[1,0] neg_lo:[0,1] neg_hi:[0,1]
  v_pk_fma_f32 v[30:31], v[24:25], v[24:25], v[30:31]
  v_pk_add_f32 v[24:25], v[92:93], v[22:23] op_sel_hi:[1,0] neg_lo:[0,1] neg_hi:[0,1]
  v_pk_fma_f32 v[28:29], v[24:25], v[24:25], v[28:29]
  v_pk_add_f32 v[24:25], v[94:95], v[22:23] op_sel_hi:[1,0] neg_lo:[0,1] neg_hi:[0,1]
  v_pk_fma_f32 v[30:31], v[24:25], v[24:25], v[30:31]
  v_pk_add_f32 v[24:25], v[96:97], v[22:23] op_sel_hi:[1,0] neg_lo:[0,1] neg_hi:[0,1]
  v_pk_fma_f32 v[28:29], v[24:25], v[24:25], v[28:29]
  v_pk_add_f32 v[24:25], v[98:99], v[22:23] op_sel_hi:[1,0] neg_lo:[0,1] neg_hi:[0,1]
  v_pk_fma_f32 v[30:31], v[24:25], v[24:25], v[30:31]
  v_pk_add_f32 v[24:25], v[100:101], v[22:23] op_sel_hi:[1,0] neg_lo:[0,1] neg_hi:[0,1]
  v_pk_fma_f32 v[28:29], v[24:25], v[24:25], v[28:29]
  v_pk_add_f32 v[24:25], v[102:103], v[22:23] op_sel_hi:[1,0] neg_lo:[0,1] neg_hi:[0,1]
  v_pk_fma_f32 v[30:31], v[24:25], v[24:25], v[30:31]
  v_pk_add_f32 v[24:25], v[104:105], v[22:23] op_sel_hi:[1,0] neg_lo:[0,1] neg_hi:[0,1]
  v_pk_fma_f32 v[28:29], v[24:25], v[24:25], v[28:29]
  v_pk_add_f32 v[24:25], v[106:107], v[22:23] op_sel_hi:[1,0] neg_lo:[0,1] neg_hi:[0,1]
  v_pk_fma_f32 v[30:31], v[24:25], v[24:25], v[30:31]
  v_pk_add_f32 v[24:25], v[108:109], v[22:23] op_sel_hi:[1,0] neg_lo:[0,1] neg_hi:[0,1]
  v_pk_fma_f32 v[28:29], v[24:25], v[24:25], v[28:29]
  v_pk_add_f32 v[24:25], v[110:111], v[22:23] op_sel_hi:[1,0] neg_lo:[0,1] neg_hi:[0,1]
  v_pk_fma_f32 v[30:31], v[24:25], v[24:25], v[30:31]
  v_pk_add_f32 v[24:25], v[112:113], v[22:23] op_sel_hi:[1,0] neg_lo:[0,1] neg_hi:[0,1]
  v_pk_fma_f32 v[28:29], v[24:25], v[24:25], v[28:29]
  v_pk_add_f32 v[24:25], v[114:115], v[22:23] op_sel_hi:[1,0] neg_lo:[0,1] neg_hi:[0,1]
  v_pk_fma_f32 v[30:31], v[24:25], v[24:25], v[30:31]
  v_pk_add_f32 v[24:25], v[116:117], v[22:23] op_sel_hi:[1,0] neg_lo:[0,1] neg_hi:[0,1]
  v_pk_fma_f32 v[28:29], v[24:25], v[24:25], v[28:29]
  v_pk_add_f32 v[24:25], v[118:119], v[22:23] op_sel_hi:[1,0] neg_lo:[0,1] neg_hi:[0,1]
  v_pk_fma_f32 v[30:31], v[24:25], v[24:25], v[30:31]
  v_pk_add_f32 v[24:25], v[120:121], v[22:23] op_sel_hi:[1,0] neg_lo:[0,1] neg_hi:[0,1]
  v_pk_fma_f32 v[28:29], v[24:25], v[24:25], v[28:29]
  v_pk_add_f32 v[24:25], v[122:123], v[22:23] op_sel_hi:[1,0] neg_lo:[0,1] neg_hi:[0,1]
  v_pk_fma_f32 v[30:31], v[24:25], v[24:25], v[30:31]
  v_pk_add_f32 v[24:25], v[124:125], v[22:23] op_sel_hi:[1,0] neg_lo:[0,1] neg_hi:[0,1]
  v_pk_fma_f32 v[28:29], v[24:25], v[24:25], v[28:29]
  v_pk_add_f32 v[24:25], v[126:127], v[22:23] op_sel_hi:[1,0] neg_lo:[0,1] neg_hi:[0,1]
  v_pk_fma_f32 v[30:31], v[24:25], v[24:25], v[30:31]
  v_pk_add_f32 v[28:29], v[28:29], v[30:31]
  v_add_f32 v28, v28, v29
  ds_write_b32 v27, v28 offset:1024
  s_waitcnt lgkmcnt(0)
  s_barrier
  ds_read_b128 v[32:35], v26 offset:1024
  ds_read_b128 v[36:39], v26 offset:1040
  ds_read_b128 v[40:43], v26 offset:1056
  ds_read_b128 v[44:47], v26 offset:1072
  s_waitcnt lgkmcnt(0)
  v_pk_add_f32 v[28:29], v[32:33], v[34:35]
  v_pk_add_f32 v[30:31], v[36:37], v[38:39]
  v_pk_add_f32 v[28:29], v[28:29], v[40:41]
  v_pk_add_f32 v[30:31], v[30:31], v[42:43]
  v_pk_add_f32 v[28:29], v[28:29], v[44:45]
  v_pk_add_f32 v[30:31], v[30:31], v[46:47]
  v_pk_add_f32 v[28:29], v[28:29], v[30:31]
  v_add_f32 v28, v28, v29
  v_mul_f32 v28, 0x3a800000, v28
  v_cvt_pk_bf16_f32 v24, v22, v28
  v_lshlrev_b32 v22, 16, v24
  v_and_b32 v28, 0xffff0000, v24
  v_add_f32 v28, 0x3727c5ac, v28
  v_cvt_pk_bf16_f32 v28, v28, v28
  v_lshlrev_b32 v28, 16, v28
  v_sqrt_f32 v28, v28
  s_nop 0
  v_cvt_pk_bf16_f32 v28, v28, v28
  v_lshlrev_b32 v28, 16, v28
  v_rcp_f32 v28, v28
  s_waitcnt vmcnt(0)
  s_mov_b32 s4, 0
  v_mov_b32 v18, v21
  s_branch VR_1_c
VR_1:
  s_sleep 4
  buffer_load_dword v18, off, s[68:71], 0 offset:136 sc1
  s_add_u32 s4, s4, 1
  s_cmp_gt_u32 s4, 0x10000
  s_cbranch_scc1 L_abort
  s_waitcnt vmcnt(0)
VR_1_c:
  v_readfirstlane_b32 s3, v18
  s_cmp_eq_u32 s3, 0
  s_cbranch_scc1 VR_1
  s_sub_u32 s3, s3, 1
  s_and_b32 s3, s3, 7
  s_cmp_lg_u32 s3, s89
  s_cbranch_scc1 L_redo
  s_lshl_b32 s3, s23, 10
  s_lshl_b32 s4, s27, 20
  s_add_u32 s3, s3, s4
  v_pk_add_f32 v[24:25], v[64:65], v[22:23] op_sel_hi:[1,0] neg_lo:[0,1] neg_hi:[0,1]
  v_cvt_pk_bf16_f32 v25, v24, v25
  v_lshlrev_b32 v24, 16, v25
  v_and_b32 v25, 0xffff0000, v25
  v_pk_mul_f32 v[24:25], v[24:25], v[28:29] op_sel_hi:[1,0]
  v_cvt_pk_bf16_f32 v32, v24, v25
  v_pk_add_f32 v[24:25], v[66:67], v[22:23] op_sel_hi:[1,0] neg_lo:[0,1] neg_hi:[0,1]
  v_cvt_pk_bf16_f32 v25, v24, v25
  v_lshlrev_b32 v24, 16, v25
  v_and_b32 v25, 0xffff0000, v25
  v_pk_mul_f32 v[24:25], v[24:25], v[28:29] op_sel_hi:[1,0]
  v_cvt_pk_bf16_f32 v33, v24, v25
  v_pk_add_f32 v[24:25], v[68:69], v[22:23] op_sel_hi:[1,0] neg_lo:[0,1] neg_hi:[0,1]
  v_cvt_pk_bf16_f32 v25, v24, v25
  v_lshlrev_b32 v24, 16, v25
  v_and_b32 v25, 0xffff0000, v25
  v_pk_mul_f32 v[24:25], v[24:25], v[28:29] op_sel_hi:[1,0]
  v_cvt_pk_bf16_f32 v34, v24, v25
  v_pk_add_f32 v[24:25], v[70:71], v[22:23] op_sel_hi:[1,0] neg_lo:[0,1] neg_hi:[0,1]
  v_cvt_pk_bf16_f32 v25, v24, v25
  v_lshlrev_b32 v24, 16, v25
  v_and_b32 v25, 0xffff0000, v25
  v_pk_mul_f32 v[24:25], v[24:25], v[28:29] op_sel_hi:[1,0]
  v_cvt_pk_bf16_f32 v35, v24, v25
  buffer_store_dwordx4 v[32:35], v0, s[8:11], s3 offen sc1
  s_add_u32 s3, s3, 131072
  v_pk_add_f32 v[24:25], v[72:73], v[22:23] op_sel_hi:[1,0] neg_lo:[0,1] neg_hi:[0,1]
  v_cvt_pk_bf16_f32 v25, v24, v25
  v_lshlrev_b32 v24, 16, v25
  v_and_b32 v25, 0xffff0000, v25
  v_pk_mul_f32 v[24:25], v[24:25], v[28:29] op_sel_hi:[1,0]
  v_cvt_pk_bf16_f32 v36, v24, v25
  v_pk_add_f32 v[24:25], v[74:75], v[22:23] op_sel_hi:[1,0] neg_lo:[0,1] neg_hi:[0,1]
  v_cvt_pk_bf16_f32 v25, v24, v25
  v_lshlrev_b32 v24, 16, v25
  v_and_b32 v25, 0xffff0000, v25
  v_pk_mul_f32 v[24:25], v[24:25], v[28:29] op_sel_hi:[1,0]
  v_cvt_pk_bf16_f32 v37, v24, v25
  v_pk_add_f32 v[24:25], v[76:77], v[22:23] op_sel_hi:[1,0] neg_lo:[0,1] neg_hi:[0,1]
  v_cvt_pk_bf16_f32 v25, v24, v25
  v_lshlrev_b32 v24, 16, v25
  v_and_b32 v25, 0xffff0000, v25
  v_pk_mul_f32 v[24:25], v[24:25], v[28:29] op_sel_hi:[1,0]
  v_cvt_pk_bf16_f32 v38, v24, v25
  v_pk_add_f32 v[24:25], v[78:79], v[22:23] op_sel_hi:[1,0] neg_lo:[0,1] neg_hi:[0,1]
  v_cvt_pk_bf16_f32 v25, v24, v25
  v_lshlrev_b32 v24, 16, v25
  v_and_b32 v25, 0xffff0000, v25
  v_pk_mul_f32 v[24:25], v[24:25], v[28:29] op_sel_hi:[1,0]
  v_cvt_pk_bf16_f32 v39, v24, v25
  buffer_store_dwordx4 v[36:39], v0, s[8:11], s3 offen sc1
  s_add_u32 s3, s3, 131072
  v_pk_add_f32 v[24:25], v[80:81], v[22:23] op_sel_hi:[1,0] neg_lo:[0,1] neg_hi:[0,1]
  v_cvt_pk_bf16_f32 v25, v24, v25
  v_lshlrev_b32 v24, 16, v25
  v_and_b32 v25, 0xffff0000, v25
  v_pk_mul_f32 v[24:25], v[24:25], v[28:29] op_sel_hi:[1,0]
  v_cvt_pk_bf16_f32 v40, v24, v25
  v_pk_add_f32 v[24:25], v[82:83], v[22:23] op_sel_hi:[1,0] neg_lo:[0,1] neg_hi:[0,1]
  v_cvt_pk_bf16_f32 v25, v24, v25
  v_lshlrev_b32 v24, 16, v25
  v_and_b32 v25, 0xffff0000, v25
  v_pk_mul_f32 v[24:25], v[24:25], v[28:29] op_sel_hi:[1,0]
  v_cvt_pk_bf16_f32 v41, v24, v25
  v_pk_add_f32 v[24:25], v[84:85], v[22:23] op_sel_hi:[1,0] neg_lo:[0,1] neg_hi:[0,1]
  v_cvt_pk_bf16_f32 v25, v24, v25
  v_lshlrev_b32 v24, 16, v25
  v_and_b32 v25, 0xffff0000, v25
  v_pk_mul_f32 v[24:25], v[24:25], v[28:29] op_sel_hi:[1,0]
  v_cvt_pk_bf16_f32 v42, v24, v25
  v_pk_add_f32 v[24:25], v[86:87], v[22:23] op_sel_hi:[1,0] neg_lo:[0,1] neg_hi:[0,1]
  v_cvt_pk_bf16_f32 v25, v24, v25
  v_lshlrev_b32 v24, 16, v25
  v_and_b32 v25, 0xffff0000, v25
  v_pk_mul_f32 v[24:25], v[24:25], v[28:29] op_sel_hi:[1,0]
  v_cvt_pk_bf16_f32 v43, v24, v25
  buffer_store_dwordx4 v[40:43], v0, s[8:11], s3 offen sc1
  s_add_u32 s3, s3, 131072
  v_pk_add_f32 v[24:25], v[88:89], v[22:23] op_sel_hi:[1,0] neg_lo:[0,1] neg_hi:[0,1]
  v_cvt_pk_bf16_f32 v25, v24, v25
  v_lshlrev_b32 v24, 16, v25
  v_and_b32 v25, 0xffff0000, v25
  v_pk_mul_f32 v[24:25], v[24:25], v[28:29] op_sel_hi:[1,0]
  v_cvt_pk_bf16_f32 v44, v24, v25
  v_pk_add_f32 v[24:25], v[90:91], v[22:23] op_sel_hi:[1,0] neg_lo:[0,1] neg_hi:[0,1]
  v_cvt_pk_bf16_f32 v25, v24, v25
  v_lshlrev_b32 v24, 16, v25
  v_and_b32 v25, 0xffff0000, v25
  v_pk_mul_f32 v[24:25], v[24:25], v[28:29] op_sel_hi:[1,0]
  v_cvt_pk_bf16_f32 v45, v24, v25
  v_pk_add_f32 v[24:25], v[92:93], v[22:23] op_sel_hi:[1,0] neg_lo:[0,1] neg_hi:[0,1]
  v_cvt_pk_bf16_f32 v25, v24, v25
  v_lshlrev_b32 v24, 16, v25
  v_and_b32 v25, 0xffff0000, v25
  v_pk_mul_f32 v[24:25], v[24:25], v[28:29] op_sel_hi:[1,0]
  v_cvt_pk_bf16_f32 v46, v24, v25
  v_pk_add_f32 v[24:25], v[94:95], v[22:23] op_sel_hi:[1,0] neg_lo:[0,1] neg_hi:[0,1]
  v_cvt_pk_bf16_f32 v25, v24, v25
  v_lshlrev_b32 v24, 16, v25
  v_and_b32 v25, 0xffff0000, v25
  v_pk_mul_f32 v[24:25], v[24:25], v[28:29] op_sel_hi:[1,0]
  v_cvt_pk_bf16_f32 v47, v24, v25
  buffer_store_dwordx4 v[44:47], v0, s[8:11], s3 offen sc1
  s_add_u32 s3, s3, 131072
  v_pk_add_f32 v[24:25], v[96:97], v[22:23] op_sel_hi:[1,0] neg_lo:[0,1] neg_hi:[0,1]
  v_cvt_pk_bf16_f32 v25, v24, v25
  v_lshlrev_b32 v24, 16, v25
  v_and_b32 v25, 0xffff0000, v25
  v_pk_mul_f32 v[24:25], v[24:25], v[28:29] op_sel_hi:[1,0]
  v_cvt_pk_bf16_f32 v48, v24, v25
  v_pk_add_f32 v[24:25], v[98:99], v[22:23] op_sel_hi:[1,0] neg_lo:[0,1] neg_hi:[0,1]
  v_cvt_pk_bf16_f32 v25, v24, v25
  v_lshlrev_b32 v24, 16, v25
  v_and_b32 v25, 0xffff0000, v25
  v_pk_mul_f32 v[24:25], v[24:25], v[28:29] op_sel_hi:[1,0]
  v_cvt_pk_bf16_f32 v49, v24, v25
  v_pk_add_f32 v[24:25], v[100:101], v[22:23] op_sel_hi:[1,0] neg_lo:[0,1] neg_hi:[0,1]
  v_cvt_pk_bf16_f32 v25, v24, v25
  v_lshlrev_b32 v24, 16, v25
  v_and_b32 v25, 0xffff0000, v25
  v_pk_mul_f32 v[24:25], v[24:25], v[28:29] op_sel_hi:[1,0]
  v_cvt_pk_bf16_f32 v50, v24, v25
  v_pk_add_f32 v[24:25], v[102:103], v[22:23] op_sel_hi:[1,0] neg_lo:[0,1] neg_hi:[0,1]
  v_cvt_pk_bf16_f32 v25, v24, v25
  v_lshlrev_b32 v24, 16, v25
  v_and_b32 v25, 0xffff0000, v25
  v_pk_mul_f32 v[24:25], v[24:25], v[28:29] op_sel_hi:[1,0]
  v_cvt_pk_bf16_f32 v51, v24, v25
  buffer_store_dwordx4 v[48:51], v0, s[8:11], s3 offen sc1
  s_add_u32 s3, s3, 131072
  v_pk_add_f32 v[24:25], v[104:105], v[22:23] op_sel_hi:[1,0] neg_lo:[0,1] neg_hi:[0,1]
  v_cvt_pk_bf16_f32 v25, v24, v25
  v_lshlrev_b32 v24, 16, v25
  v_and_b32 v25, 0xffff0000, v25
  v_pk_mul_f32 v[24:25], v[24:25], v[28:29] op_sel_hi:[1,0]
  v_cvt_pk_bf16_f32 v52, v24, v25
  v_pk_add_f32 v[24:25], v[106:107], v[22:23] op_sel_hi:[1,0] neg_lo:[0,1] neg_hi:[0,1]
  v_cvt_pk_bf16_f32 v25, v24, v25
  v_lshlrev_b32 v24, 16, v25
  v_and_b32 v25, 0xffff0000, v25
  v_pk_mul_f32 v[24:25], v[24:25], v[28:29] op_sel_hi:[1,0]
  v_cvt_pk_bf16_f32 v53, v24, v25
  v_pk_add_f32 v[24:25], v[108:109], v[22:23] op_sel_hi:[1,0] neg_lo:[0,1] neg_hi:[0,1]
  v_cvt_pk_bf16_f32 v25, v24, v25
  v_lshlrev_b32 v24, 16, v25
  v_and_b32 v25, 0xffff0000, v25
  v_pk_mul_f32 v[24:25], v[24:25], v[28:29] op_sel_hi:[1,0]
  v_cvt_pk_bf16_f32 v54, v24, v25
  v_pk_add_f32 v[24:25], v[110:111], v[22:23] op_sel_hi:[1,0] neg_lo:[0,1] neg_hi:[0,1]
  v_cvt_pk_bf16_f32 v25, v24, v25
  v_lshlrev_b32 v24, 16, v25
  v_and_b32 v25, 0xffff0000, v25
  v_pk_mul_f32 v[24:25], v[24:25], v[28:29] op_sel_hi:[1,0]
  v_cvt_pk_bf16_f32 v55, v24, v25
  buffer_store_dwordx4 v[52:55], v0, s[8:11], s3 offen sc1
  s_add_u32 s3, s3, 131072
  v_pk_add_f32 v[24:25], v[112:113], v[22:23] op_sel_hi:[1,0] neg_lo:[0,1] neg_hi:[0,1]
  v_cvt_pk_bf16_f32 v25, v24, v25
  v_lshlrev_b32 v24, 16, v25
  v_and_b32 v25, 0xffff0000, v25
  v_pk_mul_f32 v[24:25], v[24:25], v[28:29] op_sel_hi:[1,0]
  v_cvt_pk_bf16_f32 v56, v24, v25
  v_pk_add_f32 v[24:25], v[114:115], v[22:23] op_sel_hi:[1,0] neg_lo:[0,1] neg_hi:[0,1]
  v_cvt_pk_bf16_f32 v25, v24, v25
  v_lshlrev_b32 v24, 16, v25
  v_and_b32 v25, 0xffff0000, v25
  v_pk_mul_f32 v[24:25], v[24:25], v[28:29] op_sel_hi:[1,0]
  v_cvt_pk_bf16_f32 v57, v24, v25
  v_pk_add_f32 v[24:25], v[116:117], v[22:23] op_sel_hi:[1,0] neg_lo:[0,1] neg_hi:[0,1]
  v_cvt_pk_bf16_f32 v25, v24, v25
  v_lshlrev_b32 v24, 16, v25
  v_and_b32 v25, 0xffff0000, v25
  v_pk_mul_f32 v[24:25], v[24:25], v[28:29] op_sel_hi:[1,0]
  v_cvt_pk_bf16_f32 v58, v24, v25
  v_pk_add_f32 v[24:25], v[118:119], v[22:23] op_sel_hi:[1,0] neg_lo:[0,1] neg_hi:[0,1]
  v_cvt_pk_bf16_f32 v25, v24, v25
  v_lshlrev_b32 v24, 16, v25
  v_and_b32 v25, 0xffff0000, v25
  v_pk_mul_f32 v[24:25], v[24:25], v[28:29] op_sel_hi:[1,0]
  v_cvt_pk_bf16_f32 v59, v24, v25
  buffer_store_dwordx4 v[56:59], v0, s[8:11], s3 offen sc1
  s_add_u32 s3, s3, 131072
  v_pk_add_f32 v[24:25], v[120:121], v[22:23] op_sel_hi:[1,0] neg_lo:[0,1] neg_hi:[0,1]
  v_cvt_pk_bf16_f32 v25, v24, v25
  v_lshlrev_b32 v24, 16, v25
  v_and_b32 v25, 0xffff0000, v25
  v_pk_mul_f32 v[24:25], v[24:25], v[28:29] op_sel_hi:[1,0]
  v_cvt_pk_bf16_f32 v60, v24, v25
  v_pk_add_f32 v[24:25], v[122:123], v[22:23] op_sel_hi:[1,0] neg_lo:[0,1] neg_hi:[0,1]
  v_cvt_pk_bf16_f32 v25, v24, v25
  v_lshlrev_b32 v24, 16, v25
  v_and_b32 v25, 0xffff0000, v25
  v_pk_mul_f32 v[24:25], v[24:25], v[28:29] op_sel_hi:[1,0]
  v_cvt_pk_bf16_f32 v61, v24, v25
  v_pk_add_f32 v[24:25], v[124:125], v[22:23] op_sel_hi:[1,0] neg_lo:[0,1] neg_hi:[0,1]
  v_cvt_pk_bf16_f32 v25, v24, v25
  v_lshlrev_b32 v24, 16, v25
  v_and_b32 v25, 0xffff0000, v25
  v_pk_mul_f32 v[24:25], v[24:25], v[28:29] op_sel_hi:[1,0]
  v_cvt_pk_bf16_f32 v62, v24, v25
  v_pk_add_f32 v[24:25], v[126:127], v[22:23] op_sel_hi:[1,0] neg_lo:[0,1] neg_hi:[0,1]
  v_cvt_pk_bf16_f32 v25, v24, v25
  v_lshlrev_b32 v24, 16, v25
  v_and_b32 v25, 0xffff0000, v25
  v_pk_mul_f32 v[24:25], v[24:25], v[28:29] op_sel_hi:[1,0]
  v_cvt_pk_bf16_f32 v63, v24, v25
  buffer_store_dwordx4 v[60:63], v0, s[8:11], s3 offen sc1
  s_add_u32 s3, s3, 131072
  s_waitcnt vmcnt(0)
  s_barrier
  s_cmp_ge_u32 s23, 8
  s_cbranch_scc1 ST_n0
  s_cmp_lg_u32 s27, 0
  s_cbranch_scc1 DA_2
  v_mov_b32 v18, 1
  s_mov_b64 exec, 1
  buffer_atomic_add v18, off, s[68:71], 0 offset:140 sc1
  s_mov_b64 exec, -1
DA_2:
ST_n0:
  s_cmp_lg_u32 s27, 0
  s_cbranch_scc1 DA_3
  v_mov_b32 v18, 1
  s_mov_b64 exec, 1
  buffer_atomic_add v18, off, s[68:71], 0 offset:0 sc1
  s_mov_b64 exec, -1
DA_3:
  s_branch L_sched
ST_misc:
  s_mov_b32 s4, 0
VR_4:
  s_sleep 4
  buffer_load_dword v18, off, s[68:71], 0 offset:136 sc1
  s_add_u32 s4, s4, 1
  s_cmp_gt_u32 s4, 0x10000
  s_cbranch_scc1 L_abort
  s_waitcnt vmcnt(0)
VR_4_c:
  v_readfirstlane_b32 s3, v18
  s_cmp_eq_u32 s3, 0
  s_cbranch_scc1 VR_4
  s_sub_u32 s3, s3, 1
  s_and_b32 s3, s3, 7
  s_cmp_lg_u32 s3, s89
  s_cbranch_scc1 L_redo
  s_lshr_b32 s23, s2, 3
  s_lshl_b32 s23, s23, 1
  s_and_b32 s3, s2, 7
  s_cmp_eq_u32 s3, 2
  s_addc_u32 s23, s23, 0
  v_mov_b32 v32, 0xffbfffbf
  v_mov_b32 v33, 0xffbfffbf
  v_mov_b32 v34, 0xffbfffbf
  v_mov_b32 v35, 0xffbfffbf
  v_mov_b32 v36, 0xffbfffbf
  v_mov_b32 v37, 0xffbfffbf
  v_mov_b32 v38, 0xffbfffbf
  v_mov_b32 v39, 0xffbfffbf
  v_mov_b32 v40, 0xffbfffbf
  v_mov_b32 v41, 0xffbfffbf
  v_mov_b32 v42, 0xffbfffbf
  v_mov_b32 v43, 0xffbfffbf
  v_mov_b32 v44, 0xffbfffbf
  v_mov_b32 v45, 0xffbfffbf
  v_mov_b32 v46, 0xffbfffbf
  v_mov_b32 v47, 0xffbfffbf
  s_lshl_b32 s5, s27, 10
  v_add_u32 v22, s5, v0
  s_cmp_ge_u32 s23, 6
  s_cbranch_scc1 ST_fill
  s_mov_b32 s44, s58
  s_mov_b32 s45, s59
  s_mov_b32 s46, 0x4000
  s_mov_b32 s47, 0x20000
  s_mov_b32 s3, 0x13
  s_bitcmp1_b32 s3, s23
  s_cselect_b32 s46, s46, 0
  v_bfe_u32 v18, v22, 4, 3
  v_lshlrev_b32 v23, 11, v18
  v_lshrrev_b32 v18, 9, v22
  v_lshl_add_u32 v23, v18, 6, v23
  v_bfe_u32 v18, v22, 8, 1
  v_lshl_add_u32 v23, v18, 4, v23
  v_bfe_u32 v18, v22, 7, 1
  v_lshl_add_u32 v23, v18, 2, v23
  s_and_b32 s4, s23, 1
  s_lshl_b32 s4, s4, 10
  s_cmp_eq_u32 s23, 4
  s_cselect_b32 s5, 1024, 0
  s_add_u32 s3, s4, 0
  buffer_load_dword v48, v23, s[44:47], s3 offen offset:0
  buffer_load_dword v49, v23, s[44:47], s3 offen offset:32
  buffer_load_dword v50, v23, s[44:47], s3 offen offset:8
  buffer_load_dword v51, v23, s[44:47], s3 offen offset:40
  s_add_u32 s3, s4, 512
  buffer_load_dword v52, v23, s[44:47], s3 offen offset:0
  buffer_load_dword v53, v23, s[44:47], s3 offen offset:32
  buffer_load_dword v54, v23, s[44:47], s3 offen offset:8
  buffer_load_dword v55, v23, s[44:47], s3 offen offset:40
  s_add_u32 s3, s4, 0
  s_add_u32 s3, s3, s5
  buffer_load_dword v56, v23, s[44:47], s3 offen offset:0
  buffer_load_dword v57, v23, s[44:47], s3 offen offset:32
  buffer_load_dword v58, v23, s[44:47], s3 offen offset:8
  buffer_load_dword v59, v23, s[44:47], s3 offen offset:40
  s_add_u32 s3, s4, 512
  s_add_u32 s3, s3, s5
  buffer_load_dword v60, v23, s[44:47], s3 offen offset:0
  buffer_load_dword v61, v23, s[44:47], s3 offen offset:32
  buffer_load_dword v62, v23, s[44:47], s3 offen offset:8
  buffer_load_dword v63, v23, s[44:47], s3 offen offset:40
  s_waitcnt vmcnt(0)
  v_cmp_eq_u32 vcc, v32, v48
  s_nop 1
  v_cndmask_b32 v32, v48, -1, vcc
  v_cmp_eq_u32 vcc, v33, v49
  s_nop 1
  v_cndmask_b32 v33, v49, -1, vcc
  v_cmp_eq_u32 vcc, v34, v50
  s_nop 1
  v_cndmask_b32 v34, v50, -1, vcc
  v_cmp_eq_u32 vcc, v35, v51
  s_nop 1
  v_cndmask_b32 v35, v51, -1, vcc
  v_cmp_eq_u32 vcc, v36, v52
  s_nop 1
  v_cndmask_b32 v36, v52, -1, vcc
  v_cmp_eq_u32 vcc, v37, v53
  s_nop 1
  v_cndmask_b32 v37, v53, -1, vcc
  v_cmp_eq_u32 vcc, v38, v54
  s_nop 1
  v_cndmask_b32 v38, v54, -1, vcc
  v_cmp_eq_u32 vcc, v39, v55
  s_nop 1
  v_cndmask_b32 v39, v55, -1, vcc
  v_cmp_eq_u32 vcc, v40, v56
  s_nop 1
  v_cndmask_b32 v40, v56, -1, vcc
  v_cmp_eq_u32 vcc, v41, v57
  s_nop 1
  v_cndmask_b32 v41, v57, -1, vcc
  v_cmp_eq_u32 vcc, v42, v58
  s_nop 1
  v_cndmask_b32 v42, v58, -1, vcc
  v_cmp_eq_u32 vcc, v43, v59
  s_nop 1
  v_cndmask_b32 v43, v59, -1, vcc
  v_cmp_eq_u32 vcc, v44, v60
  s_nop 1
  v_cndmask_b32 v44, v60, -1, vcc
  v_cmp_eq_u32 vcc, v45, v61
  s_nop 1
  v_cndmask_b32 v45, v61, -1, vcc
  v_cmp_eq_u32 vcc, v46, v62
  s_nop 1
  v_cndmask_b32 v46, v62, -1, vcc
  v_cmp_eq_u32 vcc, v47, v63
  s_nop 1
  v_cndmask_b32 v47, v63, -1, vcc
ST_fill:
  s_lshl_b32 s3, s23, 14
  s_add_u32 s3, s3, 85983232
  buffer_store_dwordx4 v[32:35], v22, s[8:11], s3 offen sc1
  s_add_u32 s3, s3, 4096
  buffer_store_dwordx4 v[36:39], v22, s[8:11], s3 offen sc1
  s_add_u32 s3, s3, 4096
  buffer_store_dwordx4 v[40:43], v22, s[8:11], s3 offen sc1
  s_add_u32 s3, s3, 4096
  buffer_store_dwordx4 v[44:47], v22, s[8:11], s3 offen sc1
  s_add_u32 s3, s3, 4096
  v_mov_b32 v19, 0
  s_lshl_b32 s3, s23, 8
  s_add_u32 s3, s3, 99614720
  v_lshrrev_b32 v18, 2, v0
  buffer_store_dword v19, v18, s[8:11], s3 offen sc1
  s_waitcnt vmcnt(0)
  s_barrier
  s_cmp_lg_u32 s23, 0
  s_cbranch_scc1 ST_n1
  s_cmp_lg_u32 s27, 0
  s_cbranch_scc1 DA_5
  v_mov_b32 v18, 1
  s_mov_b64 exec, 1
  buffer_atomic_add v18, off, s[68:71], 0 offset:140 sc1
  s_mov_b64 exec, -1
DA_5:
ST_n1:
  s_cmp_lg_u32 s27, 0
  s_cbranch_scc1 DA_6
  v_mov_b32 v18, 1
  s_mov_b64 exec, 1
  buffer_atomic_add v18, off, s[68:71], 0 offset:0 sc1
  s_mov_b64 exec, -1
DA_6:
  s_cmp_eq_u32 s2, 248
  s_cbranch_scc1 ST_cal
  s_branch L_sched
ST_cal:
  s_cmp_lg_u32 s27, 0
  s_cbranch_scc1 ST_mw
  s_mov_b64 exec, 1
  s_mov_b32 s23, 0
  s_mov_b32 s3, 0x523d000
  s_waitcnt vmcnt(0)
  s_memtime s[4:5]
  s_waitcnt lgkmcnt(0)
  buffer_store_dword v19, off, s[8:11], s3 sc1
  s_waitcnt vmcnt(0)
  s_memtime s[6:7]
  s_waitcnt lgkmcnt(0)
  s_mov_b32 s3, 0x523e000
  s_waitcnt vmcnt(0)
  s_memtime s[4:5]
  s_waitcnt lgkmcnt(0)
  buffer_store_dword v19, off, s[8:11], s3 sc1
  s_waitcnt vmcnt(0)
  s_memtime s[6:7]
  s_waitcnt lgkmcnt(0)
  s_sub_u32 s6, s6, s4
  s_min_u32 s6, s6, 3000
  s_sub_u32 s23, s23, s6
  s_mov_b32 s3, 0x523c000
  s_waitcnt vmcnt(0)
  s_memtime s[4:5]
  s_waitcnt lgkmcnt(0)
  buffer_store_dword v19, off, s[8:11], s3 sc1
  s_waitcnt vmcnt(0)
  s_memtime s[6:7]
  s_waitcnt lgkmcnt(0)
  s_sub_u32 s6, s6, s4
  s_min_u32 s6, s6, 3000
  s_add_u32 s23, s23, s6
  s_mov_b32 s3, 0x527d000
  s_waitcnt vmcnt(0)
  s_memtime s[4:5]
  s_waitcnt lgkmcnt(0)
  buffer_store_dword v19, off, s[8:11], s3 sc1
  s_waitcnt vmcnt(0)
  s_memtime s[6:7]
  s_waitcnt lgkmcnt(0)
  s_sub_u32 s6, s6, s4
  s_min_u32 s6, s6, 3000
  s_add_u32 s23, s23, s6
  s_mov_b32 s3, 0x527f000
  s_waitcnt vmcnt(0)
  s_memtime s[4:5]
  s_waitcnt lgkmcnt(0)
  buffer_store_dword v19, off, s[8:11], s3 sc1
  s_waitcnt vmcnt(0)
  s_memtime s[6:7]
  s_waitcnt lgkmcnt(0)
  s_sub_u32 s6, s6, s4
  s_min_u32 s6, s6, 3000
  s_sub_u32 s23, s23, s6
  s_mov_b32 s3, 0x52be000
  s_waitcnt vmcnt(0)
  s_memtime s[4:5]
  s_waitcnt lgkmcnt(0)
  buffer_store_dword v19, off, s[8:11], s3 sc1
  s_waitcnt vmcnt(0)
  s_memtime s[6:7]
  s_waitcnt lgkmcnt(0)
  s_sub_u32 s6, s6, s4
  s_min_u32 s6, s6, 3000
  s_sub_u32 s23, s23, s6
  s_mov_b32 s3, 0x52bc000
  s_waitcnt vmcnt(0)
  s_memtime s[4:5]
  s_waitcnt lgkmcnt(0)
  buffer_store_dword v19, off, s[8:11], s3 sc1
  s_waitcnt vmcnt(0)
  s_memtime s[6:7]
  s_waitcnt lgkmcnt(0)
  s_sub_u32 s6, s6, s4
  s_min_u32 s6, s6, 3000
  s_add_u32 s23, s23, s6
  s_mov_b32 s3, 0x52fd000
  s_waitcnt vmcnt(0)
  s_memtime s[4:5]
  s_waitcnt lgkmcnt(0)
  buffer_store_dword v19, off, s[8:11], s3 sc1
  s_waitcnt vmcnt(0)
  s_memtime s[6:7]
  s_waitcnt lgkmcnt(0)
  s_sub_u32 s6, s6, s4
  s_min_u32 s6, s6, 3000
  s_add_u32 s23, s23, s6
  s_mov_b32 s3, 0x52ff000
  s_waitcnt vmcnt(0)
  s_memtime s[4:5]
  s_waitcnt lgkmcnt(0)
  buffer_store_dword v19, off, s[8:11], s3 sc1
  s_waitcnt vmcnt(0)
  s_memtime s[6:7]
  s_waitcnt lgkmcnt(0)
  s_sub_u32 s6, s6, s4
  s_min_u32 s6, s6, 3000
  s_sub_u32 s23, s23, s6
  s_cmp_gt_i32 s23, 0
  s_cselect_b32 s3, 3, 2
  s_lshl_b32 s23, s23, 2
  s_or_b32 s3, s3, s23
  v_mov_b32 v18, s3
  buffer_store_dword v18, off, s[68:71], 0 offset:128 sc1
  s_mov_b32 s4, 0
Wall_7:
  buffer_load_dword v18, off, s[68:71], 0 offset:0 sc1
  s_add_u32 s4, s4, 1
  s_cmp_gt_u32 s4, 65536
  s_cbranch_scc1 L_abort
  s_waitcnt vmcnt(0)
  v_readfirstlane_b32 s3, v18
  s_cmp_ge_u32 s3, 192
  s_cbranch_scc1 Wall_7_ok
  s_sleep 1
  s_branch Wall_7
Wall_7_ok:
  buffer_store_dword v18, off, s[68:71], 0 offset:132 sc1
  s_mov_b64 exec, -1
ST_mw:
  s_barrier
  s_branch L_sched
L_drain:
  s_waitcnt vmcnt(0) lgkmcnt(0)
  s_barrier
  s_cmp_lg_u32 s27, 0
  s_cbranch_scc1 SIG_8
  v_mov_b32 v18, s37
  s_mov_b64 exec, 1
  buffer_atomic_add v18, off, s[8:11], s35 sc1
  s_cmp_eq_u32 s36, 0
  s_cbranch_scc1 SIG_8_1
  buffer_atomic_add v18, off, s[8:11], s36 sc1
SIG_8_1:
  s_mov_b64 exec, -1
SIG_8:
  s_mov_b32 s35, 0
L_sched:
  s_waitcnt lgkmcnt(0)
  s_mov_b32 s30, s31
  s_add_u32 s38, s38, 4
  s_addc_u32 s39, s39, 0
  s_load_dword s31, s[38:39], 0
  s_and_b32 s3, s30, 7
  s_cmp_eq_u32 s3, 0
  s_cbranch_scc1 L_exit
  s_cmp_eq_u32 s3, 6
  s_cbranch_scc1 L_fin
  s_cmp_eq_u32 s3, 7
  s_cbranch_scc1 L_pf
  s_bitcmp1_b32 s30, 3
  s_cbranch_scc1 G4_cold
  s_bitcmp1_b32 s30, 6
  s_cbranch_scc1 G2_cold
  s_branch G8_cold
L_abort:
L_exit:
  s_endpgm
G8_cold:
  s_mul_i32 s41, s27, 4096
  s_lshl_b32 s42, s27, 12
  s_add_u32 s42, s42, 16384
  v_add_u32 v11, s41, v0
  s_mul_i32 s3, s28, 8192
  v_add_u32 v1, s3, v0
  s_bfe_u32 s4, s30, 262152
  s_bfe_u32 s5, s30, 393228
  s_bfe_u32 s20, s30, 0x50007
  s_lshl_b32 s20, s20, 12
  s_mov_b32 s18, s10
  s_mov_b32 s40, 32
  s_and_b32 s3, s30, 7
  s_cmp_eq_u32 s3, 2
  s_cbranch_scc1 SLG8c_v
  s_cmp_eq_u32 s3, 3
  s_cbranch_scc1 SLG8c_fu
  s_cmp_eq_u32 s3, 4
  s_cbranch_scc1 SLG8c_fd
  s_cmp_eq_u32 s3, 5
  s_cbranch_scc1 SLG8c_wo
  s_cmp_eq_u32 s28, 0
  s_cselect_b32 s12, s60, s62
  s_cselect_b32 s13, s61, s63
  s_mov_b32 s14, 8388608
  s_mov_b32 s22, 262144
  s_lshl_b32 s21, s5, 8
  v_mul_u32_u24 v18, 8192, v16
  v_xor_b32 v20, 0x80, v17
  v_add_u32 v12, v18, v17
  v_add_u32 v13, v18, v20
  v_add_u32 v13, 31744, v13
  v_add_u32 v14, 63488, v12
  v_add_u32 v15, 63488, v13
  s_branch SLG8c_done
SLG8c_v:
  s_mov_b32 s12, s64
  s_mov_b32 s13, s65
  s_mov_b32 s14, 8388608
  s_mov_b32 s22, 262144
  s_lshl_b32 s21, s5, 9
  s_lshl_b32 s3, s28, 8
  s_add_u32 s21, s21, s3
  v_mul_u32_u24 v18, 8192, v16
  v_xor_b32 v20, 0x80, v17
  v_add_u32 v12, v18, v17
  v_add_u32 v13, v18, v20
  v_add_u32 v13, 31744, v13
  v_add_u32 v14, 63488, v12
  v_add_u32 v15, 63488, v13
  s_branch SLG8c_done
SLG8c_fu:
  s_cmp_eq_u32 s28, 0
  s_cselect_b32 s12, s72, s74
  s_cselect_b32 s13, s73, s75
  s_mov_b32 s14, 7340032
  s_mov_b32 s22, 229376
  s_lshl_b32 s21, s5, 8
  v_mul_u32_u24 v18, 7168, v16
  v_xor_b32 v20, 0x80, v17
  v_add_u32 v12, v18, v17
  v_add_u32 v13, v18, v20
  v_add_u32 v13, 27648, v13
  v_add_u32 v14, 55296, v12
  v_add_u32 v15, 55296, v13
  s_branch SLG8c_done
SLG8c_fd:
  s_mov_b32 s12, s76
  s_mov_b32 s13, s77
  s_mov_b32 s14, 7340032
  s_mov_b32 s22, 65536
  s_lshl_b32 s21, s5, 9
  s_lshl_b32 s3, s28, 8
  s_add_u32 s21, s21, s3
  s_add_u32 s20, s20, 54525952
  s_mov_b32 s40, 112
  v_mul_u32_u24 v18, 2048, v16
  v_xor_b32 v20, 0x80, v17
  v_add_u32 v12, v18, v17
  v_add_u32 v13, v18, v20
  v_add_u32 v13, 7168, v13
  v_add_u32 v14, 14336, v12
  v_add_u32 v15, 14336, v13
  s_branch SLG8c_done
SLG8c_wo:
  s_mov_b32 s12, s66
  s_mov_b32 s13, s67
  s_mov_b32 s14, 8388608
  s_mov_b32 s22, 65536
  s_lshl_b32 s21, s5, 9
  s_lshl_b32 s3, s28, 8
  s_add_u32 s21, s21, s3
  s_bfe_u32 s3, s30, 262162
  s_lshl_b32 s4, s3, 19
  s_add_u32 s21, s21, s4
  s_lshl_b32 s4, s3, 20
  s_add_u32 s20, s20, s4
  s_add_u32 s20, s20, 69206016
  s_bfe_u32 s40, s30, 262166
  s_add_u32 s40, s40, 1
  s_lshl_b32 s40, s40, 3
  v_mul_u32_u24 v18, 2048, v16
  v_xor_b32 v20, 0x80, v17
  v_add_u32 v12, v18, v17
  v_add_u32 v13, v18, v20
  v_add_u32 v13, 7168, v13
  v_add_u32 v14, 14336, v12
  v_add_u32 v15, 14336, v13
SLG8c_done:
  s_mov_b32 s24, 0
  s_mov_b32 s25, 0
  s_add_u32 m0, s24, s42
  s_nop 0
  buffer_load_dwordx4 v12, s[12:15], s21 offen offset:0 lds
  buffer_load_dwordx4 v13, s[12:15], s21 offen offset:1024 lds
  buffer_load_dwordx4 v14, s[12:15], s21 offen offset:2048 lds
  buffer_load_dwordx4 v15, s[12:15], s21 offen offset:3072 lds
  s_add_u32 s21, s21, s22
  s_add_u32 s24, s24, 32768
  s_and_b32 s24, s24, 131071
  s_add_u32 m0, s24, s42
  s_nop 0
  buffer_load_dwordx4 v12, s[12:15], s21 offen offset:0 lds
  buffer_load_dwordx4 v13, s[12:15], s21 offen offset:1024 lds
  buffer_load_dwordx4 v14, s[12:15], s21 offen offset:2048 lds
  buffer_load_dwordx4 v15, s[12:15], s21 offen offset:3072 lds
  s_add_u32 s21, s21, s22
  s_add_u32 s24, s24, 32768
  s_and_b32 s24, s24, 131071
  s_add_u32 m0, s24, s42
  s_nop 0
  buffer_load_dwordx4 v12, s[12:15], s21 offen offset:0 lds
  buffer_load_dwordx4 v13, s[12:15], s21 offen offset:1024 lds
  buffer_load_dwordx4 v14, s[12:15], s21 offen offset:2048 lds
  buffer_load_dwordx4 v15, s[12:15], s21 offen offset:3072 lds
  s_add_u32 s21, s21, s22
  s_add_u32 s24, s24, 32768
  s_and_b32 s24, s24, 131071
  s_cmp_lg_u32 s87, 0
  s_cbranch_scc1 DW_9_x
  s_and_b32 s3, s30, 0xf07
  s_cmp_gt_u32 s3, 2
  s_cbranch_scc1 DW_9_all
  s_and_b32 s3, s30, 0x48
  s_cbranch_scc0 DW_9_all
  s_cmp_lg_u32 s27, 0
  s_cbranch_scc1 Wx0_10_ok
  s_mov_b32 s4, 0
Wx0_10:
  buffer_load_dword v18, off, s[68:71], 0 offset:140 sc1
  s_add_u32 s4, s4, 1
  s_cmp_gt_u32 s4, 65536
  s_cbranch_scc1 L_abort
  s_waitcnt vmcnt(0)
  v_readfirstlane_b32 s3, v18
  s_cmp_ge_u32 s3, 9
  s_cbranch_scc1 Wx0_10_ok
  s_sleep 2
  s_branch Wx0_10
Wx0_10_ok:
  s_barrier
  s_branch DW_9
DW_9_all:
  s_cmp_lg_u32 s27, 0
  s_cbranch_scc1 Wxn_11_ok
  s_mov_b32 s4, 0
Wxn_11:
  buffer_load_dword v18, off, s[68:71], 0 offset:132 sc1
  s_add_u32 s4, s4, 1
  s_cmp_gt_u32 s4, 65536
  s_cbranch_scc1 L_abort
  s_waitcnt vmcnt(0)
  v_readfirstlane_b32 s3, v18
  s_cmp_ge_u32 s3, 1
  s_cbranch_scc1 Wxn_11_ok
  s_sleep 2
  s_branch Wxn_11
Wxn_11_ok:
  s_barrier
  s_mov_b32 s87, 1
DW_9_x:
  s_and_b32 s3, s30, 7
  s_cmp_lt_u32 s3, 4
  s_cbranch_scc1 DW_9
  s_bfe_u32 s7, s30, 262152
  s_cmp_eq_u32 s3, 4
  s_cbranch_scc0 DW_9_o
  s_lshl_b32 s7, s7, 7
  s_add_u32 s7, s7, 99616768
  s_cmp_lg_u32 s27, 0
  s_cbranch_scc1 Wdep_12_ok
  s_mov_b32 s4, 0
Wdep_12:
  buffer_load_dword v18, off, s[8:11], s7 offset:0 sc1
  s_add_u32 s4, s4, 1
  s_cmp_gt_u32 s4, 65536
  s_cbranch_scc1 L_abort
  s_waitcnt vmcnt(0)
  v_readfirstlane_b32 s3, v18
  s_cmp_ge_u32 s3, 28
  s_cbranch_scc1 Wdep_12_ok
  s_sleep 8
  s_branch Wdep_12
Wdep_12_ok:
  s_barrier
  s_branch DW_9
DW_9_o:
  s_cmp_lg_u32 s27, 0
  s_cbranch_scc1 DW_9_b
  s_bfe_u32 s5, s30, 262162
  s_lshl_b32 s5, s5, 8
  s_add_u32 s5, s5, 99618816
  s_lshr_b32 s3, s40, 2
  s_bfm_b64 exec, s3, 0
  v_lshlrev_b32 v19, 3, v0
  s_mov_b32 s4, 0
DW_9_p:
  buffer_load_dword v18, v19, s[8:11], s5 offen sc1
  s_add_u32 s4, s4, 1
  s_cmp_gt_u32 s4, 65536
  s_cbranch_scc1 L_abort
  s_waitcnt vmcnt(0)
  v_cmp_ge_u32 vcc, s7, v18
  s_cbranch_vccz DW_9_q
  v_cmp_gt_u32 vcc, s7, v18
  s_cbranch_vccz DW_9_r
  s_sleep 127
DW_9_r:
  s_sleep 3
  s_branch DW_9_p
DW_9_q:
  s_mov_b64 exec, -1
DW_9_b:
  s_barrier
DW_9:
  s_add_u32 m0, s41, 0
  s_nop 0
  buffer_load_dwordx4 v11, s[16:19], s20 offen offset:0 sc1 lds
  buffer_load_dwordx4 v11, s[16:19], s20 offen offset:1024 sc1 lds
  buffer_load_dwordx4 v11, s[16:19], s20 offen offset:2048 sc1 lds
  buffer_load_dwordx4 v11, s[16:19], s20 offen offset:3072 sc1 lds
  s_add_u32 s20, s20, 131072
  s_add_u32 m0, s41, 32768
  s_nop 0
  buffer_load_dwordx4 v11, s[16:19], s20 offen offset:0 sc1 lds
  buffer_load_dwordx4 v11, s[16:19], s20 offen offset:1024 sc1 lds
  buffer_load_dwordx4 v11, s[16:19], s20 offen offset:2048 sc1 lds
  buffer_load_dwordx4 v11, s[16:19], s20 offen offset:3072 sc1 lds
  s_add_u32 s20, s20, 131072
  s_add_u32 m0, s41, 65536
  s_nop 0
  buffer_load_dwordx4 v11, s[16:19], s20 offen offset:0 sc1 lds
  buffer_load_dwordx4 v11, s[16:19], s20 offen offset:1024 sc1 lds
  buffer_load_dwordx4 v11, s[16:19], s20 offen offset:2048 sc1 lds
  buffer_load_dwordx4 v11, s[16:19], s20 offen offset:3072 sc1 lds
  s_add_u32 s20, s20, 131072
  s_add_u32 m0, s41, 98304
  s_nop 0
  buffer_load_dwordx4 v11, s[16:19], s20 offen offset:0 sc1 lds
  buffer_load_dwordx4 v11, s[16:19], s20 offen offset:1024 sc1 lds
  buffer_load_dwordx4 v11, s[16:19], s20 offen offset:2048 sc1 lds
  buffer_load_dwordx4 v11, s[16:19], s20 offen offset:3072 sc1 lds
  s_add_u32 s20, s20, 131072
  v_mov_b32 v6, v1
  v_mov_b32 v7, v2
  v_mov_b32 v8, v3
  v_mov_b32 v9, v4
  v_mov_b32 v10, v5
  s_waitcnt vmcnt(4)
  s_barrier
  ds_read_b64_tr_b16 a[32:33], v7 offset:16384
  ds_read_b64_tr_b16 a[34:35], v7 offset:20480
  ds_read_b64_tr_b16 a[36:37], v8 offset:16384
  ds_read_b64_tr_b16 a[38:39], v8 offset:20480
  ds_read_b64_tr_b16 a[40:41], v9 offset:16384
  ds_read_b64_tr_b16 a[42:43], v9 offset:20480
  ds_read_b64_tr_b16 a[44:45], v10 offset:16384
  ds_read_b64_tr_b16 a[46:47], v10 offset:20480
  ds_read_b128 a[64:67], v6 offset:0
  ds_read_b128 a[68:71], v6 offset:1024
  ds_read_b128 a[72:75], v6 offset:2048
  ds_read_b128 a[76:79], v6 offset:3072
  ds_read_b128 a[80:83], v6 offset:4096
  ds_read_b128 a[84:87], v6 offset:5120
  ds_read_b128 a[88:91], v6 offset:6144
  ds_read_b128 a[92:95], v6 offset:7168
G8_task:
  s_sub_u32 s32, s40, 5
  s_sub_u32 s33, s40, 1
  s_cmp_lg_u32 s35, 0
  s_cselect_b32 s43, 3, s32
  s_waitcnt lgkmcnt(0)
  v_mfma_f32_16x16x32_bf16 v[32:35], a[32:35], a[64:67], 0
  ds_read_b64_tr_b16 a[48:49], v7 offset:24576
  v_mfma_f32_16x16x32_bf16 v[36:39], a[32:35], a[68:71], 0
  ds_read_b64_tr_b16 a[50:51], v7 offset:28672
  v_mfma_f32_16x16x32_bf16 v[40:43], a[32:35], a[72:75], 0
  ds_read_b64_tr_b16 a[52:53], v8 offset:24576
  v_mfma_f32_16x16x32_bf16 v[44:47], a[32:35], a[76:79], 0
  ds_read_b64_tr_b16 a[54:55], v8 offset:28672
  v_mfma_f32_16x16x32_bf16 v[48:51], a[32:35], a[80:83], 0
  ds_read_b64_tr_b16 a[56:57], v9 offset:24576
  v_mfma_f32_16x16x32_bf16 v[52:55], a[32:35], a[84:87], 0
  ds_read_b64_tr_b16 a[58:59], v9 offset:28672
  v_mfma_f32_16x16x32_bf16 v[56:59], a[32:35], a[88:91], 0
  ds_read_b64_tr_b16 a[60:61], v10 offset:24576
  v_mfma_f32_16x16x32_bf16 v[60:63], a[32:35], a[92:95], 0
  ds_read_b64_tr_b16 a[62:63], v10 offset:28672
  v_mfma_f32_16x16x32_bf16 v[64:67], a[36:39], a[64:67], 0
  s_add_u32 s25, s25, 32768
  s_and_b32 s25, s25, 131071
  v_mfma_f32_16x16x32_bf16 v[68:71], a[36:39], a[68:71], 0
  v_add_u32 v6, s25, v1
  v_mfma_f32_16x16x32_bf16 v[72:75], a[36:39], a[72:75], 0
  v_add_u32 v7, s25, v2
  v_mfma_f32_16x16x32_bf16 v[76:79], a[36:39], a[76:79], 0
  v_add_u32 v8, s25, v3
  v_mfma_f32_16x16x32_bf16 v[80:83], a[36:39], a[80:83], 0
  v_add_u32 v9, s25, v4
  v_mfma_f32_16x16x32_bf16 v[84:87], a[36:39], a[84:87], 0
  v_add_u32 v10, s25, v5
  v_mfma_f32_16x16x32_bf16 v[88:91], a[36:39], a[88:91], 0
  v_mfma_f32_16x16x32_bf16 v[92:95], a[36:39], a[92:95], 0
  v_mfma_f32_16x16x32_bf16 v[96:99], a[40:43], a[64:67], 0
  v_mfma_f32_16x16x32_bf16 v[100:103], a[40:43], a[68:71], 0
  s_add_u32 m0, s24, s42
  v_mfma_f32_16x16x32_bf16 v[104:107], a[40:43], a[72:75], 0
  buffer_load_dwordx4 v12, s[12:15], s21 offen offset:0 lds
  v_mfma_f32_16x16x32_bf16 v[108:111], a[40:43], a[76:79], 0
  v_mfma_f32_16x16x32_bf16 v[112:115], a[40:43], a[80:83], 0
  v_mfma_f32_16x16x32_bf16 v[116:119], a[40:43], a[84:87], 0
  v_mfma_f32_16x16x32_bf16 v[120:123], a[40:43], a[88:91], 0
  buffer_load_dwordx4 v13, s[12:15], s21 offen offset:1024 lds
  v_mfma_f32_16x16x32_bf16 v[124:127], a[40:43], a[92:95], 0
  v_mfma_f32_16x16x32_bf16 v[128:131], a[44:47], a[64:67], 0
  v_mfma_f32_16x16x32_bf16 v[132:135], a[44:47], a[68:71], 0
  v_mfma_f32_16x16x32_bf16 v[136:139], a[44:47], a[72:75], 0
  buffer_load_dwordx4 v14, s[12:15], s21 offen offset:2048 lds
  v_mfma_f32_16x16x32_bf16 v[140:143], a[44:47], a[76:79], 0
  v_mfma_f32_16x16x32_bf16 v[144:147], a[44:47], a[80:83], 0
  v_mfma_f32_16x16x32_bf16 v[148:151], a[44:47], a[84:87], 0
  v_mfma_f32_16x16x32_bf16 v[152:155], a[44:47], a[88:91], 0
  buffer_load_dwordx4 v15, s[12:15], s21 offen offset:3072 lds
  v_mfma_f32_16x16x32_bf16 v[156:159], a[44:47], a[92:95], 0
  s_add_u32 s21, s21, s22
  s_add_u32 s24, s24, 32768
  s_and_b32 s24, s24, 131071
  s_waitcnt lgkmcnt(0) vmcnt(16)
  s_barrier
  v_mfma_f32_16x16x32_bf16 v[160:163], a[48:51], a[64:67], 0
  ds_read_b64_tr_b16 a[32:33], v7 offset:16384
  v_mfma_f32_16x16x32_bf16 v[164:167], a[48:51], a[68:71], 0
  ds_read_b64_tr_b16 a[34:35], v7 offset:20480
  v_mfma_f32_16x16x32_bf16 v[168:171], a[48:51], a[72:75], 0
  ds_read_b128 a[96:99], v6 offset:0
  v_mfma_f32_16x16x32_bf16 v[172:175], a[48:51], a[76:79], 0
  ds_read_b128 a[100:103], v6 offset:1024
  v_mfma_f32_16x16x32_bf16 v[176:179], a[48:51], a[80:83], 0
  ds_read_b128 a[104:107], v6 offset:2048
  v_mfma_f32_16x16x32_bf16 v[180:183], a[48:51], a[84:87], 0
  ds_read_b128 a[108:111], v6 offset:3072
  v_mfma_f32_16x16x32_bf16 v[184:187], a[48:51], a[88:91], 0
  ds_read_b128 a[112:115], v6 offset:4096
  v_mfma_f32_16x16x32_bf16 v[188:191], a[48:51], a[92:95], 0
  ds_read_b128 a[116:119], v6 offset:5120
  v_mfma_f32_16x16x32_bf16 v[192:195], a[52:55], a[64:67], 0
  ds_read_b128 a[120:123], v6 offset:6144
  v_mfma_f32_16x16x32_bf16 v[196:199], a[52:55], a[68:71], 0
  ds_read_b128 a[124:127], v6 offset:7168
  v_mfma_f32_16x16x32_bf16 v[200:203], a[52:55], a[72:75], 0
  ds_read_b64_tr_b16 a[36:37], v8 offset:16384
  v_mfma_f32_16x16x32_bf16 v[204:207], a[52:55], a[76:79], 0
  ds_read_b64_tr_b16 a[38:39], v8 offset:20480
  v_mfma_f32_16x16x32_bf16 v[208:211], a[52:55], a[80:83], 0
  ds_read_b64_tr_b16 a[40:41], v9 offset:16384
  v_mfma_f32_16x16x32_bf16 v[212:215], a[52:55], a[84:87], 0
  ds_read_b64_tr_b16 a[42:43], v9 offset:20480
  v_mfma_f32_16x16x32_bf16 v[216:219], a[52:55], a[88:91], 0
  ds_read_b64_tr_b16 a[44:45], v10 offset:16384
  v_mfma_f32_16x16x32_bf16 v[220:223], a[52:55], a[92:95], 0
  ds_read_b64_tr_b16 a[46:47], v10 offset:20480
  v_mfma_f32_16x16x32_bf16 v[224:227], a[56:59], a[64:67], 0
  v_mfma_f32_16x16x32_bf16 v[228:231], a[56:59], a[68:71], 0
  s_add_u32 m0, s24, s41
  v_mfma_f32_16x16x32_bf16 v[232:235], a[56:59], a[72:75], 0
  buffer_load_dwordx4 v11, s[16:19], s20 offen offset:0 sc1 lds
  v_mfma_f32_16x16x32_bf16 v[236:239], a[56:59], a[76:79], 0
  v_mfma_f32_16x16x32_bf16 v[240:243], a[56:59], a[80:83], 0
  v_mfma_f32_16x16x32_bf16 v[244:247], a[56:59], a[84:87], 0
  v_mfma_f32_16x16x32_bf16 v[248:251], a[56:59], a[88:91], 0
  buffer_load_dwordx4 v11, s[16:19], s20 offen offset:1024 sc1 lds
  v_mfma_f32_16x16x32_bf16 v[252:255], a[56:59], a[92:95], 0
  v_mfma_f32_16x16x32_bf16 a[0:3], a[60:63], a[64:67], 0
  v_mfma_f32_16x16x32_bf16 a[4:7], a[60:63], a[68:71], 0
  v_mfma_f32_16x16x32_bf16 a[8:11], a[60:63], a[72:75], 0
  buffer_load_dwordx4 v11, s[16:19], s20 offen offset:2048 sc1 lds
  v_mfma_f32_16x16x32_bf16 a[12:15], a[60:63], a[76:79], 0
  v_mfma_f32_16x16x32_bf16 a[16:19], a[60:63], a[80:83], 0
  v_mfma_f32_16x16x32_bf16 a[20:23], a[60:63], a[84:87], 0
  v_mfma_f32_16x16x32_bf16 a[24:27], a[60:63], a[88:91], 0
  buffer_load_dwordx4 v11, s[16:19], s20 offen offset:3072 sc1 lds
  v_mfma_f32_16x16x32_bf16 a[28:31], a[60:63], a[92:95], 0
  s_add_u32 s20, s20, 131072
  s_waitcnt lgkmcnt(0)
  v_mfma_f32_16x16x32_bf16 v[32:35], a[32:35], a[96:99], v[32:35]
  ds_read_b64_tr_b16 a[48:49], v7 offset:24576
  v_mfma_f32_16x16x32_bf16 v[36:39], a[32:35], a[100:103], v[36:39]
  ds_read_b64_tr_b16 a[50:51], v7 offset:28672
  v_mfma_f32_16x16x32_bf16 v[40:43], a[32:35], a[104:107], v[40:43]
  ds_read_b64_tr_b16 a[52:53], v8 offset:24576
  v_mfma_f32_16x16x32_bf16 v[44:47], a[32:35], a[108:111], v[44:47]
  ds_read_b64_tr_b16 a[54:55], v8 offset:28672
  v_mfma_f32_16x16x32_bf16 v[48:51], a[32:35], a[112:115], v[48:51]
  ds_read_b64_tr_b16 a[56:57], v9 offset:24576
  v_mfma_f32_16x16x32_bf16 v[52:55], a[32:35], a[116:119], v[52:55]
  ds_read_b64_tr_b16 a[58:59], v9 offset:28672
  v_mfma_f32_16x16x32_bf16 v[56:59], a[32:35], a[120:123], v[56:59]
  ds_read_b64_tr_b16 a[60:61], v10 offset:24576
  v_mfma_f32_16x16x32_bf16 v[60:63], a[32:35], a[124:127], v[60:63]
  ds_read_b64_tr_b16 a[62:63], v10 offset:28672
  v_mfma_f32_16x16x32_bf16 v[64:67], a[36:39], a[96:99], v[64:67]
  s_add_u32 s25, s25, 32768
  s_and_b32 s25, s25, 131071
  v_mfma_f32_16x16x32_bf16 v[68:71], a[36:39], a[100:103], v[68:71]
  v_add_u32 v6, s25, v1
  v_mfma_f32_16x16x32_bf16 v[72:75], a[36:39], a[104:107], v[72:75]
  v_add_u32 v7, s25, v2
  v_mfma_f32_16x16x32_bf16 v[76:79], a[36:39], a[108:111], v[76:79]
  v_add_u32 v8, s25, v3
  v_mfma_f32_16x16x32_bf16 v[80:83], a[36:39], a[112:115], v[80:83]
  v_add_u32 v9, s25, v4
  v_mfma_f32_16x16x32_bf16 v[84:87], a[36:39], a[116:119], v[84:87]
  v_add_u32 v10, s25, v5
  v_mfma_f32_16x16x32_bf16 v[88:91], a[36:39], a[120:123], v[88:91]
  v_mfma_f32_16x16x32_bf16 v[92:95], a[36:39], a[124:127], v[92:95]
  v_mfma_f32_16x16x32_bf16 v[96:99], a[40:43], a[96:99], v[96:99]
  v_mfma_f32_16x16x32_bf16 v[100:103], a[40:43], a[100:103], v[100:103]
  s_add_u32 m0, s24, s42
  v_mfma_f32_16x16x32_bf16 v[104:107], a[40:43], a[104:107], v[104:107]
  buffer_load_dwordx4 v12, s[12:15], s21 offen offset:0 lds
  v_mfma_f32_16x16x32_bf16 v[108:111], a[40:43], a[108:111], v[108:111]
  v_mfma_f32_16x16x32_bf16 v[112:115], a[40:43], a[112:115], v[112:115]
  v_mfma_f32_16x16x32_bf16 v[116:119], a[40:43], a[116:119], v[116:119]
  v_mfma_f32_16x16x32_bf16 v[120:123], a[40:43], a[120:123], v[120:123]
  buffer_load_dwordx4 v13, s[12:15], s21 offen offset:1024 lds
  v_mfma_f32_16x16x32_bf16 v[124:127], a[40:43], a[124:127], v[124:127]
  v_mfma_f32_16x16x32_bf16 v[128:131], a[44:47], a[96:99], v[128:131]
  v_mfma_f32_16x16x32_bf16 v[132:135], a[44:47], a[100:103], v[132:135]
  v_mfma_f32_16x16x32_bf16 v[136:139], a[44:47], a[104:107], v[136:139]
  buffer_load_dwordx4 v14, s[12:15], s21 offen offset:2048 lds
  v_mfma_f32_16x16x32_bf16 v[140:143], a[44:47], a[108:111], v[140:143]
  v_mfma_f32_16x16x32_bf16 v[144:147], a[44:47], a[112:115], v[144:147]
  v_mfma_f32_16x16x32_bf16 v[148:151], a[44:47], a[116:119], v[148:151]
  v_mfma_f32_16x16x32_bf16 v[152:155], a[44:47], a[120:123], v[152:155]
  buffer_load_dwordx4 v15, s[12:15], s21 offen offset:3072 lds
  v_mfma_f32_16x16x32_bf16 v[156:159], a[44:47], a[124:127], v[156:159]
  s_add_u32 s21, s21, s22
  s_add_u32 s24, s24, 32768
  s_and_b32 s24, s24, 131071
  s_mov_b32 s26, 1
.p2align 6
G8_loop:
  s_waitcnt lgkmcnt(0) vmcnt(16)
  s_barrier
  v_mfma_f32_16x16x32_bf16 v[160:163], a[48:51], a[96:99], v[160:163]
  ds_read_b64_tr_b16 a[32:33], v7 offset:16384
  v_mfma_f32_16x16x32_bf16 v[164:167], a[48:51], a[100:103], v[164:167]
  ds_read_b64_tr_b16 a[34:35], v7 offset:20480
  v_mfma_f32_16x16x32_bf16 v[168:171], a[48:51], a[104:107], v[168:171]
  ds_read_b128 a[64:67], v6 offset:0
  v_mfma_f32_16x16x32_bf16 v[172:175], a[48:51], a[108:111], v[172:175]
  ds_read_b128 a[68:71], v6 offset:1024
  v_mfma_f32_16x16x32_bf16 v[176:179], a[48:51], a[112:115], v[176:179]
  ds_read_b128 a[72:75], v6 offset:2048
  v_mfma_f32_16x16x32_bf16 v[180:183], a[48:51], a[116:119], v[180:183]
  ds_read_b128 a[76:79], v6 offset:3072
  v_mfma_f32_16x16x32_bf16 v[184:187], a[48:51], a[120:123], v[184:187]
  ds_read_b128 a[80:83], v6 offset:4096
  v_mfma_f32_16x16x32_bf16 v[188:191], a[48:51], a[124:127], v[188:191]
  ds_read_b128 a[84:87], v6 offset:5120
  v_mfma_f32_16x16x32_bf16 v[192:195], a[52:55], a[96:99], v[192:195]
  ds_read_b128 a[88:91], v6 offset:6144
  v_mfma_f32_16x16x32_bf16 v[196:199], a[52:55], a[100:103], v[196:199]
  ds_read_b128 a[92:95], v6 offset:7168
  v_mfma_f32_16x16x32_bf16 v[200:203], a[52:55], a[104:107], v[200:203]
  ds_read_b64_tr_b16 a[36:37], v8 offset:16384
  v_mfma_f32_16x16x32_bf16 v[204:207], a[52:55], a[108:111], v[204:207]
  ds_read_b64_tr_b16 a[38:39], v8 offset:20480
  v_mfma_f32_16x16x32_bf16 v[208:211], a[52:55], a[112:115], v[208:211]
  ds_read_b64_tr_b16 a[40:41], v9 offset:16384
  v_mfma_f32_16x16x32_bf16 v[212:215], a[52:55], a[116:119], v[212:215]
  ds_read_b64_tr_b16 a[42:43], v9 offset:20480
  v_mfma_f32_16x16x32_bf16 v[216:219], a[52:55], a[120:123], v[216:219]
  ds_read_b64_tr_b16 a[44:45], v10 offset:16384
  v_mfma_f32_16x16x32_bf16 v[220:223], a[52:55], a[124:127], v[220:223]
  ds_read_b64_tr_b16 a[46:47], v10 offset:20480
  v_mfma_f32_16x16x32_bf16 v[224:227], a[56:59], a[96:99], v[224:227]
  v_mfma_f32_16x16x32_bf16 v[228:231], a[56:59], a[100:103], v[228:231]
  s_add_u32 m0, s24, s41
  v_mfma_f32_16x16x32_bf16 v[232:235], a[56:59], a[104:107], v[232:235]
  buffer_load_dwordx4 v11, s[16:19], s20 offen offset:0 sc1 lds
  v_mfma_f32_16x16x32_bf16 v[236:239], a[56:59], a[108:111], v[236:239]
  v_mfma_f32_16x16x32_bf16 v[240:243], a[56:59], a[112:115], v[240:243]
  v_mfma_f32_16x16x32_bf16 v[244:247], a[56:59], a[116:119], v[244:247]
  v_mfma_f32_16x16x32_bf16 v[248:251], a[56:59], a[120:123], v[248:251]
  buffer_load_dwordx4 v11, s[16:19], s20 offen offset:1024 sc1 lds
  v_mfma_f32_16x16x32_bf16 v[252:255], a[56:59], a[124:127], v[252:255]
  v_mfma_f32_16x16x32_bf16 a[0:3], a[60:63], a[96:99], a[0:3]
  v_mfma_f32_16x16x32_bf16 a[4:7], a[60:63], a[100:103], a[4:7]
  v_mfma_f32_16x16x32_bf16 a[8:11], a[60:63], a[104:107], a[8:11]
  buffer_load_dwordx4 v11, s[16:19], s20 offen offset:2048 sc1 lds
  v_mfma_f32_16x16x32_bf16 a[12:15], a[60:63], a[108:111], a[12:15]
  v_mfma_f32_16x16x32_bf16 a[16:19], a[60:63], a[112:115], a[16:19]
  v_mfma_f32_16x16x32_bf16 a[20:23], a[60:63], a[116:119], a[20:23]
  v_mfma_f32_16x16x32_bf16 a[24:27], a[60:63], a[120:123], a[24:27]
  buffer_load_dwordx4 v11, s[16:19], s20 offen offset:3072 sc1 lds
  v_mfma_f32_16x16x32_bf16 a[28:31], a[60:63], a[124:127], a[28:31]
  s_add_u32 s20, s20, 131072
  s_cmp_eq_u32 s26, s33
  s_cbranch_scc1 G8_epi
  s_waitcnt lgkmcnt(0)
  v_mfma_f32_16x16x32_bf16 v[32:35], a[32:35], a[64:67], v[32:35]
  ds_read_b64_tr_b16 a[48:49], v7 offset:24576
  v_mfma_f32_16x16x32_bf16 v[36:39], a[32:35], a[68:71], v[36:39]
  ds_read_b64_tr_b16 a[50:51], v7 offset:28672
  v_mfma_f32_16x16x32_bf16 v[40:43], a[32:35], a[72:75], v[40:43]
  ds_read_b64_tr_b16 a[52:53], v8 offset:24576
  v_mfma_f32_16x16x32_bf16 v[44:47], a[32:35], a[76:79], v[44:47]
  ds_read_b64_tr_b16 a[54:55], v8 offset:28672
  v_mfma_f32_16x16x32_bf16 v[48:51], a[32:35], a[80:83], v[48:51]
  ds_read_b64_tr_b16 a[56:57], v9 offset:24576
  v_mfma_f32_16x16x32_bf16 v[52:55], a[32:35], a[84:87], v[52:55]
  ds_read_b64_tr_b16 a[58:59], v9 offset:28672
  v_mfma_f32_16x16x32_bf16 v[56:59], a[32:35], a[88:91], v[56:59]
  ds_read_b64_tr_b16 a[60:61], v10 offset:24576
  v_mfma_f32_16x16x32_bf16 v[60:63], a[32:35], a[92:95], v[60:63]
  ds_read_b64_tr_b16 a[62:63], v10 offset:28672
  v_mfma_f32_16x16x32_bf16 v[64:67], a[36:39], a[64:67], v[64:67]
  s_add_u32 s25, s25, 32768
  s_and_b32 s25, s25, 131071
  v_mfma_f32_16x16x32_bf16 v[68:71], a[36:39], a[68:71], v[68:71]
  v_add_u32 v6, s25, v1
  v_mfma_f32_16x16x32_bf16 v[72:75], a[36:39], a[72:75], v[72:75]
  v_add_u32 v7, s25, v2
  v_mfma_f32_16x16x32_bf16 v[76:79], a[36:39], a[76:79], v[76:79]
  v_add_u32 v8, s25, v3
  v_mfma_f32_16x16x32_bf16 v[80:83], a[36:39], a[80:83], v[80:83]
  v_add_u32 v9, s25, v4
  v_mfma_f32_16x16x32_bf16 v[84:87], a[36:39], a[84:87], v[84:87]
  v_add_u32 v10, s25, v5
  v_mfma_f32_16x16x32_bf16 v[88:91], a[36:39], a[88:91], v[88:91]
  v_mfma_f32_16x16x32_bf16 v[92:95], a[36:39], a[92:95], v[92:95]
  v_mfma_f32_16x16x32_bf16 v[96:99], a[40:43], a[64:67], v[96:99]
  v_mfma_f32_16x16x32_bf16 v[100:103], a[40:43], a[68:71], v[100:103]
  s_add_u32 m0, s24, s42
  v_mfma_f32_16x16x32_bf16 v[104:107], a[40:43], a[72:75], v[104:107]
  buffer_load_dwordx4 v12, s[12:15], s21 offen offset:0 lds
  v_mfma_f32_16x16x32_bf16 v[108:111], a[40:43], a[76:79], v[108:111]
  v_mfma_f32_16x16x32_bf16 v[112:115], a[40:43], a[80:83], v[112:115]
  v_mfma_f32_16x16x32_bf16 v[116:119], a[40:43], a[84:87], v[116:119]
  v_mfma_f32_16x16x32_bf16 v[120:123], a[40:43], a[88:91], v[120:123]
  buffer_load_dwordx4 v13, s[12:15], s21 offen offset:1024 lds
  v_mfma_f32_16x16x32_bf16 v[124:127], a[40:43], a[92:95], v[124:127]
  v_mfma_f32_16x16x32_bf16 v[128:131], a[44:47], a[64:67], v[128:131]
  v_mfma_f32_16x16x32_bf16 v[132:135], a[44:47], a[68:71], v[132:135]
  v_mfma_f32_16x16x32_bf16 v[136:139], a[44:47], a[72:75], v[136:139]
  buffer_load_dwordx4 v14, s[12:15], s21 offen offset:2048 lds
  v_mfma_f32_16x16x32_bf16 v[140:143], a[44:47], a[76:79], v[140:143]
  v_mfma_f32_16x16x32_bf16 v[144:147], a[44:47], a[80:83], v[144:147]
  v_mfma_f32_16x16x32_bf16 v[148:151], a[44:47], a[84:87], v[148:151]
  v_mfma_f32_16x16x32_bf16 v[152:155], a[44:47], a[88:91], v[152:155]
  buffer_load_dwordx4 v15, s[12:15], s21 offen offset:3072 lds
  v_mfma_f32_16x16x32_bf16 v[156:159], a[44:47], a[92:95], v[156:159]
  s_add_u32 s21, s21, s22
  s_add_u32 s24, s24, 32768
  s_and_b32 s24, s24, 131071
  s_cmp_eq_u32 s26, s43
  s_cbranch_scc1 G8_event
G8_back:
  s_waitcnt lgkmcnt(0) vmcnt(16)
  s_barrier
  v_mfma_f32_16x16x32_bf16 v[160:163], a[48:51], a[64:67], v[160:163]
  ds_read_b64_tr_b16 a[32:33], v7 offset:16384
  v_mfma_f32_16x16x32_bf16 v[164:167], a[48:51], a[68:71], v[164:167]
  ds_read_b64_tr_b16 a[34:35], v7 offset:20480
  v_mfma_f32_16x16x32_bf16 v[168:171], a[48:51], a[72:75], v[168:171]
  ds_read_b128 a[96:99], v6 offset:0
  v_mfma_f32_16x16x32_bf16 v[172:175], a[48:51], a[76:79], v[172:175]
  ds_read_b128 a[100:103], v6 offset:1024
  v_mfma_f32_16x16x32_bf16 v[176:179], a[48:51], a[80:83], v[176:179]
  ds_read_b128 a[104:107], v6 offset:2048
  v_mfma_f32_16x16x32_bf16 v[180:183], a[48:51], a[84:87], v[180:183]
  ds_read_b128 a[108:111], v6 offset:3072
  v_mfma_f32_16x16x32_bf16 v[184:187], a[48:51], a[88:91], v[184:187]
  ds_read_b128 a[112:115], v6 offset:4096
  v_mfma_f32_16x16x32_bf16 v[188:191], a[48:51], a[92:95], v[188:191]
  ds_read_b128 a[116:119], v6 offset:5120
  v_mfma_f32_16x16x32_bf16 v[192:195], a[52:55], a[64:67], v[192:195]
  ds_read_b128 a[120:123], v6 offset:6144
  v_mfma_f32_16x16x32_bf16 v[196:199], a[52:55], a[68:71], v[196:199]
  ds_read_b128 a[124:127], v6 offset:7168
  v_mfma_f32_16x16x32_bf16 v[200:203], a[52:55], a[72:75], v[200:203]
  ds_read_b64_tr_b16 a[36:37], v8 offset:16384
  v_mfma_f32_16x16x32_bf16 v[204:207], a[52:55], a[76:79], v[204:207]
  ds_read_b64_tr_b16 a[38:39], v8 offset:20480
  v_mfma_f32_16x16x32_bf16 v[208:211], a[52:55], a[80:83], v[208:211]
  ds_read_b64_tr_b16 a[40:41], v9 offset:16384
  v_mfma_f32_16x16x32_bf16 v[212:215], a[52:55], a[84:87], v[212:215]
  ds_read_b64_tr_b16 a[42:43], v9 offset:20480
  v_mfma_f32_16x16x32_bf16 v[216:219], a[52:55], a[88:91], v[216:219]
  ds_read_b64_tr_b16 a[44:45], v10 offset:16384
  v_mfma_f32_16x16x32_bf16 v[220:223], a[52:55], a[92:95], v[220:223]
  ds_read_b64_tr_b16 a[46:47], v10 offset:20480
  v_mfma_f32_16x16x32_bf16 v[224:227], a[56:59], a[64:67], v[224:227]
  v_mfma_f32_16x16x32_bf16 v[228:231], a[56:59], a[68:71], v[228:231]
  s_add_u32 m0, s24, s41
  v_mfma_f32_16x16x32_bf16 v[232:235], a[56:59], a[72:75], v[232:235]
  buffer_load_dwordx4 v11, s[16:19], s20 offen offset:0 sc1 lds
  v_mfma_f32_16x16x32_bf16 v[236:239], a[56:59], a[76:79], v[236:239]
  v_mfma_f32_16x16x32_bf16 v[240:243], a[56:59], a[80:83], v[240:243]
  v_mfma_f32_16x16x32_bf16 v[244:247], a[56:59], a[84:87], v[244:247]
  v_mfma_f32_16x16x32_bf16 v[248:251], a[56:59], a[88:91], v[248:251]
  buffer_load_dwordx4 v11, s[16:19], s20 offen offset:1024 sc1 lds
  v_mfma_f32_16x16x32_bf16 v[252:255], a[56:59], a[92:95], v[252:255]
  v_mfma_f32_16x16x32_bf16 a[0:3], a[60:63], a[64:67], a[0:3]
  v_mfma_f32_16x16x32_bf16 a[4:7], a[60:63], a[68:71], a[4:7]
  v_mfma_f32_16x16x32_bf16 a[8:11], a[60:63], a[72:75], a[8:11]
  buffer_load_dwordx4 v11, s[16:19], s20 offen offset:2048 sc1 lds
  v_mfma_f32_16x16x32_bf16 a[12:15], a[60:63], a[76:79], a[12:15]
  v_mfma_f32_16x16x32_bf16 a[16:19], a[60:63], a[80:83], a[16:19]
  v_mfma_f32_16x16x32_bf16 a[20:23], a[60:63], a[84:87], a[20:23]
  v_mfma_f32_16x16x32_bf16 a[24:27], a[60:63], a[88:91], a[24:27]
  buffer_load_dwordx4 v11, s[16:19], s20 offen offset:3072 sc1 lds
  v_mfma_f32_16x16x32_bf16 a[28:31], a[60:63], a[92:95], a[28:31]
  s_add_u32 s20, s20, 131072
  s_waitcnt lgkmcnt(0)
  v_mfma_f32_16x16x32_bf16 v[32:35], a[32:35], a[96:99], v[32:35]
  ds_read_b64_tr_b16 a[48:49], v7 offset:24576
  v_mfma_f32_16x16x32_bf16 v[36:39], a[32:35], a[100:103], v[36:39]
  ds_read_b64_tr_b16 a[50:51], v7 offset:28672
  v_mfma_f32_16x16x32_bf16 v[40:43], a[32:35], a[104:107], v[40:43]
  ds_read_b64_tr_b16 a[52:53], v8 offset:24576
  v_mfma_f32_16x16x32_bf16 v[44:47], a[32:35], a[108:111], v[44:47]
  ds_read_b64_tr_b16 a[54:55], v8 offset:28672
  v_mfma_f32_16x16x32_bf16 v[48:51], a[32:35], a[112:115], v[48:51]
  ds_read_b64_tr_b16 a[56:57], v9 offset:24576
  v_mfma_f32_16x16x32_bf16 v[52:55], a[32:35], a[116:119], v[52:55]
  ds_read_b64_tr_b16 a[58:59], v9 offset:28672
  v_mfma_f32_16x16x32_bf16 v[56:59], a[32:35], a[120:123], v[56:59]
  ds_read_b64_tr_b16 a[60:61], v10 offset:24576
  v_mfma_f32_16x16x32_bf16 v[60:63], a[32:35], a[124:127], v[60:63]
  ds_read_b64_tr_b16 a[62:63], v10 offset:28672
  v_mfma_f32_16x16x32_bf16 v[64:67], a[36:39], a[96:99], v[64:67]
  s_add_u32 s25, s25, 32768
  s_and_b32 s25, s25, 131071
  v_mfma_f32_16x16x32_bf16 v[68:71], a[36:39], a[100:103], v[68:71]
  v_add_u32 v6, s25, v1
  v_mfma_f32_16x16x32_bf16 v[72:75], a[36:39], a[104:107], v[72:75]
  v_add_u32 v7, s25, v2
  v_mfma_f32_16x16x32_bf16 v[76:79], a[36:39], a[108:111], v[76:79]
  v_add_u32 v8, s25, v3
  v_mfma_f32_16x16x32_bf16 v[80:83], a[36:39], a[112:115], v[80:83]
  v_add_u32 v9, s25, v4
  v_mfma_f32_16x16x32_bf16 v[84:87], a[36:39], a[116:119], v[84:87]
  v_add_u32 v10, s25, v5
  v_mfma_f32_16x16x32_bf16 v[88:91], a[36:39], a[120:123], v[88:91]
  v_mfma_f32_16x16x32_bf16 v[92:95], a[36:39], a[124:127], v[92:95]
  v_mfma_f32_16x16x32_bf16 v[96:99], a[40:43], a[96:99], v[96:99]
  v_mfma_f32_16x16x32_bf16 v[100:103], a[40:43], a[100:103], v[100:103]
  s_add_u32 m0, s24, s42
  v_mfma_f32_16x16x32_bf16 v[104:107], a[40:43], a[104:107], v[104:107]
  buffer_load_dwordx4 v12, s[12:15], s21 offen offset:0 lds
  v_mfma_f32_16x16x32_bf16 v[108:111], a[40:43], a[108:111], v[108:111]
  v_mfma_f32_16x16x32_bf16 v[112:115], a[40:43], a[112:115], v[112:115]
  v_mfma_f32_16x16x32_bf16 v[116:119], a[40:43], a[116:119], v[116:119]
  v_mfma_f32_16x16x32_bf16 v[120:123], a[40:43], a[120:123], v[120:123]
  buffer_load_dwordx4 v13, s[12:15], s21 offen offset:1024 lds
  v_mfma_f32_16x16x32_bf16 v[124:127], a[40:43], a[124:127], v[124:127]
  v_mfma_f32_16x16x32_bf16 v[128:131], a[44:47], a[96:99], v[128:131]
  v_mfma_f32_16x16x32_bf16 v[132:135], a[44:47], a[100:103], v[132:135]
  v_mfma_f32_16x16x32_bf16 v[136:139], a[44:47], a[104:107], v[136:139]
  buffer_load_dwordx4 v14, s[12:15], s21 offen offset:2048 lds
  v_mfma_f32_16x16x32_bf16 v[140:143], a[44:47], a[108:111], v[140:143]
  v_mfma_f32_16x16x32_bf16 v[144:147], a[44:47], a[112:115], v[144:147]
  v_mfma_f32_16x16x32_bf16 v[148:151], a[44:47], a[116:119], v[148:151]
  v_mfma_f32_16x16x32_bf16 v[152:155], a[44:47], a[120:123], v[152:155]
  buffer_load_dwordx4 v15, s[12:15], s21 offen offset:3072 lds
  v_mfma_f32_16x16x32_bf16 v[156:159], a[44:47], a[124:127], v[156:159]
  s_add_u32 s21, s21, s22
  s_add_u32 s24, s24, 32768
  s_and_b32 s24, s24, 131071
  s_add_u32 s26, s26, 2
  s_branch G8_loop
G8_event:
  s_cmp_eq_u32 s26, s32
  s_cbranch_scc1 G8_switch
  s_cmp_lg_u32 s27, 0
  s_cbranch_scc1 SIG_13
  v_mov_b32 v18, s37
  s_mov_b64 exec, 1
  buffer_atomic_add v18, off, s[8:11], s35 sc1
  s_cmp_eq_u32 s36, 0
  s_cbranch_scc1 SIG_13_1
  buffer_atomic_add v18, off, s[8:11], s36 sc1
SIG_13_1:
  s_mov_b64 exec, -1
SIG_13:
  s_mov_b32 s35, 0
  s_mov_b32 s43, s32
  s_branch G8_back
G8_switch:
  s_bitcmp1_b32 s31, 4
  s_cbranch_scc1 G8_sw1
  s_mov_b32 s14, 0
  s_mov_b32 s18, 0
  s_branch G8_back
G8_sw1:
  s_bfe_u32 s4, s31, 262152
  s_bfe_u32 s5, s31, 393228
  s_bfe_u32 s20, s31, 0x50007
  s_lshl_b32 s20, s20, 12
  s_mov_b32 s18, s10
  s_mov_b32 s40, 32
  s_and_b32 s3, s31, 7
  s_cmp_eq_u32 s3, 2
  s_cbranch_scc1 SLG8s_v
  s_cmp_eq_u32 s3, 3
  s_cbranch_scc1 SLG8s_fu
  s_cmp_eq_u32 s3, 4
  s_cbranch_scc1 SLG8s_fd
  s_cmp_eq_u32 s3, 5
  s_cbranch_scc1 SLG8s_wo
  s_cmp_eq_u32 s28, 0
  s_cselect_b32 s12, s60, s62
  s_cselect_b32 s13, s61, s63
  s_mov_b32 s14, 8388608
  s_mov_b32 s22, 262144
  s_lshl_b32 s21, s5, 8
  v_mul_u32_u24 v18, 8192, v16
  v_xor_b32 v20, 0x80, v17
  v_add_u32 v12, v18, v17
  v_add_u32 v13, v18, v20
  v_add_u32 v13, 31744, v13
  v_add_u32 v14, 63488, v12
  v_add_u32 v15, 63488, v13
  s_branch SLG8s_done
SLG8s_v:
  s_mov_b32 s12, s64
  s_mov_b32 s13, s65
  s_mov_b32 s14, 8388608
  s_mov_b32 s22, 262144
  s_lshl_b32 s21, s5, 9
  s_lshl_b32 s3, s28, 8
  s_add_u32 s21, s21, s3
  v_mul_u32_u24 v18, 8192, v16
  v_xor_b32 v20, 0x80, v17
  v_add_u32 v12, v18, v17
  v_add_u32 v13, v18, v20
  v_add_u32 v13, 31744, v13
  v_add_u32 v14, 63488, v12
  v_add_u32 v15, 63488, v13
  s_branch SLG8s_done
SLG8s_fu:
  s_cmp_eq_u32 s28, 0
  s_cselect_b32 s12, s72, s74
  s_cselect_b32 s13, s73, s75
  s_mov_b32 s14, 7340032
  s_mov_b32 s22, 229376
  s_lshl_b32 s21, s5, 8
  v_mul_u32_u24 v18, 7168, v16
  v_xor_b32 v20, 0x80, v17
  v_add_u32 v12, v18, v17
  v_add_u32 v13, v18, v20
  v_add_u32 v13, 27648, v13
  v_add_u32 v14, 55296, v12
  v_add_u32 v15, 55296, v13
  s_branch SLG8s_done
SLG8s_fd:
  s_mov_b32 s12, s76
  s_mov_b32 s13, s77
  s_mov_b32 s14, 7340032
  s_mov_b32 s22, 65536
  s_lshl_b32 s21, s5, 9
  s_lshl_b32 s3, s28, 8
  s_add_u32 s21, s21, s3
  s_add_u32 s20, s20, 54525952
  s_mov_b32 s40, 112
  v_mul_u32_u24 v18, 2048, v16
  v_xor_b32 v20, 0x80, v17
  v_add_u32 v12, v18, v17
  v_add_u32 v13, v18, v20
  v_add_u32 v13, 7168, v13
  v_add_u32 v14, 14336, v12
  v_add_u32 v15, 14336, v13
  s_branch SLG8s_done
SLG8s_wo:
  s_mov_b32 s12, s66
  s_mov_b32 s13, s67
  s_mov_b32 s14, 8388608
  s_mov_b32 s22, 65536
  s_lshl_b32 s21, s5, 9
  s_lshl_b32 s3, s28, 8
  s_add_u32 s21, s21, s3
  s_bfe_u32 s3, s31, 262162
  s_lshl_b32 s4, s3, 19
  s_add_u32 s21, s21, s4
  s_lshl_b32 s4, s3, 20
  s_add_u32 s20, s20, s4
  s_add_u32 s20, s20, 69206016
  s_bfe_u32 s40, s31, 262166
  s_add_u32 s40, s40, 1
  s_lshl_b32 s40, s40, 3
  v_mul_u32_u24 v18, 2048, v16
  v_xor_b32 v20, 0x80, v17
  v_add_u32 v12, v18, v17
  v_add_u32 v13, v18, v20
  v_add_u32 v13, 7168, v13
  v_add_u32 v14, 14336, v12
  v_add_u32 v15, 14336, v13
SLG8s_done:
  s_branch G8_back
G8_epi:
  s_bfe_u32 s4, s30, 262152
  s_bfe_u32 s5, s30, 393228
  s_bfe_u32 s6, s30, 0x50007
  s_lshl_b32 s6, s6, 2
  s_mul_i32 s3, s28, 8
  s_add_u32 s6, s6, s3
  s_lshl_b32 s35, s4, 7
  s_add_u32 s35, s35, 99614720
  s_mov_b32 s37, 1
  s_and_b32 s3, s30, 7
  s_cmp_eq_u32 s3, 3
  s_cbranch_scc1 G8_fu
  s_add_u32 s35, s35, 0
  s_add_u32 s36, s35, 128
  s_mov_b32 s37, 2
  s_lshr_b32 s6, s6, 1
  s_mul_i32 s6, s6, 24576
  s_mul_i32 s5, s5, 1572864
  s_add_u32 s6, s6, s5
  s_add_u32 s5, s5, 16384
  s_cmp_eq_u32 s3, 2
  s_cselect_b32 s5, s5, 0
  s_mov_b32 s7, 8192
  s_cmov_b32 s7, 1572864
  s_add_u32 s6, s6, s5
  s_lshl_b32 s3, s29, 11
  s_add_u32 s6, s6, s3
  s_add_u32 s6, s6, 4194304
  v_cvt_pk_bf16_f32 v32, v32, v33
  v_cvt_pk_bf16_f32 v33, v34, v35
  v_cvt_pk_bf16_f32 v34, v64, v65
  v_cvt_pk_bf16_f32 v35, v66, v67
  s_add_u32 s3, s6, 0
  buffer_store_dwordx4 v[32:35], v0, s[8:11], s3 offen offset:0 sc1
  v_cvt_pk_bf16_f32 v36, v36, v37
  v_cvt_pk_bf16_f32 v37, v38, v39
  v_cvt_pk_bf16_f32 v38, v68, v69
  v_cvt_pk_bf16_f32 v39, v70, v71
  s_add_u32 s3, s6, 4096
  buffer_store_dwordx4 v[36:39], v0, s[8:11], s3 offen offset:0 sc1
  v_cvt_pk_bf16_f32 v40, v40, v41
  v_cvt_pk_bf16_f32 v41, v42, v43
  v_cvt_pk_bf16_f32 v42, v72, v73
  v_cvt_pk_bf16_f32 v43, v74, v75
  s_add_u32 s3, s6, 24576
  buffer_store_dwordx4 v[40:43], v0, s[8:11], s3 offen offset:0 sc1
  v_cvt_pk_bf16_f32 v44, v44, v45
  v_cvt_pk_bf16_f32 v45, v46, v47
  v_cvt_pk_bf16_f32 v46, v76, v77
  v_cvt_pk_bf16_f32 v47, v78, v79
  s_add_u32 s3, s6, 28672
  buffer_store_dwordx4 v[44:47], v0, s[8:11], s3 offen offset:0 sc1
  v_cvt_pk_bf16_f32 v48, v48, v49
  v_cvt_pk_bf16_f32 v49, v50, v51
  v_cvt_pk_bf16_f32 v50, v80, v81
  v_cvt_pk_bf16_f32 v51, v82, v83
  s_add_u32 s3, s6, 49152
  buffer_store_dwordx4 v[48:51], v0, s[8:11], s3 offen offset:0 sc1
  v_cvt_pk_bf16_f32 v52, v52, v53
  v_cvt_pk_bf16_f32 v53, v54, v55
  v_cvt_pk_bf16_f32 v54, v84, v85
  v_cvt_pk_bf16_f32 v55, v86, v87
  s_add_u32 s3, s6, 53248
  buffer_store_dwordx4 v[52:55], v0, s[8:11], s3 offen offset:0 sc1
  v_cvt_pk_bf16_f32 v56, v56, v57
  v_cvt_pk_bf16_f32 v57, v58, v59
  v_cvt_pk_bf16_f32 v58, v88, v89
  v_cvt_pk_bf16_f32 v59, v90, v91
  s_add_u32 s3, s6, 73728
  buffer_store_dwordx4 v[56:59], v0, s[8:11], s3 offen offset:0 sc1
  v_cvt_pk_bf16_f32 v60, v60, v61
  v_cvt_pk_bf16_f32 v61, v62, v63
  v_cvt_pk_bf16_f32 v62, v92, v93
  v_cvt_pk_bf16_f32 v63, v94, v95
  s_add_u32 s3, s6, 77824
  buffer_store_dwordx4 v[60:63], v0, s[8:11], s3 offen offset:0 sc1
  v_cvt_pk_bf16_f32 v96, v96, v97
  v_cvt_pk_bf16_f32 v97, v98, v99
  v_cvt_pk_bf16_f32 v98, v128, v129
  v_cvt_pk_bf16_f32 v99, v130, v131
  s_add_u32 s3, s6, 0
  buffer_store_dwordx4 v[96:99], v0, s[8:11], s3 offen offset:1024 sc1
  v_cvt_pk_bf16_f32 v100, v100, v101
  v_cvt_pk_bf16_f32 v101, v102, v103
  v_cvt_pk_bf16_f32 v102, v132, v133
  v_cvt_pk_bf16_f32 v103, v134, v135
  s_add_u32 s3, s6, 4096
  buffer_store_dwordx4 v[100:103], v0, s[8:11], s3 offen offset:1024 sc1
  v_cvt_pk_bf16_f32 v104, v104, v105
  v_cvt_pk_bf16_f32 v105, v106, v107
  v_cvt_pk_bf16_f32 v106, v136, v137
  v_cvt_pk_bf16_f32 v107, v138, v139
  s_add_u32 s3, s6, 24576
  buffer_store_dwordx4 v[104:107], v0, s[8:11], s3 offen offset:1024 sc1
  v_cvt_pk_bf16_f32 v108, v108, v109
  v_cvt_pk_bf16_f32 v109, v110, v111
  v_cvt_pk_bf16_f32 v110, v140, v141
  v_cvt_pk_bf16_f32 v111, v142, v143
  s_add_u32 s3, s6, 28672
  buffer_store_dwordx4 v[108:111], v0, s[8:11], s3 offen offset:1024 sc1
  v_cvt_pk_bf16_f32 v112, v112, v113
  v_cvt_pk_bf16_f32 v113, v114, v115
  v_cvt_pk_bf16_f32 v114, v144, v145
  v_cvt_pk_bf16_f32 v115, v146, v147
  s_add_u32 s3, s6, 49152
  buffer_store_dwordx4 v[112:115], v0, s[8:11], s3 offen offset:1024 sc1
  v_cvt_pk_bf16_f32 v116, v116, v117
  v_cvt_pk_bf16_f32 v117, v118, v119
  v_cvt_pk_bf16_f32 v118, v148, v149
  v_cvt_pk_bf16_f32 v119, v150, v151
  s_add_u32 s3, s6, 53248
  buffer_store_dwordx4 v[116:119], v0, s[8:11], s3 offen offset:1024 sc1
  v_cvt_pk_bf16_f32 v120, v120, v121
  v_cvt_pk_bf16_f32 v121, v122, v123
  v_cvt_pk_bf16_f32 v122, v152, v153
  v_cvt_pk_bf16_f32 v123, v154, v155
  s_add_u32 s3, s6, 73728
  buffer_store_dwordx4 v[120:123], v0, s[8:11], s3 offen offset:1024 sc1
  v_cvt_pk_bf16_f32 v124, v124, v125
  v_cvt_pk_bf16_f32 v125, v126, v127
  v_cvt_pk_bf16_f32 v126, v156, v157
  v_cvt_pk_bf16_f32 v127, v158, v159
  s_add_u32 s3, s6, 77824
  buffer_store_dwordx4 v[124:127], v0, s[8:11], s3 offen offset:1024 sc1
  s_add_u32 s6, s6, s7
  v_cvt_pk_bf16_f32 v160, v160, v161
  v_cvt_pk_bf16_f32 v161, v162, v163
  v_cvt_pk_bf16_f32 v162, v192, v193
  v_cvt_pk_bf16_f32 v163, v194, v195
  s_add_u32 s3, s6, 0
  buffer_store_dwordx4 v[160:163], v0, s[8:11], s3 offen offset:0 sc1
  v_cvt_pk_bf16_f32 v164, v164, v165
  v_cvt_pk_bf16_f32 v165, v166, v167
  v_cvt_pk_bf16_f32 v166, v196, v197
  v_cvt_pk_bf16_f32 v167, v198, v199
  s_add_u32 s3, s6, 4096
  buffer_store_dwordx4 v[164:167], v0, s[8:11], s3 offen offset:0 sc1
  v_cvt_pk_bf16_f32 v168, v168, v169
  v_cvt_pk_bf16_f32 v169, v170, v171
  v_cvt_pk_bf16_f32 v170, v200, v201
  v_cvt_pk_bf16_f32 v171, v202, v203
  s_add_u32 s3, s6, 24576
  buffer_store_dwordx4 v[168:171], v0, s[8:11], s3 offen offset:0 sc1
  v_cvt_pk_bf16_f32 v172, v172, v173
  v_cvt_pk_bf16_f32 v173, v174, v175
  v_cvt_pk_bf16_f32 v174, v204, v205
  v_cvt_pk_bf16_f32 v175, v206, v207
  s_add_u32 s3, s6, 28672
  buffer_store_dwordx4 v[172:175], v0, s[8:11], s3 offen offset:0 sc1
  v_cvt_pk_bf16_f32 v176, v176, v177
  v_cvt_pk_bf16_f32 v177, v178, v179
  v_cvt_pk_bf16_f32 v178, v208, v209
  v_cvt_pk_bf16_f32 v179, v210, v211
  s_add_u32 s3, s6, 49152
  buffer_store_dwordx4 v[176:179], v0, s[8:11], s3 offen offset:0 sc1
  v_cvt_pk_bf16_f32 v180, v180, v181
  v_cvt_pk_bf16_f32 v181, v182, v183
  v_cvt_pk_bf16_f32 v182, v212, v213
  v_cvt_pk_bf16_f32 v183, v214, v215
  s_add_u32 s3, s6, 53248
  buffer_store_dwordx4 v[180:183], v0, s[8:11], s3 offen offset:0 sc1
  v_cvt_pk_bf16_f32 v184, v184, v185
  v_cvt_pk_bf16_f32 v185, v186, v187
  v_cvt_pk_bf16_f32 v186, v216, v217
  v_cvt_pk_bf16_f32 v187, v218, v219
  s_add_u32 s3, s6, 73728
  buffer_store_dwordx4 v[184:187], v0, s[8:11], s3 offen offset:0 sc1
  v_cvt_pk_bf16_f32 v188, v188, v189
  v_cvt_pk_bf16_f32 v189, v190, v191
  v_cvt_pk_bf16_f32 v190, v220, v221
  v_cvt_pk_bf16_f32 v191, v222, v223
  s_add_u32 s3, s6, 77824
  buffer_store_dwordx4 v[188:191], v0, s[8:11], s3 offen offset:0 sc1
  v_accvgpr_read_b32 v20, a0
  v_accvgpr_read_b32 v21, a1
  v_accvgpr_read_b32 v22, a2
  v_accvgpr_read_b32 v23, a3
  v_cvt_pk_bf16_f32 v224, v224, v225
  v_cvt_pk_bf16_f32 v225, v226, v227
  v_cvt_pk_bf16_f32 v226, v20, v21
  v_cvt_pk_bf16_f32 v227, v22, v23
  s_add_u32 s3, s6, 0
  buffer_store_dwordx4 v[224:227], v0, s[8:11], s3 offen offset:1024 sc1
  v_accvgpr_read_b32 v24, a4
  v_accvgpr_read_b32 v25, a5
  v_accvgpr_read_b32 v26, a6
  v_accvgpr_read_b32 v27, a7
  v_cvt_pk_bf16_f32 v228, v228, v229
  v_cvt_pk_bf16_f32 v229, v230, v231
  v_cvt_pk_bf16_f32 v230, v24, v25
  v_cvt_pk_bf16_f32 v231, v26, v27
  s_add_u32 s3, s6, 4096
  buffer_store_dwordx4 v[228:231], v0, s[8:11], s3 offen offset:1024 sc1
  v_accvgpr_read_b32 v20, a8
  v_accvgpr_read_b32 v21, a9
  v_accvgpr_read_b32 v22, a10
  v_accvgpr_read_b32 v23, a11
  v_cvt_pk_bf16_f32 v232, v232, v233
  v_cvt_pk_bf16_f32 v233, v234, v235
  v_cvt_pk_bf16_f32 v234, v20, v21
  v_cvt_pk_bf16_f32 v235, v22, v23
  s_add_u32 s3, s6, 24576
  buffer_store_dwordx4 v[232:235], v0, s[8:11], s3 offen offset:1024 sc1
  v_accvgpr_read_b32 v24, a12
  v_accvgpr_read_b32 v25, a13
  v_accvgpr_read_b32 v26, a14
  v_accvgpr_read_b32 v27, a15
  v_cvt_pk_bf16_f32 v236, v236, v237
  v_cvt_pk_bf16_f32 v237, v238, v239
  v_cvt_pk_bf16_f32 v238, v24, v25
  v_cvt_pk_bf16_f32 v239, v26, v27
  s_add_u32 s3, s6, 28672
  buffer_store_dwordx4 v[236:239], v0, s[8:11], s3 offen offset:1024 sc1
  v_accvgpr_read_b32 v20, a16
  v_accvgpr_read_b32 v21, a17
  v_accvgpr_read_b32 v22, a18
  v_accvgpr_read_b32 v23, a19
  v_cvt_pk_bf16_f32 v240, v240, v241
  v_cvt_pk_bf16_f32 v241, v242, v243
  v_cvt_pk_bf16_f32 v242, v20, v21
  v_cvt_pk_bf16_f32 v243, v22, v23
  s_add_u32 s3, s6, 49152
  buffer_store_dwordx4 v[240:243], v0, s[8:11], s3 offen offset:1024 sc1
  v_accvgpr_read_b32 v24, a20
  v_accvgpr_read_b32 v25, a21
  v_accvgpr_read_b32 v26, a22
  v_accvgpr_read_b32 v27, a23
  v_cvt_pk_bf16_f32 v244, v244, v245
  v_cvt_pk_bf16_f32 v245, v246, v247
  v_cvt_pk_bf16_f32 v246, v24, v25
  v_cvt_pk_bf16_f32 v247, v26, v27
  s_add_u32 s3, s6, 53248
  buffer_store_dwordx4 v[244:247], v0, s[8:11], s3 offen offset:1024 sc1
  v_accvgpr_read_b32 v20, a24
  v_accvgpr_read_b32 v21, a25
  v_accvgpr_read_b32 v22, a26
  v_accvgpr_read_b32 v23, a27
  v_cvt_pk_bf16_f32 v248, v248, v249
  v_cvt_pk_bf16_f32 v249, v250, v251
  v_cvt_pk_bf16_f32 v250, v20, v21
  v_cvt_pk_bf16_f32 v251, v22, v23
  s_add_u32 s3, s6, 73728
  buffer_store_dwordx4 v[248:251], v0, s[8:11], s3 offen offset:1024 sc1
  v_accvgpr_read_b32 v24, a28
  v_accvgpr_read_b32 v25, a29
  v_accvgpr_read_b32 v26, a30
  v_accvgpr_read_b32 v27, a31
  v_cvt_pk_bf16_f32 v252, v252, v253
  v_cvt_pk_bf16_f32 v253, v254, v255
  v_cvt_pk_bf16_f32 v254, v24, v25
  v_cvt_pk_bf16_f32 v255, v26, v27
  s_add_u32 s3, s6, 77824
  buffer_store_dwordx4 v[252:255], v0, s[8:11], s3 offen offset:1024 sc1
G8_done:
  s_bitcmp1_b32 s31, 4
  s_cbranch_scc0 L_drain
  s_mov_b32 s30, s31
  s_add_u32 s38, s38, 4
  s_addc_u32 s39, s39, 0
  s_load_dword s31, s[38:39], 0
  s_branch G8_task
G8_fu:
  s_add_u32 s35, s35, 2048
  s_add_u32 s36, s35, 128
  s_lshl_b32 s5, s5, 2
  s_lshl_b32 s3, s29, 1
  s_add_u32 s5, s5, s3
  s_lshl_b32 s5, s5, 17
  s_lshl_b32 s6, s6, 10
  s_add_u32 s6, s6, s5
  s_add_u32 s6, s6, 54525952
  s_mov_b32 s7, 0xbfb8aa3b
  v_mul_f32 v20, s7, v32
  v_mul_f32 v21, s7, v33
  v_mul_f32 v22, s7, v34
  v_mul_f32 v23, s7, v35
  v_exp_f32 v20, v20
  v_exp_f32 v21, v21
  v_exp_f32 v22, v22
  v_exp_f32 v23, v23
  v_pk_mul_f32 v[32:33], v[32:33], v[160:161]
  v_pk_mul_f32 v[34:35], v[34:35], v[162:163]
  v_add_f32 v20, 1.0, v20
  v_add_f32 v21, 1.0, v21
  v_add_f32 v22, 1.0, v22
  v_add_f32 v23, 1.0, v23
  v_rcp_f32 v20, v20
  v_rcp_f32 v21, v21
  v_rcp_f32 v22, v22
  v_rcp_f32 v23, v23
  v_mul_f32 v24, s7, v64
  v_mul_f32 v25, s7, v65
  v_mul_f32 v26, s7, v66
  v_mul_f32 v27, s7, v67
  v_exp_f32 v24, v24
  v_exp_f32 v25, v25
  v_exp_f32 v26, v26
  v_exp_f32 v27, v27
  v_pk_mul_f32 v[64:65], v[64:65], v[192:193]
  v_pk_mul_f32 v[66:67], v[66:67], v[194:195]
  v_add_f32 v24, 1.0, v24
  v_add_f32 v25, 1.0, v25
  v_add_f32 v26, 1.0, v26
  v_add_f32 v27, 1.0, v27
  v_rcp_f32 v24, v24
  v_rcp_f32 v25, v25
  v_rcp_f32 v26, v26
  v_rcp_f32 v27, v27
  v_pk_mul_f32 v[32:33], v[32:33], v[20:21]
  v_pk_mul_f32 v[34:35], v[34:35], v[22:23]
  v_pk_mul_f32 v[64:65], v[64:65], v[24:25]
  v_pk_mul_f32 v[66:67], v[66:67], v[26:27]
  v_cvt_pk_bf16_f32 v32, v32, v33
  v_cvt_pk_bf16_f32 v33, v34, v35
  v_cvt_pk_bf16_f32 v34, v64, v65
  v_cvt_pk_bf16_f32 v35, v66, v67
  s_add_u32 s3, s6, 0
  buffer_store_dwordx4 v[32:35], v0, s[8:11], s3 offen offset:0 sc1
  v_mul_f32 v20, s7, v36
  v_mul_f32 v21, s7, v37
  v_mul_f32 v22, s7, v38
  v_mul_f32 v23, s7, v39
  v_exp_f32 v20, v20
  v_exp_f32 v21, v21
  v_exp_f32 v22, v22
  v_exp_f32 v23, v23
  v_pk_mul_f32 v[36:37], v[36:37], v[164:165]
  v_pk_mul_f32 v[38:39], v[38:39], v[166:167]
  v_add_f32 v20, 1.0, v20
  v_add_f32 v21, 1.0, v21
  v_add_f32 v22, 1.0, v22
  v_add_f32 v23, 1.0, v23
  v_rcp_f32 v20, v20
  v_rcp_f32 v21, v21
  v_rcp_f32 v22, v22
  v_rcp_f32 v23, v23
  v_mul_f32 v24, s7, v68
  v_mul_f32 v25, s7, v69
  v_mul_f32 v26, s7, v70
  v_mul_f32 v27, s7, v71
  v_exp_f32 v24, v24
  v_exp_f32 v25, v25
  v_exp_f32 v26, v26
  v_exp_f32 v27, v27
  v_pk_mul_f32 v[68:69], v[68:69], v[196:197]
  v_pk_mul_f32 v[70:71], v[70:71], v[198:199]
  v_add_f32 v24, 1.0, v24
  v_add_f32 v25, 1.0, v25
  v_add_f32 v26, 1.0, v26
  v_add_f32 v27, 1.0, v27
  v_rcp_f32 v24, v24
  v_rcp_f32 v25, v25
  v_rcp_f32 v26, v26
  v_rcp_f32 v27, v27
  v_pk_mul_f32 v[36:37], v[36:37], v[20:21]
  v_pk_mul_f32 v[38:39], v[38:39], v[22:23]
  v_pk_mul_f32 v[68:69], v[68:69], v[24:25]
  v_pk_mul_f32 v[70:71], v[70:71], v[26:27]
  v_cvt_pk_bf16_f32 v36, v36, v37
  v_cvt_pk_bf16_f32 v37, v38, v39
  v_cvt_pk_bf16_f32 v38, v68, v69
  v_cvt_pk_bf16_f32 v39, v70, v71
  buffer_store_dwordx4 v[36:39], v0, s[8:11], s3 offen offset:1024 sc1
  v_mul_f32 v20, s7, v40
  v_mul_f32 v21, s7, v41
  v_mul_f32 v22, s7, v42
  v_mul_f32 v23, s7, v43
  v_exp_f32 v20, v20
  v_exp_f32 v21, v21
  v_exp_f32 v22, v22
  v_exp_f32 v23, v23
  v_pk_mul_f32 v[40:41], v[40:41], v[168:169]
  v_pk_mul_f32 v[42:43], v[42:43], v[170:171]
  v_add_f32 v20, 1.0, v20
  v_add_f32 v21, 1.0, v21
  v_add_f32 v22, 1.0, v22
  v_add_f32 v23, 1.0, v23
  v_rcp_f32 v20, v20
  v_rcp_f32 v21, v21
  v_rcp_f32 v22, v22
  v_rcp_f32 v23, v23
  v_mul_f32 v24, s7, v72
  v_mul_f32 v25, s7, v73
  v_mul_f32 v26, s7, v74
  v_mul_f32 v27, s7, v75
  v_exp_f32 v24, v24
  v_exp_f32 v25, v25
  v_exp_f32 v26, v26
  v_exp_f32 v27, v27
  v_pk_mul_f32 v[72:73], v[72:73], v[200:201]
  v_pk_mul_f32 v[74:75], v[74:75], v[202:203]
  v_add_f32 v24, 1.0, v24
  v_add_f32 v25, 1.0, v25
  v_add_f32 v26, 1.0, v26
  v_add_f32 v27, 1.0, v27
  v_rcp_f32 v24, v24
  v_rcp_f32 v25, v25
  v_rcp_f32 v26, v26
  v_rcp_f32 v27, v27
  v_pk_mul_f32 v[40:41], v[40:41], v[20:21]
  v_pk_mul_f32 v[42:43], v[42:43], v[22:23]
  v_pk_mul_f32 v[72:73], v[72:73], v[24:25]
  v_pk_mul_f32 v[74:75], v[74:75], v[26:27]
  v_cvt_pk_bf16_f32 v40, v40, v41
  v_cvt_pk_bf16_f32 v41, v42, v43
  v_cvt_pk_bf16_f32 v42, v72, v73
  v_cvt_pk_bf16_f32 v43, v74, v75
  buffer_store_dwordx4 v[40:43], v0, s[8:11], s3 offen offset:2048 sc1
  v_mul_f32 v20, s7, v44
  v_mul_f32 v21, s7, v45
  v_mul_f32 v22, s7, v46
  v_mul_f32 v23, s7, v47
  v_exp_f32 v20, v20
  v_exp_f32 v21, v21
  v_exp_f32 v22, v22
  v_exp_f32 v23, v23
  v_pk_mul_f32 v[44:45], v[44:45], v[172:173]
  v_pk_mul_f32 v[46:47], v[46:47], v[174:175]
  v_add_f32 v20, 1.0, v20
  v_add_f32 v21, 1.0, v21
  v_add_f32 v22, 1.0, v22
  v_add_f32 v23, 1.0, v23
  v_rcp_f32 v20, v20
  v_rcp_f32 v21, v21
  v_rcp_f32 v22, v22
  v_rcp_f32 v23, v23
  v_mul_f32 v24, s7, v76
  v_mul_f32 v25, s7, v77
  v_mul_f32 v26, s7, v78
  v_mul_f32 v27, s7, v79
  v_exp_f32 v24, v24
  v_exp_f32 v25, v25
  v_exp_f32 v26, v26
  v_exp_f32 v27, v27
  v_pk_mul_f32 v[76:77], v[76:77], v[204:205]
  v_pk_mul_f32 v[78:79], v[78:79], v[206:207]
  v_add_f32 v24, 1.0, v24
  v_add_f32 v25, 1.0, v25
  v_add_f32 v26, 1.0, v26
  v_add_f32 v27, 1.0, v27
  v_rcp_f32 v24, v24
  v_rcp_f32 v25, v25
  v_rcp_f32 v26, v26
  v_rcp_f32 v27, v27
  v_pk_mul_f32 v[44:45], v[44:45], v[20:21]
  v_pk_mul_f32 v[46:47], v[46:47], v[22:23]
  v_pk_mul_f32 v[76:77], v[76:77], v[24:25]
  v_pk_mul_f32 v[78:79], v[78:79], v[26:27]
  v_cvt_pk_bf16_f32 v44, v44, v45
  v_cvt_pk_bf16_f32 v45, v46, v47
  v_cvt_pk_bf16_f32 v46, v76, v77
  v_cvt_pk_bf16_f32 v47, v78, v79
  buffer_store_dwordx4 v[44:47], v0, s[8:11], s3 offen offset:3072 sc1
  v_mul_f32 v20, s7, v48
  v_mul_f32 v21, s7, v49
  v_mul_f32 v22, s7, v50
  v_mul_f32 v23, s7, v51
  v_exp_f32 v20, v20
  v_exp_f32 v21, v21
  v_exp_f32 v22, v22
  v_exp_f32 v23, v23
  v_pk_mul_f32 v[48:49], v[48:49], v[176:177]
  v_pk_mul_f32 v[50:51], v[50:51], v[178:179]
  v_add_f32 v20, 1.0, v20
  v_add_f32 v21, 1.0, v21
  v_add_f32 v22, 1.0, v22
  v_add_f32 v23, 1.0, v23
  v_rcp_f32 v20, v20
  v_rcp_f32 v21, v21
  v_rcp_f32 v22, v22
  v_rcp_f32 v23, v23
  v_mul_f32 v24, s7, v80
  v_mul_f32 v25, s7, v81
  v_mul_f32 v26, s7, v82
  v_mul_f32 v27, s7, v83
  v_exp_f32 v24, v24
  v_exp_f32 v25, v25
  v_exp_f32 v26, v26
  v_exp_f32 v27, v27
  v_pk_mul_f32 v[80:81], v[80:81], v[208:209]
  v_pk_mul_f32 v[82:83], v[82:83], v[210:211]
  v_add_f32 v24, 1.0, v24
  v_add_f32 v25, 1.0, v25
  v_add_f32 v26, 1.0, v26
  v_add_f32 v27, 1.0, v27
  v_rcp_f32 v24, v24
  v_rcp_f32 v25, v25
  v_rcp_f32 v26, v26
  v_rcp_f32 v27, v27
  v_pk_mul_f32 v[48:49], v[48:49], v[20:21]
  v_pk_mul_f32 v[50:51], v[50:51], v[22:23]
  v_pk_mul_f32 v[80:81], v[80:81], v[24:25]
  v_pk_mul_f32 v[82:83], v[82:83], v[26:27]
  v_cvt_pk_bf16_f32 v48, v48, v49
  v_cvt_pk_bf16_f32 v49, v50, v51
  v_cvt_pk_bf16_f32 v50, v80, v81
  v_cvt_pk_bf16_f32 v51, v82, v83
  s_add_u32 s3, s6, 4096
  buffer_store_dwordx4 v[48:51], v0, s[8:11], s3 offen offset:0 sc1
  v_mul_f32 v20, s7, v52
  v_mul_f32 v21, s7, v53
  v_mul_f32 v22, s7, v54
  v_mul_f32 v23, s7, v55
  v_exp_f32 v20, v20
  v_exp_f32 v21, v21
  v_exp_f32 v22, v22
  v_exp_f32 v23, v23
  v_pk_mul_f32 v[52:53], v[52:53], v[180:181]
  v_pk_mul_f32 v[54:55], v[54:55], v[182:183]
  v_add_f32 v20, 1.0, v20
  v_add_f32 v21, 1.0, v21
  v_add_f32 v22, 1.0, v22
  v_add_f32 v23, 1.0, v23
  v_rcp_f32 v20, v20
  v_rcp_f32 v21, v21
  v_rcp_f32 v22, v22
  v_rcp_f32 v23, v23
  v_mul_f32 v24, s7, v84
  v_mul_f32 v25, s7, v85
  v_mul_f32 v26, s7, v86
  v_mul_f32 v27, s7, v87
  v_exp_f32 v24, v24
  v_exp_f32 v25, v25
  v_exp_f32 v26, v26
  v_exp_f32 v27, v27
  v_pk_mul_f32 v[84:85], v[84:85], v[212:213]
  v_pk_mul_f32 v[86:87], v[86:87], v[214:215]
  v_add_f32 v24, 1.0, v24
  v_add_f32 v25, 1.0, v25
  v_add_f32 v26, 1.0, v26
  v_add_f32 v27, 1.0, v27
  v_rcp_f32 v24, v24
  v_rcp_f32 v25, v25
  v_rcp_f32 v26, v26
  v_rcp_f32 v27, v27
  v_pk_mul_f32 v[52:53], v[52:53], v[20:21]
  v_pk_mul_f32 v[54:55], v[54:55], v[22:23]
  v_pk_mul_f32 v[84:85], v[84:85], v[24:25]
  v_pk_mul_f32 v[86:87], v[86:87], v[26:27]
  v_cvt_pk_bf16_f32 v52, v52, v53
  v_cvt_pk_bf16_f32 v53, v54, v55
  v_cvt_pk_bf16_f32 v54, v84, v85
  v_cvt_pk_bf16_f32 v55, v86, v87
  buffer_store_dwordx4 v[52:55], v0, s[8:11], s3 offen offset:1024 sc1
  v_mul_f32 v20, s7, v56
  v_mul_f32 v21, s7, v57
  v_mul_f32 v22, s7, v58
  v_mul_f32 v23, s7, v59
  v_exp_f32 v20, v20
  v_exp_f32 v21, v21
  v_exp_f32 v22, v22
  v_exp_f32 v23, v23
  v_pk_mul_f32 v[56:57], v[56:57], v[184:185]
  v_pk_mul_f32 v[58:59], v[58:59], v[186:187]
  v_add_f32 v20, 1.0, v20
  v_add_f32 v21, 1.0, v21
  v_add_f32 v22, 1.0, v22
  v_add_f32 v23, 1.0, v23
  v_rcp_f32 v20, v20
  v_rcp_f32 v21, v21
  v_rcp_f32 v22, v22
  v_rcp_f32 v23, v23
  v_mul_f32 v24, s7, v88
  v_mul_f32 v25, s7, v89
  v_mul_f32 v26, s7, v90
  v_mul_f32 v27, s7, v91
  v_exp_f32 v24, v24
  v_exp_f32 v25, v25
  v_exp_f32 v26, v26
  v_exp_f32 v27, v27
  v_pk_mul_f32 v[88:89], v[88:89], v[216:217]
  v_pk_mul_f32 v[90:91], v[90:91], v[218:219]
  v_add_f32 v24, 1.0, v24
  v_add_f32 v25, 1.0, v25
  v_add_f32 v26, 1.0, v26
  v_add_f32 v27, 1.0, v27
  v_rcp_f32 v24, v24
  v_rcp_f32 v25, v25
  v_rcp_f32 v26, v26
  v_rcp_f32 v27, v27
  v_pk_mul_f32 v[56:57], v[56:57], v[20:21]
  v_pk_mul_f32 v[58:59], v[58:59], v[22:23]
  v_pk_mul_f32 v[88:89], v[88:89], v[24:25]
  v_pk_mul_f32 v[90:91], v[90:91], v[26:27]
  v_cvt_pk_bf16_f32 v56, v56, v57
  v_cvt_pk_bf16_f32 v57, v58, v59
  v_cvt_pk_bf16_f32 v58, v88, v89
  v_cvt_pk_bf16_f32 v59, v90, v91
  buffer_store_dwordx4 v[56:59], v0, s[8:11], s3 offen offset:2048 sc1
  v_mul_f32 v20, s7, v60
  v_mul_f32 v21, s7, v61
  v_mul_f32 v22, s7, v62
  v_mul_f32 v23, s7, v63
  v_exp_f32 v20, v20
  v_exp_f32 v21, v21
  v_exp_f32 v22, v22
  v_exp_f32 v23, v23
  v_pk_mul_f32 v[60:61], v[60:61], v[188:189]
  v_pk_mul_f32 v[62:63], v[62:63], v[190:191]
  v_add_f32 v20, 1.0, v20
  v_add_f32 v21, 1.0, v21
  v_add_f32 v22, 1.0, v22
  v_add_f32 v23, 1.0, v23
  v_rcp_f32 v20, v20
  v_rcp_f32 v21, v21
  v_rcp_f32 v22, v22
  v_rcp_f32 v23, v23
  v_mul_f32 v24, s7, v92
  v_mul_f32 v25, s7, v93
  v_mul_f32 v26, s7, v94
  v_mul_f32 v27, s7, v95
  v_exp_f32 v24, v24
  v_exp_f32 v25, v25
  v_exp_f32 v26, v26
  v_exp_f32 v27, v27
  v_pk_mul_f32 v[92:93], v[92:93], v[220:221]
  v_pk_mul_f32 v[94:95], v[94:95], v[222:223]
  v_add_f32 v24, 1.0, v24
  v_add_f32 v25, 1.0, v25
  v_add_f32 v26, 1.0, v26
  v_add_f32 v27, 1.0, v27
  v_rcp_f32 v24, v24
  v_rcp_f32 v25, v25
  v_rcp_f32 v26, v26
  v_rcp_f32 v27, v27
  v_pk_mul_f32 v[60:61], v[60:61], v[20:21]
  v_pk_mul_f32 v[62:63], v[62:63], v[22:23]
  v_pk_mul_f32 v[92:93], v[92:93], v[24:25]
  v_pk_mul_f32 v[94:95], v[94:95], v[26:27]
  v_cvt_pk_bf16_f32 v60, v60, v61
  v_cvt_pk_bf16_f32 v61, v62, v63
  v_cvt_pk_bf16_f32 v62, v92, v93
  v_cvt_pk_bf16_f32 v63, v94, v95
  buffer_store_dwordx4 v[60:63], v0, s[8:11], s3 offen offset:3072 sc1
  v_mul_f32 v20, s7, v96
  v_mul_f32 v21, s7, v97
  v_mul_f32 v22, s7, v98
  v_mul_f32 v23, s7, v99
  v_exp_f32 v20, v20
  v_exp_f32 v21, v21
  v_exp_f32 v22, v22
  v_exp_f32 v23, v23
  v_pk_mul_f32 v[96:97], v[96:97], v[224:225]
  v_pk_mul_f32 v[98:99], v[98:99], v[226:227]
  v_add_f32 v20, 1.0, v20
  v_add_f32 v21, 1.0, v21
  v_add_f32 v22, 1.0, v22
  v_add_f32 v23, 1.0, v23
  v_rcp_f32 v20, v20
  v_rcp_f32 v21, v21
  v_rcp_f32 v22, v22
  v_rcp_f32 v23, v23
  v_accvgpr_read_b32 v28, a0
  v_accvgpr_read_b32 v29, a1
  v_accvgpr_read_b32 v30, a2
  v_accvgpr_read_b32 v31, a3
  v_mul_f32 v24, s7, v128
  v_mul_f32 v25, s7, v129
  v_mul_f32 v26, s7, v130
  v_mul_f32 v27, s7, v131
  v_exp_f32 v24, v24
  v_exp_f32 v25, v25
  v_exp_f32 v26, v26
  v_exp_f32 v27, v27
  v_pk_mul_f32 v[128:129], v[128:129], v[28:29]
  v_pk_mul_f32 v[130:131], v[130:131], v[30:31]
  v_add_f32 v24, 1.0, v24
  v_add_f32 v25, 1.0, v25
  v_add_f32 v26, 1.0, v26
  v_add_f32 v27, 1.0, v27
  v_rcp_f32 v24, v24
  v_rcp_f32 v25, v25
  v_rcp_f32 v26, v26
  v_rcp_f32 v27, v27
  v_pk_mul_f32 v[96:97], v[96:97], v[20:21]
  v_pk_mul_f32 v[98:99], v[98:99], v[22:23]
  v_pk_mul_f32 v[128:129], v[128:129], v[24:25]
  v_pk_mul_f32 v[130:131], v[130:131], v[26:27]
  v_cvt_pk_bf16_f32 v96, v96, v97
  v_cvt_pk_bf16_f32 v97, v98, v99
  v_cvt_pk_bf16_f32 v98, v128, v129
  v_cvt_pk_bf16_f32 v99, v130, v131
  s_add_u32 s3, s6, 131072
  buffer_store_dwordx4 v[96:99], v0, s[8:11], s3 offen offset:0 sc1
  v_mul_f32 v20, s7, v100
  v_mul_f32 v21, s7, v101
  v_mul_f32 v22, s7, v102
  v_mul_f32 v23, s7, v103
  v_exp_f32 v20, v20
  v_exp_f32 v21, v21
  v_exp_f32 v22, v22
  v_exp_f32 v23, v23
  v_pk_mul_f32 v[100:101], v[100:101], v[228:229]
  v_pk_mul_f32 v[102:103], v[102:103], v[230:231]
  v_add_f32 v20, 1.0, v20
  v_add_f32 v21, 1.0, v21
  v_add_f32 v22, 1.0, v22
  v_add_f32 v23, 1.0, v23
  v_rcp_f32 v20, v20
  v_rcp_f32 v21, v21
  v_rcp_f32 v22, v22
  v_rcp_f32 v23, v23
  v_accvgpr_read_b32 v28, a4
  v_accvgpr_read_b32 v29, a5
  v_accvgpr_read_b32 v30, a6
  v_accvgpr_read_b32 v31, a7
  v_mul_f32 v24, s7, v132
  v_mul_f32 v25, s7, v133
  v_mul_f32 v26, s7, v134
  v_mul_f32 v27, s7, v135
  v_exp_f32 v24, v24
  v_exp_f32 v25, v25
  v_exp_f32 v26, v26
  v_exp_f32 v27, v27
  v_pk_mul_f32 v[132:133], v[132:133], v[28:29]
  v_pk_mul_f32 v[134:135], v[134:135], v[30:31]
  v_add_f32 v24, 1.0, v24
  v_add_f32 v25, 1.0, v25
  v_add_f32 v26, 1.0, v26
  v_add_f32 v27, 1.0, v27
  v_rcp_f32 v24, v24
  v_rcp_f32 v25, v25
  v_rcp_f32 v26, v26
  v_rcp_f32 v27, v27
  v_pk_mul_f32 v[100:101], v[100:101], v[20:21]
  v_pk_mul_f32 v[102:103], v[102:103], v[22:23]
  v_pk_mul_f32 v[132:133], v[132:133], v[24:25]
  v_pk_mul_f32 v[134:135], v[134:135], v[26:27]
  v_cvt_pk_bf16_f32 v100, v100, v101
  v_cvt_pk_bf16_f32 v101, v102, v103
  v_cvt_pk_bf16_f32 v102, v132, v133
  v_cvt_pk_bf16_f32 v103, v134, v135
  buffer_store_dwordx4 v[100:103], v0, s[8:11], s3 offen offset:1024 sc1
  v_mul_f32 v20, s7, v104
  v_mul_f32 v21, s7, v105
  v_mul_f32 v22, s7, v106
  v_mul_f32 v23, s7, v107
  v_exp_f32 v20, v20
  v_exp_f32 v21, v21
  v_exp_f32 v22, v22
  v_exp_f32 v23, v23
  v_pk_mul_f32 v[104:105], v[104:105], v[232:233]
  v_pk_mul_f32 v[106:107], v[106:107], v[234:235]
  v_add_f32 v20, 1.0, v20
  v_add_f32 v21, 1.0, v21
  v_add_f32 v22, 1.0, v22
  v_add_f32 v23, 1.0, v23
  v_rcp_f32 v20, v20
  v_rcp_f32 v21, v21
  v_rcp_f32 v22, v22
  v_rcp_f32 v23, v23
  v_accvgpr_read_b32 v28, a8
  v_accvgpr_read_b32 v29, a9
  v_accvgpr_read_b32 v30, a10
  v_accvgpr_read_b32 v31, a11
  v_mul_f32 v24, s7, v136
  v_mul_f32 v25, s7, v137
  v_mul_f32 v26, s7, v138
  v_mul_f32 v27, s7, v139
  v_exp_f32 v24, v24
  v_exp_f32 v25, v25
  v_exp_f32 v26, v26
  v_exp_f32 v27, v27
  v_pk_mul_f32 v[136:137], v[136:137], v[28:29]
  v_pk_mul_f32 v[138:139], v[138:139], v[30:31]
  v_add_f32 v24, 1.0, v24
  v_add_f32 v25, 1.0, v25
  v_add_f32 v26, 1.0, v26
  v_add_f32 v27, 1.0, v27
  v_rcp_f32 v24, v24
  v_rcp_f32 v25, v25
  v_rcp_f32 v26, v26
  v_rcp_f32 v27, v27
  v_pk_mul_f32 v[104:105], v[104:105], v[20:21]
  v_pk_mul_f32 v[106:107], v[106:107], v[22:23]
  v_pk_mul_f32 v[136:137], v[136:137], v[24:25]
  v_pk_mul_f32 v[138:139], v[138:139], v[26:27]
  v_cvt_pk_bf16_f32 v104, v104, v105
  v_cvt_pk_bf16_f32 v105, v106, v107
  v_cvt_pk_bf16_f32 v106, v136, v137
  v_cvt_pk_bf16_f32 v107, v138, v139
  buffer_store_dwordx4 v[104:107], v0, s[8:11], s3 offen offset:2048 sc1
  v_mul_f32 v20, s7, v108
  v_mul_f32 v21, s7, v109
  v_mul_f32 v22, s7, v110
  v_mul_f32 v23, s7, v111
  v_exp_f32 v20, v20
  v_exp_f32 v21, v21
  v_exp_f32 v22, v22
  v_exp_f32 v23, v23
  v_pk_mul_f32 v[108:109], v[108:109], v[236:237]
  v_pk_mul_f32 v[110:111], v[110:111], v[238:239]
  v_add_f32 v20, 1.0, v20
  v_add_f32 v21, 1.0, v21
  v_add_f32 v22, 1.0, v22
  v_add_f32 v23, 1.0, v23
  v_rcp_f32 v20, v20
  v_rcp_f32 v21, v21
  v_rcp_f32 v22, v22
  v_rcp_f32 v23, v23
  v_accvgpr_read_b32 v28, a12
  v_accvgpr_read_b32 v29, a13
  v_accvgpr_read_b32 v30, a14
  v_accvgpr_read_b32 v31, a15
  v_mul_f32 v24, s7, v140
  v_mul_f32 v25, s7, v141
  v_mul_f32 v26, s7, v142
  v_mul_f32 v27, s7, v143
  v_exp_f32 v24, v24
  v_exp_f32 v25, v25
  v_exp_f32 v26, v26
  v_exp_f32 v27, v27
  v_pk_mul_f32 v[140:141], v[140:141], v[28:29]
  v_pk_mul_f32 v[142:143], v[142:143], v[30:31]
  v_add_f32 v24, 1.0, v24
  v_add_f32 v25, 1.0, v25
  v_add_f32 v26, 1.0, v26
  v_add_f32 v27, 1.0, v27
  v_rcp_f32 v24, v24
  v_rcp_f32 v25, v25
  v_rcp_f32 v26, v26
  v_rcp_f32 v27, v27
  v_pk_mul_f32 v[108:109], v[108:109], v[20:21]
  v_pk_mul_f32 v[110:111], v[110:111], v[22:23]
  v_pk_mul_f32 v[140:141], v[140:141], v[24:25]
  v_pk_mul_f32 v[142:143], v[142:143], v[26:27]
  v_cvt_pk_bf16_f32 v108, v108, v109
  v_cvt_pk_bf16_f32 v109, v110, v111
  v_cvt_pk_bf16_f32 v110, v140, v141
  v_cvt_pk_bf16_f32 v111, v142, v143
  buffer_store_dwordx4 v[108:111], v0, s[8:11], s3 offen offset:3072 sc1
  v_mul_f32 v20, s7, v112
  v_mul_f32 v21, s7, v113
  v_mul_f32 v22, s7, v114
  v_mul_f32 v23, s7, v115
  v_exp_f32 v20, v20
  v_exp_f32 v21, v21
  v_exp_f32 v22, v22
  v_exp_f32 v23, v23
  v_pk_mul_f32 v[112:113], v[112:113], v[240:241]
  v_pk_mul_f32 v[114:115], v[114:115], v[242:243]
  v_add_f32 v20, 1.0, v20
  v_add_f32 v21, 1.0, v21
  v_add_f32 v22, 1.0, v22
  v_add_f32 v23, 1.0, v23
  v_rcp_f32 v20, v20
  v_rcp_f32 v21, v21
  v_rcp_f32 v22, v22
  v_rcp_f32 v23, v23
  v_accvgpr_read_b32 v28, a16
  v_accvgpr_read_b32 v29, a17
  v_accvgpr_read_b32 v30, a18
  v_accvgpr_read_b32 v31, a19
  v_mul_f32 v24, s7, v144
  v_mul_f32 v25, s7, v145
  v_mul_f32 v26, s7, v146
  v_mul_f32 v27, s7, v147
  v_exp_f32 v24, v24
  v_exp_f32 v25, v25
  v_exp_f32 v26, v26
  v_exp_f32 v27, v27
  v_pk_mul_f32 v[144:145], v[144:145], v[28:29]
  v_pk_mul_f32 v[146:147], v[146:147], v[30:31]
  v_add_f32 v24, 1.0, v24
  v_add_f32 v25, 1.0, v25
  v_add_f32 v26, 1.0, v26
  v_add_f32 v27, 1.0, v27
  v_rcp_f32 v24, v24
  v_rcp_f32 v25, v25
  v_rcp_f32 v26, v26
  v_rcp_f32 v27, v27
  v_pk_mul_f32 v[112:113], v[112:113], v[20:21]
  v_pk_mul_f32 v[114:115], v[114:115], v[22:23]
  v_pk_mul_f32 v[144:145], v[144:145], v[24:25]
  v_pk_mul_f32 v[146:147], v[146:147], v[26:27]
  v_cvt_pk_bf16_f32 v112, v112, v113
  v_cvt_pk_bf16_f32 v113, v114, v115
  v_cvt_pk_bf16_f32 v114, v144, v145
  v_cvt_pk_bf16_f32 v115, v146, v147
  s_add_u32 s3, s6, 135168
  buffer_store_dwordx4 v[112:115], v0, s[8:11], s3 offen offset:0 sc1
  v_mul_f32 v20, s7, v116
  v_mul_f32 v21, s7, v117
  v_mul_f32 v22, s7, v118
  v_mul_f32 v23, s7, v119
  v_exp_f32 v20, v20
  v_exp_f32 v21, v21
  v_exp_f32 v22, v22
  v_exp_f32 v23, v23
  v_pk_mul_f32 v[116:117], v[116:117], v[244:245]
  v_pk_mul_f32 v[118:119], v[118:119], v[246:247]
  v_add_f32 v20, 1.0, v20
  v_add_f32 v21, 1.0, v21
  v_add_f32 v22, 1.0, v22
  v_add_f32 v23, 1.0, v23
  v_rcp_f32 v20, v20
  v_rcp_f32 v21, v21
  v_rcp_f32 v22, v22
  v_rcp_f32 v23, v23
  v_accvgpr_read_b32 v28, a20
  v_accvgpr_read_b32 v29, a21
  v_accvgpr_read_b32 v30, a22
  v_accvgpr_read_b32 v31, a23
  v_mul_f32 v24, s7, v148
  v_mul_f32 v25, s7, v149
  v_mul_f32 v26, s7, v150
  v_mul_f32 v27, s7, v151
  v_exp_f32 v24, v24
  v_exp_f32 v25, v25
  v_exp_f32 v26, v26
  v_exp_f32 v27, v27
  v_pk_mul_f32 v[148:149], v[148:149], v[28:29]
  v_pk_mul_f32 v[150:151], v[150:151], v[30:31]
  v_add_f32 v24, 1.0, v24
  v_add_f32 v25, 1.0, v25
  v_add_f32 v26, 1.0, v26
  v_add_f32 v27, 1.0, v27
  v_rcp_f32 v24, v24
  v_rcp_f32 v25, v25
  v_rcp_f32 v26, v26
  v_rcp_f32 v27, v27
  v_pk_mul_f32 v[116:117], v[116:117], v[20:21]
  v_pk_mul_f32 v[118:119], v[118:119], v[22:23]
  v_pk_mul_f32 v[148:149], v[148:149], v[24:25]
  v_pk_mul_f32 v[150:151], v[150:151], v[26:27]
  v_cvt_pk_bf16_f32 v116, v116, v117
  v_cvt_pk_bf16_f32 v117, v118, v119
  v_cvt_pk_bf16_f32 v118, v148, v149
  v_cvt_pk_bf16_f32 v119, v150, v151
  buffer_store_dwordx4 v[116:119], v0, s[8:11], s3 offen offset:1024 sc1
  v_mul_f32 v20, s7, v120
  v_mul_f32 v21, s7, v121
  v_mul_f32 v22, s7, v122
  v_mul_f32 v23, s7, v123
  v_exp_f32 v20, v20
  v_exp_f32 v21, v21
  v_exp_f32 v22, v22
  v_exp_f32 v23, v23
  v_pk_mul_f32 v[120:121], v[120:121], v[248:249]
  v_pk_mul_f32 v[122:123], v[122:123], v[250:251]
  v_add_f32 v20, 1.0, v20
  v_add_f32 v21, 1.0, v21
  v_add_f32 v22, 1.0, v22
  v_add_f32 v23, 1.0, v23
  v_rcp_f32 v20, v20
  v_rcp_f32 v21, v21
  v_rcp_f32 v22, v22
  v_rcp_f32 v23, v23
  v_accvgpr_read_b32 v28, a24
  v_accvgpr_read_b32 v29, a25
  v_accvgpr_read_b32 v30, a26
  v_accvgpr_read_b32 v31, a27
  v_mul_f32 v24, s7, v152
  v_mul_f32 v25, s7, v153
  v_mul_f32 v26, s7, v154
  v_mul_f32 v27, s7, v155
  v_exp_f32 v24, v24
  v_exp_f32 v25, v25
  v_exp_f32 v26, v26
  v_exp_f32 v27, v27
  v_pk_mul_f32 v[152:153], v[152:153], v[28:29]
  v_pk_mul_f32 v[154:155], v[154:155], v[30:31]
  v_add_f32 v24, 1.0, v24
  v_add_f32 v25, 1.0, v25
  v_add_f32 v26, 1.0, v26
  v_add_f32 v27, 1.0, v27
  v_rcp_f32 v24, v24
  v_rcp_f32 v25, v25
  v_rcp_f32 v26, v26
  v_rcp_f32 v27, v27
  v_pk_mul_f32 v[120:121], v[120:121], v[20:21]
  v_pk_mul_f32 v[122:123], v[122:123], v[22:23]
  v_pk_mul_f32 v[152:153], v[152:153], v[24:25]
  v_pk_mul_f32 v[154:155], v[154:155], v[26:27]
  v_cvt_pk_bf16_f32 v120, v120, v121
  v_cvt_pk_bf16_f32 v121, v122, v123
  v_cvt_pk_bf16_f32 v122, v152, v153
  v_cvt_pk_bf16_f32 v123, v154, v155
  buffer_store_dwordx4 v[120:123], v0, s[8:11], s3 offen offset:2048 sc1
  v_mul_f32 v20, s7, v124
  v_mul_f32 v21, s7, v125
  v_mul_f32 v22, s7, v126
  v_mul_f32 v23, s7, v127
  v_exp_f32 v20, v20
  v_exp_f32 v21, v21
  v_exp_f32 v22, v22
  v_exp_f32 v23, v23
  v_pk_mul_f32 v[124:125], v[124:125], v[252:253]
  v_pk_mul_f32 v[126:127], v[126:127], v[254:255]
  v_add_f32 v20, 1.0, v20
  v_add_f32 v21, 1.0, v21
  v_add_f32 v22, 1.0, v22
  v_add_f32 v23, 1.0, v23
  v_rcp_f32 v20, v20
  v_rcp_f32 v21, v21
  v_rcp_f32 v22, v22
  v_rcp_f32 v23, v23
  v_accvgpr_read_b32 v28, a28
  v_accvgpr_read_b32 v29, a29
  v_accvgpr_read_b32 v30, a30
  v_accvgpr_read_b32 v31, a31
  v_mul_f32 v24, s7, v156
  v_mul_f32 v25, s7, v157
  v_mul_f32 v26, s7, v158
  v_mul_f32 v27, s7, v159
  v_exp_f32 v24, v24
  v_exp_f32 v25, v25
  v_exp_f32 v26, v26
  v_exp_f32 v27, v27
  v_pk_mul_f32 v[156:157], v[156:157], v[28:29]
  v_pk_mul_f32 v[158:159], v[158:159], v[30:31]
  v_add_f32 v24, 1.0, v24
  v_add_f32 v25, 1.0, v25
  v_add_f32 v26, 1.0, v26
  v_add_f32 v27, 1.0, v27
  v_rcp_f32 v24, v24
  v_rcp_f32 v25, v25
  v_rcp_f32 v26, v26
  v_rcp_f32 v27, v27
  v_pk_mul_f32 v[124:125], v[124:125], v[20:21]
  v_pk_mul_f32 v[126:127], v[126:127], v[22:23]
  v_pk_mul_f32 v[156:157], v[156:157], v[24:25]
  v_pk_mul_f32 v[158:159], v[158:159], v[26:27]
  v_cvt_pk_bf16_f32 v124, v124, v125
  v_cvt_pk_bf16_f32 v125, v126, v127
  v_cvt_pk_bf16_f32 v126, v156, v157
  v_cvt_pk_bf16_f32 v127, v158, v159
  buffer_store_dwordx4 v[124:127], v0, s[8:11], s3 offen offset:3072 sc1
  s_branch G8_done
G4_cold:
  s_mul_i32 s41, s27, 2048
  s_lshl_b32 s42, s27, 12
  s_add_u32 s42, s42, 16384
  v_add_u32 v11, s41, v0
  s_mul_i32 s3, s28, 4096
  v_add_u32 v1, s3, v0
  s_bfe_u32 s4, s30, 262152
  s_bfe_u32 s5, s30, 393228
  s_bfe_u32 s20, s30, 0x50007
  s_lshl_b32 s20, s20, 12
  s_mov_b32 s18, s10
  s_mov_b32 s40, 32
  s_and_b32 s3, s30, 7
  s_cmp_eq_u32 s3, 2
  s_cbranch_scc1 SLG4c_v
  s_cmp_eq_u32 s3, 3
  s_cbranch_scc1 SLG4c_fu
  s_cmp_eq_u32 s3, 4
  s_cbranch_scc1 SLG4c_fd
  s_cmp_eq_u32 s3, 5
  s_cbranch_scc1 SLG4c_wo
  s_cmp_eq_u32 s28, 0
  s_cselect_b32 s12, s60, s62
  s_cselect_b32 s13, s61, s63
  s_mov_b32 s14, 8388608
  s_mov_b32 s22, 262144
  s_lshl_b32 s21, s5, 8
  v_mul_u32_u24 v18, 8192, v16
  v_xor_b32 v20, 0x80, v17
  v_add_u32 v12, v18, v17
  v_add_u32 v13, v18, v20
  v_add_u32 v13, 31744, v13
  v_add_u32 v14, 63488, v12
  v_add_u32 v15, 63488, v13
  s_branch SLG4c_done
SLG4c_v:
  s_mov_b32 s12, s64
  s_mov_b32 s13, s65
  s_mov_b32 s14, 8388608
  s_mov_b32 s22, 262144
  s_lshl_b32 s21, s5, 9
  s_lshl_b32 s3, s28, 8
  s_add_u32 s21, s21, s3
  v_mul_u32_u24 v18, 8192, v16
  v_xor_b32 v20, 0x80, v17
  v_add_u32 v12, v18, v17
  v_add_u32 v13, v18, v20
  v_add_u32 v13, 31744, v13
  v_add_u32 v14, 63488, v12
  v_add_u32 v15, 63488, v13
  s_branch SLG4c_done
SLG4c_fu:
  s_cmp_eq_u32 s28, 0
  s_cselect_b32 s12, s72, s74
  s_cselect_b32 s13, s73, s75
  s_mov_b32 s14, 7340032
  s_mov_b32 s22, 229376
  s_lshl_b32 s21, s5, 8
  v_mul_u32_u24 v18, 7168, v16
  v_xor_b32 v20, 0x80, v17
  v_add_u32 v12, v18, v17
  v_add_u32 v13, v18, v20
  v_add_u32 v13, 27648, v13
  v_add_u32 v14, 55296, v12
  v_add_u32 v15, 55296, v13
  s_branch SLG4c_done
SLG4c_fd:
  s_mov_b32 s12, s76
  s_mov_b32 s13, s77
  s_mov_b32 s14, 7340032
  s_mov_b32 s22, 65536
  s_lshl_b32 s21, s5, 9
  s_lshl_b32 s3, s28, 8
  s_add_u32 s21, s21, s3
  s_add_u32 s20, s20, 54525952
  s_mov_b32 s40, 112
  v_mul_u32_u24 v18, 2048, v16
  v_xor_b32 v20, 0x80, v17
  v_add_u32 v12, v18, v17
  v_add_u32 v13, v18, v20
  v_add_u32 v13, 7168, v13
  v_add_u32 v14, 14336, v12
  v_add_u32 v15, 14336, v13
  s_branch SLG4c_done
SLG4c_wo:
  s_mov_b32 s12, s66
  s_mov_b32 s13, s67
  s_mov_b32 s14, 8388608
  s_mov_b32 s22, 65536
  s_lshl_b32 s21, s5, 9
  s_lshl_b32 s3, s28, 8
  s_add_u32 s21, s21, s3
  s_bfe_u32 s3, s30, 262162
  s_lshl_b32 s4, s3, 19
  s_add_u32 s21, s21, s4
  s_lshl_b32 s4, s3, 20
  s_add_u32 s20, s20, s4
  s_add_u32 s20, s20, 69206016
  s_bfe_u32 s40, s30, 262166
  s_add_u32 s40, s40, 1
  s_lshl_b32 s40, s40, 3
  v_mul_u32_u24 v18, 2048, v16
  v_xor_b32 v20, 0x80, v17
  v_add_u32 v12, v18, v17
  v_add_u32 v13, v18, v20
  v_add_u32 v13, 7168, v13
  v_add_u32 v14, 14336, v12
  v_add_u32 v15, 14336, v13
SLG4c_done:
  s_mov_b32 s24, 0
  s_mov_b32 s25, 0
  s_add_u32 m0, s24, s42
  s_nop 0
  buffer_load_dwordx4 v12, s[12:15], s21 offen offset:0 lds
  buffer_load_dwordx4 v13, s[12:15], s21 offen offset:1024 lds
  buffer_load_dwordx4 v14, s[12:15], s21 offen offset:2048 lds
  buffer_load_dwordx4 v15, s[12:15], s21 offen offset:3072 lds
  s_add_u32 s21, s21, s22
  s_add_u32 s24, s24, 32768
  s_and_b32 s24, s24, 131071
  s_add_u32 m0, s24, s42
  s_nop 0
  buffer_load_dwordx4 v12, s[12:15], s21 offen offset:0 lds
  buffer_load_dwordx4 v13, s[12:15], s21 offen offset:1024 lds
  buffer_load_dwordx4 v14, s[12:15], s21 offen offset:2048 lds
  buffer_load_dwordx4 v15, s[12:15], s21 offen offset:3072 lds
  s_add_u32 s21, s21, s22
  s_add_u32 s24, s24, 32768
  s_and_b32 s24, s24, 131071
  s_add_u32 m0, s24, s42
  s_nop 0
  buffer_load_dwordx4 v12, s[12:15], s21 offen offset:0 lds
  buffer_load_dwordx4 v13, s[12:15], s21 offen offset:1024 lds
  buffer_load_dwordx4 v14, s[12:15], s21 offen offset:2048 lds
  buffer_load_dwordx4 v15, s[12:15], s21 offen offset:3072 lds
  s_add_u32 s21, s21, s22
  s_add_u32 s24, s24, 32768
  s_and_b32 s24, s24, 131071
  s_cmp_lg_u32 s87, 0
  s_cbranch_scc1 DW_14_x
  s_and_b32 s3, s30, 0xf07
  s_cmp_gt_u32 s3, 2
  s_cbranch_scc1 DW_14_all
  s_and_b32 s3, s30, 0x48
  s_cbranch_scc0 DW_14_all
  s_cmp_lg_u32 s27, 0
  s_cbranch_scc1 Wx0_15_ok
  s_mov_b32 s4, 0
Wx0_15:
  buffer_load_dword v18, off, s[68:71], 0 offset:140 sc1
  s_add_u32 s4, s4, 1
  s_cmp_gt_u32 s4, 65536
  s_cbranch_scc1 L_abort
  s_waitcnt vmcnt(0)
  v_readfirstlane_b32 s3, v18
  s_cmp_ge_u32 s3, 9
  s_cbranch_scc1 Wx0_15_ok
  s_sleep 2
  s_branch Wx0_15
Wx0_15_ok:
  s_barrier
  s_branch DW_14
DW_14_all:
  s_cmp_lg_u32 s27, 0
  s_cbranch_scc1 Wxn_16_ok
  s_mov_b32 s4, 0
Wxn_16:
  buffer_load_dword v18, off, s[68:71], 0 offset:132 sc1
  s_add_u32 s4, s4, 1
  s_cmp_gt_u32 s4, 65536
  s_cbranch_scc1 L_abort
  s_waitcnt vmcnt(0)
  v_readfirstlane_b32 s3, v18
  s_cmp_ge_u32 s3, 1
  s_cbranch_scc1 Wxn_16_ok
  s_sleep 2
  s_branch Wxn_16
Wxn_16_ok:
  s_barrier
  s_mov_b32 s87, 1
DW_14_x:
  s_and_b32 s3, s30, 7
  s_cmp_lt_u32 s3, 4
  s_cbranch_scc1 DW_14
  s_bfe_u32 s7, s30, 262152
  s_cmp_eq_u32 s3, 4
  s_cbranch_scc0 DW_14_o
  s_lshl_b32 s7, s7, 7
  s_add_u32 s7, s7, 99616768
  s_cmp_lg_u32 s27, 0
  s_cbranch_scc1 Wdep_17_ok
  s_mov_b32 s4, 0
Wdep_17:
  buffer_load_dword v18, off, s[8:11], s7 offset:0 sc1
  s_add_u32 s4, s4, 1
  s_cmp_gt_u32 s4, 65536
  s_cbranch_scc1 L_abort
  s_waitcnt vmcnt(0)
  v_readfirstlane_b32 s3, v18
  s_cmp_ge_u32 s3, 28
  s_cbranch_scc1 Wdep_17_ok
  s_sleep 8
  s_branch Wdep_17
Wdep_17_ok:
  s_barrier
  s_branch DW_14
DW_14_o:
  s_cmp_lg_u32 s27, 0
  s_cbranch_scc1 DW_14_b
  s_bfe_u32 s5, s30, 262162
  s_lshl_b32 s5, s5, 8
  s_add_u32 s5, s5, 99618816
  s_lshr_b32 s3, s40, 2
  s_bfm_b64 exec, s3, 0
  v_lshlrev_b32 v19, 3, v0
  s_mov_b32 s4, 0
DW_14_p:
  buffer_load_dword v18, v19, s[8:11], s5 offen sc1
  s_add_u32 s4, s4, 1
  s_cmp_gt_u32 s4, 65536
  s_cbranch_scc1 L_abort
  s_waitcnt vmcnt(0)
  v_cmp_ge_u32 vcc, s7, v18
  s_cbranch_vccz DW_14_q
  v_cmp_gt_u32 vcc, s7, v18
  s_cbranch_vccz DW_14_r
  s_sleep 127
DW_14_r:
  s_sleep 3
  s_branch DW_14_p
DW_14_q:
  s_mov_b64 exec, -1
DW_14_b:
  s_barrier
DW_14:
  s_add_u32 m0, s41, 0
  s_nop 0
  buffer_load_dwordx4 v11, s[16:19], s20 offen offset:0 sc1 lds
  buffer_load_dwordx4 v11, s[16:19], s20 offen offset:1024 sc1 lds
  s_add_u32 s20, s20, 131072
  s_add_u32 m0, s41, 32768
  s_nop 0
  buffer_load_dwordx4 v11, s[16:19], s20 offen offset:0 sc1 lds
  buffer_load_dwordx4 v11, s[16:19], s20 offen offset:1024 sc1 lds
  s_add_u32 s20, s20, 131072
  s_add_u32 m0, s41, 65536
  s_nop 0
  buffer_load_dwordx4 v11, s[16:19], s20 offen offset:0 sc1 lds
  buffer_load_dwordx4 v11, s[16:19], s20 offen offset:1024 sc1 lds
  s_add_u32 s20, s20, 131072
  s_add_u32 m0, s41, 98304
  s_nop 0
  buffer_load_dwordx4 v11, s[16:19], s20 offen offset:0 sc1 lds
  buffer_load_dwordx4 v11, s[16:19], s20 offen offset:1024 sc1 lds
  s_add_u32 s20, s20, 131072
  v_mov_b32 v6, v1
  v_mov_b32 v7, v2
  v_mov_b32 v8, v3
  v_mov_b32 v9, v4
  v_mov_b32 v10, v5
  s_waitcnt vmcnt(2)
  s_barrier
  ds_read_b64_tr_b16 a[32:33], v7 offset:16384
  ds_read_b64_tr_b16 a[34:35], v7 offset:20480
  ds_read_b64_tr_b16 a[36:37], v8 offset:16384
  ds_read_b64_tr_b16 a[38:39], v8 offset:20480
  ds_read_b64_tr_b16 a[40:41], v9 offset:16384
  ds_read_b64_tr_b16 a[42:43], v9 offset:20480
  ds_read_b64_tr_b16 a[44:45], v10 offset:16384
  ds_read_b64_tr_b16 a[46:47], v10 offset:20480
  ds_read_b128 a[64:67], v6 offset:0
  ds_read_b128 a[68:71], v6 offset:1024
  ds_read_b128 a[72:75], v6 offset:2048
  ds_read_b128 a[76:79], v6 offset:3072
G4_task:
  s_sub_u32 s32, s40, 5
  s_sub_u32 s33, s40, 1
  s_cmp_lg_u32 s35, 0
  s_cselect_b32 s43, 3, s32
  s_waitcnt lgkmcnt(0)
  v_mfma_f32_16x16x32_bf16 v[32:35], a[32:35], a[64:67], 0
  ds_read_b64_tr_b16 a[48:49], v7 offset:24576
  ds_read_b64_tr_b16 a[50:51], v7 offset:28672
  v_mfma_f32_16x16x32_bf16 v[36:39], a[32:35], a[68:71], 0
  ds_read_b64_tr_b16 a[52:53], v8 offset:24576
  ds_read_b64_tr_b16 a[54:55], v8 offset:28672
  v_mfma_f32_16x16x32_bf16 v[40:43], a[32:35], a[72:75], 0
  ds_read_b64_tr_b16 a[56:57], v9 offset:24576
  ds_read_b64_tr_b16 a[58:59], v9 offset:28672
  v_mfma_f32_16x16x32_bf16 v[44:47], a[32:35], a[76:79], 0
  ds_read_b64_tr_b16 a[60:61], v10 offset:24576
  ds_read_b64_tr_b16 a[62:63], v10 offset:28672
  v_mfma_f32_16x16x32_bf16 v[48:51], a[36:39], a[64:67], 0
  s_add_u32 s25, s25, 32768
  s_and_b32 s25, s25, 131071
  v_add_u32 v6, s25, v1
  v_mfma_f32_16x16x32_bf16 v[52:55], a[36:39], a[68:71], 0
  v_add_u32 v7, s25, v2
  v_add_u32 v8, s25, v3
  v_mfma_f32_16x16x32_bf16 v[56:59], a[36:39], a[72:75], 0
  v_add_u32 v9, s25, v4
  v_add_u32 v10, s25, v5
  v_mfma_f32_16x16x32_bf16 v[60:63], a[36:39], a[76:79], 0
  s_add_u32 m0, s24, s42
  v_mfma_f32_16x16x32_bf16 v[64:67], a[40:43], a[64:67], 0
  buffer_load_dwordx4 v12, s[12:15], s21 offen offset:0 lds
  v_mfma_f32_16x16x32_bf16 v[68:71], a[40:43], a[68:71], 0
  v_mfma_f32_16x16x32_bf16 v[72:75], a[40:43], a[72:75], 0
  buffer_load_dwordx4 v13, s[12:15], s21 offen offset:1024 lds
  v_mfma_f32_16x16x32_bf16 v[76:79], a[40:43], a[76:79], 0
  v_mfma_f32_16x16x32_bf16 v[80:83], a[44:47], a[64:67], 0
  buffer_load_dwordx4 v14, s[12:15], s21 offen offset:2048 lds
  v_mfma_f32_16x16x32_bf16 v[84:87], a[44:47], a[68:71], 0
  v_mfma_f32_16x16x32_bf16 v[88:91], a[44:47], a[72:75], 0
  buffer_load_dwordx4 v15, s[12:15], s21 offen offset:3072 lds
  v_mfma_f32_16x16x32_bf16 v[92:95], a[44:47], a[76:79], 0
  s_add_u32 s21, s21, s22
  s_add_u32 s24, s24, 32768
  s_and_b32 s24, s24, 131071
  s_waitcnt lgkmcnt(0) vmcnt(12)
  s_barrier
  v_mfma_f32_16x16x32_bf16 v[96:99], a[48:51], a[64:67], 0
  ds_read_b64_tr_b16 a[32:33], v7 offset:16384
  ds_read_b64_tr_b16 a[34:35], v7 offset:20480
  v_mfma_f32_16x16x32_bf16 v[100:103], a[48:51], a[68:71], 0
  ds_read_b128 a[96:99], v6 offset:0
  ds_read_b128 a[100:103], v6 offset:1024
  v_mfma_f32_16x16x32_bf16 v[104:107], a[48:51], a[72:75], 0
  ds_read_b128 a[104:107], v6 offset:2048
  ds_read_b128 a[108:111], v6 offset:3072
  v_mfma_f32_16x16x32_bf16 v[108:111], a[48:51], a[76:79], 0
  ds_read_b64_tr_b16 a[36:37], v8 offset:16384
  ds_read_b64_tr_b16 a[38:39], v8 offset:20480
  v_mfma_f32_16x16x32_bf16 v[112:115], a[52:55], a[64:67], 0
  ds_read_b64_tr_b16 a[40:41], v9 offset:16384
  ds_read_b64_tr_b16 a[42:43], v9 offset:20480
  v_mfma_f32_16x16x32_bf16 v[116:119], a[52:55], a[68:71], 0
  ds_read_b64_tr_b16 a[44:45], v10 offset:16384
  ds_read_b64_tr_b16 a[46:47], v10 offset:20480
  v_mfma_f32_16x16x32_bf16 v[120:123], a[52:55], a[72:75], 0
  v_mfma_f32_16x16x32_bf16 v[124:127], a[52:55], a[76:79], 0
  v_mfma_f32_16x16x32_bf16 v[128:131], a[56:59], a[64:67], 0
  s_add_u32 m0, s24, s41
  v_mfma_f32_16x16x32_bf16 v[132:135], a[56:59], a[68:71], 0
  buffer_load_dwordx4 v11, s[16:19], s20 offen offset:0 sc1 lds
  v_mfma_f32_16x16x32_bf16 v[136:139], a[56:59], a[72:75], 0
  v_mfma_f32_16x16x32_bf16 v[140:143], a[56:59], a[76:79], 0
  v_mfma_f32_16x16x32_bf16 v[144:147], a[60:63], a[64:67], 0
  v_mfma_f32_16x16x32_bf16 v[148:151], a[60:63], a[68:71], 0
  buffer_load_dwordx4 v11, s[16:19], s20 offen offset:1024 sc1 lds
  v_mfma_f32_16x16x32_bf16 v[152:155], a[60:63], a[72:75], 0
  v_mfma_f32_16x16x32_bf16 v[156:159], a[60:63], a[76:79], 0
  s_add_u32 s20, s20, 131072
  s_waitcnt lgkmcnt(0)
  v_mfma_f32_16x16x32_bf16 v[32:35], a[32:35], a[96:99], v[32:35]
  ds_read_b64_tr_b16 a[48:49], v7 offset:24576
  ds_read_b64_tr_b16 a[50:51], v7 offset:28672
  v_mfma_f32_16x16x32_bf16 v[36:39], a[32:35], a[100:103], v[36:39]
  ds_read_b64_tr_b16 a[52:53], v8 offset:24576
  ds_read_b64_tr_b16 a[54:55], v8 offset:28672
  v_mfma_f32_16x16x32_bf16 v[40:43], a[32:35], a[104:107], v[40:43]
  ds_read_b64_tr_b16 a[56:57], v9 offset:24576
  ds_read_b64_tr_b16 a[58:59], v9 offset:28672
  v_mfma_f32_16x16x32_bf16 v[44:47], a[32:35], a[108:111], v[44:47]
  ds_read_b64_tr_b16 a[60:61], v10 offset:24576
  ds_read_b64_tr_b16 a[62:63], v10 offset:28672
  v_mfma_f32_16x16x32_bf16 v[48:51], a[36:39], a[96:99], v[48:51]
  s_add_u32 s25, s25, 32768
  s_and_b32 s25, s25, 131071
  v_add_u32 v6, s25, v1
  v_mfma_f32_16x16x32_bf16 v[52:55], a[36:39], a[100:103], v[52:55]
  v_add_u32 v7, s25, v2
  v_add_u32 v8, s25, v3
  v_mfma_f32_16x16x32_bf16 v[56:59], a[36:39], a[104:107], v[56:59]
  v_add_u32 v9, s25, v4
  v_add_u32 v10, s25, v5
  v_mfma_f32_16x16x32_bf16 v[60:63], a[36:39], a[108:111], v[60:63]
  s_add_u32 m0, s24, s42
  v_mfma_f32_16x16x32_bf16 v[64:67], a[40:43], a[96:99], v[64:67]
  buffer_load_dwordx4 v12, s[12:15], s21 offen offset:0 lds
  v_mfma_f32_16x16x32_bf16 v[68:71], a[40:43], a[100:103], v[68:71]
  v_mfma_f32_16x16x32_bf16 v[72:75], a[40:43], a[104:107], v[72:75]
  buffer_load_dwordx4 v13, s[12:15], s21 offen offset:1024 lds
  v_mfma_f32_16x16x32_bf16 v[76:79], a[40:43], a[108:111], v[76:79]
  v_mfma_f32_16x16x32_bf16 v[80:83], a[44:47], a[96:99], v[80:83]
  buffer_load_dwordx4 v14, s[12:15], s21 offen offset:2048 lds
  v_mfma_f32_16x16x32_bf16 v[84:87], a[44:47], a[100:103], v[84:87]
  v_mfma_f32_16x16x32_bf16 v[88:91], a[44:47], a[104:107], v[88:91]
  buffer_load_dwordx4 v15, s[12:15], s21 offen offset:3072 lds
  v_mfma_f32_16x16x32_bf16 v[92:95], a[44:47], a[108:111], v[92:95]
  s_add_u32 s21, s21, s22
  s_add_u32 s24, s24, 32768
  s_and_b32 s24, s24, 131071
  s_mov_b32 s26, 1
.p2align 6
G4_loop:
  s_waitcnt lgkmcnt(0) vmcnt(12)
  s_barrier
  v_mfma_f32_16x16x32_bf16 v[96:99], a[48:51], a[96:99], v[96:99]
  ds_read_b64_tr_b16 a[32:33], v7 offset:16384
  ds_read_b64_tr_b16 a[34:35], v7 offset:20480
  v_mfma_f32_16x16x32_bf16 v[100:103], a[48:51], a[100:103], v[100:103]
  ds_read_b128 a[64:67], v6 offset:0
  ds_read_b128 a[68:71], v6 offset:1024
  v_mfma_f32_16x16x32_bf16 v[104:107], a[48:51], a[104:107], v[104:107]
  ds_read_b128 a[72:75], v6 offset:2048
  ds_read_b128 a[76:79], v6 offset:3072
  v_mfma_f32_16x16x32_bf16 v[108:111], a[48:51], a[108:111], v[108:111]
  ds_read_b64_tr_b16 a[36:37], v8 offset:16384
  ds_read_b64_tr_b16 a[38:39], v8 offset:20480
  v_mfma_f32_16x16x32_bf16 v[112:115], a[52:55], a[96:99], v[112:115]
  ds_read_b64_tr_b16 a[40:41], v9 offset:16384
  ds_read_b64_tr_b16 a[42:43], v9 offset:20480
  v_mfma_f32_16x16x32_bf16 v[116:119], a[52:55], a[100:103], v[116:119]
  ds_read_b64_tr_b16 a[44:45], v10 offset:16384
  ds_read_b64_tr_b16 a[46:47], v10 offset:20480
  v_mfma_f32_16x16x32_bf16 v[120:123], a[52:55], a[104:107], v[120:123]
  v_mfma_f32_16x16x32_bf16 v[124:127], a[52:55], a[108:111], v[124:127]
  v_mfma_f32_16x16x32_bf16 v[128:131], a[56:59], a[96:99], v[128:131]
  s_add_u32 m0, s24, s41
  v_mfma_f32_16x16x32_bf16 v[132:135], a[56:59], a[100:103], v[132:135]
  buffer_load_dwordx4 v11, s[16:19], s20 offen offset:0 sc1 lds
  v_mfma_f32_16x16x32_bf16 v[136:139], a[56:59], a[104:107], v[136:139]
  v_mfma_f32_16x16x32_bf16 v[140:143], a[56:59], a[108:111], v[140:143]
  v_mfma_f32_16x16x32_bf16 v[144:147], a[60:63], a[96:99], v[144:147]
  v_mfma_f32_16x16x32_bf16 v[148:151], a[60:63], a[100:103], v[148:151]
  buffer_load_dwordx4 v11, s[16:19], s20 offen offset:1024 sc1 lds
  v_mfma_f32_16x16x32_bf16 v[152:155], a[60:63], a[104:107], v[152:155]
  v_mfma_f32_16x16x32_bf16 v[156:159], a[60:63], a[108:111], v[156:159]
  s_add_u32 s20, s20, 131072
  s_cmp_eq_u32 s26, s33
  s_cbranch_scc1 G4_epi
  s_waitcnt lgkmcnt(0)
  v_mfma_f32_16x16x32_bf16 v[32:35], a[32:35], a[64:67], v[32:35]
  ds_read_b64_tr_b16 a[48:49], v7 offset:24576
  ds_read_b64_tr_b16 a[50:51], v7 offset:28672
  v_mfma_f32_16x16x32_bf16 v[36:39], a[32:35], a[68:71], v[36:39]
  ds_read_b64_tr_b16 a[52:53], v8 offset:24576
  ds_read_b64_tr_b16 a[54:55], v8 offset:28672
  v_mfma_f32_16x16x32_bf16 v[40:43], a[32:35], a[72:75], v[40:43]
  ds_read_b64_tr_b16 a[56:57], v9 offset:24576
  ds_read_b64_tr_b16 a[58:59], v9 offset:28672
  v_mfma_f32_16x16x32_bf16 v[44:47], a[32:35], a[76:79], v[44:47]
  ds_read_b64_tr_b16 a[60:61], v10 offset:24576
  ds_read_b64_tr_b16 a[62:63], v10 offset:28672
  v_mfma_f32_16x16x32_bf16 v[48:51], a[36:39], a[64:67], v[48:51]
  s_add_u32 s25, s25, 32768
  s_and_b32 s25, s25, 131071
  v_add_u32 v6, s25, v1
  v_mfma_f32_16x16x32_bf16 v[52:55], a[36:39], a[68:71], v[52:55]
  v_add_u32 v7, s25, v2
  v_add_u32 v8, s25, v3
  v_mfma_f32_16x16x32_bf16 v[56:59], a[36:39], a[72:75], v[56:59]
  v_add_u32 v9, s25, v4
  v_add_u32 v10, s25, v5
  v_mfma_f32_16x16x32_bf16 v[60:63], a[36:39], a[76:79], v[60:63]
  s_add_u32 m0, s24, s42
  v_mfma_f32_16x16x32_bf16 v[64:67], a[40:43], a[64:67], v[64:67]
  buffer_load_dwordx4 v12, s[12:15], s21 offen offset:0 lds
  v_mfma_f32_16x16x32_bf16 v[68:71], a[40:43], a[68:71], v[68:71]
  v_mfma_f32_16x16x32_bf16 v[72:75], a[40:43], a[72:75], v[72:75]
  buffer_load_dwordx4 v13, s[12:15], s21 offen offset:1024 lds
  v_mfma_f32_16x16x32_bf16 v[76:79], a[40:43], a[76:79], v[76:79]
  v_mfma_f32_16x16x32_bf16 v[80:83], a[44:47], a[64:67], v[80:83]
  buffer_load_dwordx4 v14, s[12:15], s21 offen offset:2048 lds
  v_mfma_f32_16x16x32_bf16 v[84:87], a[44:47], a[68:71], v[84:87]
  v_mfma_f32_16x16x32_bf16 v[88:91], a[44:47], a[72:75], v[88:91]
  buffer_load_dwordx4 v15, s[12:15], s21 offen offset:3072 lds
  v_mfma_f32_16x16x32_bf16 v[92:95], a[44:47], a[76:79], v[92:95]
  s_add_u32 s21, s21, s22
  s_add_u32 s24, s24, 32768
  s_and_b32 s24, s24, 131071
  s_cmp_eq_u32 s26, s43
  s_cbranch_scc1 G4_event
G4_back:
  s_waitcnt lgkmcnt(0) vmcnt(12)
  s_barrier
  v_mfma_f32_16x16x32_bf16 v[96:99], a[48:51], a[64:67], v[96:99]
  ds_read_b64_tr_b16 a[32:33], v7 offset:16384
  ds_read_b64_tr_b16 a[34:35], v7 offset:20480
  v_mfma_f32_16x16x32_bf16 v[100:103], a[48:51], a[68:71], v[100:103]
  ds_read_b128 a[96:99], v6 offset:0
  ds_read_b128 a[100:103], v6 offset:1024
  v_mfma_f32_16x16x32_bf16 v[104:107], a[48:51], a[72:75], v[104:107]
  ds_read_b128 a[104:107], v6 offset:2048
  ds_read_b128 a[108:111], v6 offset:3072
  v_mfma_f32_16x16x32_bf16 v[108:111], a[48:51], a[76:79], v[108:111]
  ds_read_b64_tr_b16 a[36:37], v8 offset:16384
  ds_read_b64_tr_b16 a[38:39], v8 offset:20480
  v_mfma_f32_16x16x32_bf16 v[112:115], a[52:55], a[64:67], v[112:115]
  ds_read_b64_tr_b16 a[40:41], v9 offset:16384
  ds_read_b64_tr_b16 a[42:43], v9 offset:20480
  v_mfma_f32_16x16x32_bf16 v[116:119], a[52:55], a[68:71], v[116:119]
  ds_read_b64_tr_b16 a[44:45], v10 offset:16384
  ds_read_b64_tr_b16 a[46:47], v10 offset:20480
  v_mfma_f32_16x16x32_bf16 v[120:123], a[52:55], a[72:75], v[120:123]
  v_mfma_f32_16x16x32_bf16 v[124:127], a[52:55], a[76:79], v[124:127]
  v_mfma_f32_16x16x32_bf16 v[128:131], a[56:59], a[64:67], v[128:131]
  s_add_u32 m0, s24, s41
  v_mfma_f32_16x16x32_bf16 v[132:135], a[56:59], a[68:71], v[132:135]
  buffer_load_dwordx4 v11, s[16:19], s20 offen offset:0 sc1 lds
  v_mfma_f32_16x16x32_bf16 v[136:139], a[56:59], a[72:75], v[136:139]
  v_mfma_f32_16x16x32_bf16 v[140:143], a[56:59], a[76:79], v[140:143]
  v_mfma_f32_16x16x32_bf16 v[144:147], a[60:63], a[64:67], v[144:147]
  v_mfma_f32_16x16x32_bf16 v[148:151], a[60:63], a[68:71], v[148:151]
  buffer_load_dwordx4 v11, s[16:19], s20 offen offset:1024 sc1 lds
  v_mfma_f32_16x16x32_bf16 v[152:155], a[60:63], a[72:75], v[152:155]
  v_mfma_f32_16x16x32_bf16 v[156:159], a[60:63], a[76:79], v[156:159]
  s_add_u32 s20, s20, 131072
  s_waitcnt lgkmcnt(0)
  v_mfma_f32_16x16x32_bf16 v[32:35], a[32:35], a[96:99], v[32:35]
  ds_read_b64_tr_b16 a[48:49], v7 offset:24576
  ds_read_b64_tr_b16 a[50:51], v7 offset:28672
  v_mfma_f32_16x16x32_bf16 v[36:39], a[32:35], a[100:103], v[36:39]
  ds_read_b64_tr_b16 a[52:53], v8 offset:24576
  ds_read_b64_tr_b16 a[54:55], v8 offset:28672
  v_mfma_f32_16x16x32_bf16 v[40:43], a[32:35], a[104:107], v[40:43]
  ds_read_b64_tr_b16 a[56:57], v9 offset:24576
  ds_read_b64_tr_b16 a[58:59], v9 offset:28672
  v_mfma_f32_16x16x32_bf16 v[44:47], a[32:35], a[108:111], v[44:47]
  ds_read_b64_tr_b16 a[60:61], v10 offset:24576
  ds_read_b64_tr_b16 a[62:63], v10 offset:28672
  v_mfma_f32_16x16x32_bf16 v[48:51], a[36:39], a[96:99], v[48:51]
  s_add_u32 s25, s25, 32768
  s_and_b32 s25, s25, 131071
  v_add_u32 v6, s25, v1
  v_mfma_f32_16x16x32_bf16 v[52:55], a[36:39], a[100:103], v[52:55]
  v_add_u32 v7, s25, v2
  v_add_u32 v8, s25, v3
  v_mfma_f32_16x16x32_bf16 v[56:59], a[36:39], a[104:107], v[56:59]
  v_add_u32 v9, s25, v4
  v_add_u32 v10, s25, v5
  v_mfma_f32_16x16x32_bf16 v[60:63], a[36:39], a[108:111], v[60:63]
  s_add_u32 m0, s24, s42
  v_mfma_f32_16x16x32_bf16 v[64:67], a[40:43], a[96:99], v[64:67]
  buffer_load_dwordx4 v12, s[12:15], s21 offen offset:0 lds
  v_mfma_f32_16x16x32_bf16 v[68:71], a[40:43], a[100:103], v[68:71]
  v_mfma_f32_16x16x32_bf16 v[72:75], a[40:43], a[104:107], v[72:75]
  buffer_load_dwordx4 v13, s[12:15], s21 offen offset:1024 lds
  v_mfma_f32_16x16x32_bf16 v[76:79], a[40:43], a[108:111], v[76:79]
  v_mfma_f32_16x16x32_bf16 v[80:83], a[44:47], a[96:99], v[80:83]
  buffer_load_dwordx4 v14, s[12:15], s21 offen offset:2048 lds
  v_mfma_f32_16x16x32_bf16 v[84:87], a[44:47], a[100:103], v[84:87]
  v_mfma_f32_16x16x32_bf16 v[88:91], a[44:47], a[104:107], v[88:91]
  buffer_load_dwordx4 v15, s[12:15], s21 offen offset:3072 lds
  v_mfma_f32_16x16x32_bf16 v[92:95], a[44:47], a[108:111], v[92:95]
  s_add_u32 s21, s21, s22
  s_add_u32 s24, s24, 32768
  s_and_b32 s24, s24, 131071
  s_add_u32 s26, s26, 2
  s_branch G4_loop
G4_event:
  s_cmp_eq_u32 s26, s32
  s_cbranch_scc1 G4_switch
  s_cmp_lg_u32 s27, 0
  s_cbranch_scc1 SIG_18
  v_mov_b32 v18, s37
  s_mov_b64 exec, 1
  buffer_atomic_add v18, off, s[8:11], s35 sc1
  s_cmp_eq_u32 s36, 0
  s_cbranch_scc1 SIG_18_1
  buffer_atomic_add v18, off, s[8:11], s36 sc1
SIG_18_1:
  s_mov_b64 exec, -1
SIG_18:
  s_mov_b32 s35, 0
  s_mov_b32 s43, s32
  s_branch G4_back
G4_switch:
  s_bitcmp1_b32 s31, 4
  s_cbranch_scc1 G4_sw1
  s_mov_b32 s14, 0
  s_mov_b32 s18, 0
  s_branch G4_back
G4_sw1:
  s_bfe_u32 s4, s31, 262152
  s_bfe_u32 s5, s31, 393228
  s_bfe_u32 s20, s31, 0x50007
  s_lshl_b32 s20, s20, 12
  s_mov_b32 s18, s10
  s_mov_b32 s40, 32
  s_and_b32 s3, s31, 7
  s_cmp_eq_u32 s3, 2
  s_cbranch_scc1 SLG4s_v
  s_cmp_eq_u32 s3, 3
  s_cbranch_scc1 SLG4s_fu
  s_cmp_eq_u32 s3, 4
  s_cbranch_scc1 SLG4s_fd
  s_cmp_eq_u32 s3, 5
  s_cbranch_scc1 SLG4s_wo
  s_cmp_eq_u32 s28, 0
  s_cselect_b32 s12, s60, s62
  s_cselect_b32 s13, s61, s63
  s_mov_b32 s14, 8388608
  s_mov_b32 s22, 262144
  s_lshl_b32 s21, s5, 8
  v_mul_u32_u24 v18, 8192, v16
  v_xor_b32 v20, 0x80, v17
  v_add_u32 v12, v18, v17
  v_add_u32 v13, v18, v20
  v_add_u32 v13, 31744, v13
  v_add_u32 v14, 63488, v12
  v_add_u32 v15, 63488, v13
  s_branch SLG4s_done
SLG4s_v:
  s_mov_b32 s12, s64
  s_mov_b32 s13, s65
  s_mov_b32 s14, 8388608
  s_mov_b32 s22, 262144
  s_lshl_b32 s21, s5, 9
  s_lshl_b32 s3, s28, 8
  s_add_u32 s21, s21, s3
  v_mul_u32_u24 v18, 8192, v16
  v_xor_b32 v20, 0x80, v17
  v_add_u32 v12, v18, v17
  v_add_u32 v13, v18, v20
  v_add_u32 v13, 31744, v13
  v_add_u32 v14, 63488, v12
  v_add_u32 v15, 63488, v13
  s_branch SLG4s_done
SLG4s_fu:
  s_cmp_eq_u32 s28, 0
  s_cselect_b32 s12, s72, s74
  s_cselect_b32 s13, s73, s75
  s_mov_b32 s14, 7340032
  s_mov_b32 s22, 229376
  s_lshl_b32 s21, s5, 8
  v_mul_u32_u24 v18, 7168, v16
  v_xor_b32 v20, 0x80, v17
  v_add_u32 v12, v18, v17
  v_add_u32 v13, v18, v20
  v_add_u32 v13, 27648, v13
  v_add_u32 v14, 55296, v12
  v_add_u32 v15, 55296, v13
  s_branch SLG4s_done
SLG4s_fd:
  s_mov_b32 s12, s76
  s_mov_b32 s13, s77
  s_mov_b32 s14, 7340032
  s_mov_b32 s22, 65536
  s_lshl_b32 s21, s5, 9
  s_lshl_b32 s3, s28, 8
  s_add_u32 s21, s21, s3
  s_add_u32 s20, s20, 54525952
  s_mov_b32 s40, 112
  v_mul_u32_u24 v18, 2048, v16
  v_xor_b32 v20, 0x80, v17
  v_add_u32 v12, v18, v17
  v_add_u32 v13, v18, v20
  v_add_u32 v13, 7168, v13
  v_add_u32 v14, 14336, v12
  v_add_u32 v15, 14336, v13
  s_branch SLG4s_done
SLG4s_wo:
  s_mov_b32 s12, s66
  s_mov_b32 s13, s67
  s_mov_b32 s14, 8388608
  s_mov_b32 s22, 65536
  s_lshl_b32 s21, s5, 9
  s_lshl_b32 s3, s28, 8
  s_add_u32 s21, s21, s3
  s_bfe_u32 s3, s31, 262162
  s_lshl_b32 s4, s3, 19
  s_add_u32 s21, s21, s4
  s_lshl_b32 s4, s3, 20
  s_add_u32 s20, s20, s4
  s_add_u32 s20, s20, 69206016
  s_bfe_u32 s40, s31, 262166
  s_add_u32 s40, s40, 1
  s_lshl_b32 s40, s40, 3
  v_mul_u32_u24 v18, 2048, v16
  v_xor_b32 v20, 0x80, v17
  v_add_u32 v12, v18, v17
  v_add_u32 v13, v18, v20
  v_add_u32 v13, 7168, v13
  v_add_u32 v14, 14336, v12
  v_add_u32 v15, 14336, v13
SLG4s_done:
  s_branch G4_back
G4_epi:
  s_bfe_u32 s4, s30, 262152
  s_bfe_u32 s5, s30, 393228
  s_bfe_u32 s6, s30, 0x50007
  s_lshl_b32 s6, s6, 2
  s_mul_i32 s3, s28, 4
  s_add_u32 s6, s6, s3
  s_lshl_b32 s35, s4, 7
  s_add_u32 s35, s35, 99614720
  s_mov_b32 s37, 1
  s_and_b32 s3, s30, 7
  s_cmp_ge_u32 s3, 4
  s_cbranch_scc1 G4_fd
  s_add_u32 s35, s35, 0
  s_mov_b32 s36, 0
  s_mov_b32 s37, 2
  s_lshr_b32 s6, s6, 1
  s_mul_i32 s6, s6, 24576
  s_mul_i32 s5, s5, 1572864
  s_add_u32 s6, s6, s5
  s_add_u32 s5, s5, 16384
  s_cmp_eq_u32 s3, 2
  s_cselect_b32 s5, s5, 0
  s_mov_b32 s7, 8192
  s_cmov_b32 s7, 1572864
  s_add_u32 s6, s6, s5
  s_lshl_b32 s3, s29, 11
  s_add_u32 s6, s6, s3
  s_add_u32 s6, s6, 4194304
  v_cvt_pk_bf16_f32 v32, v32, v33
  v_cvt_pk_bf16_f32 v33, v34, v35
  v_cvt_pk_bf16_f32 v34, v48, v49
  v_cvt_pk_bf16_f32 v35, v50, v51
  s_add_u32 s3, s6, 0
  buffer_store_dwordx4 v[32:35], v0, s[8:11], s3 offen offset:0 sc1
  v_cvt_pk_bf16_f32 v36, v36, v37
  v_cvt_pk_bf16_f32 v37, v38, v39
  v_cvt_pk_bf16_f32 v38, v52, v53
  v_cvt_pk_bf16_f32 v39, v54, v55
  s_add_u32 s3, s6, 4096
  buffer_store_dwordx4 v[36:39], v0, s[8:11], s3 offen offset:0 sc1
  v_cvt_pk_bf16_f32 v40, v40, v41
  v_cvt_pk_bf16_f32 v41, v42, v43
  v_cvt_pk_bf16_f32 v42, v56, v57
  v_cvt_pk_bf16_f32 v43, v58, v59
  s_add_u32 s3, s6, 24576
  buffer_store_dwordx4 v[40:43], v0, s[8:11], s3 offen offset:0 sc1
  v_cvt_pk_bf16_f32 v44, v44, v45
  v_cvt_pk_bf16_f32 v45, v46, v47
  v_cvt_pk_bf16_f32 v46, v60, v61
  v_cvt_pk_bf16_f32 v47, v62, v63
  s_add_u32 s3, s6, 28672
  buffer_store_dwordx4 v[44:47], v0, s[8:11], s3 offen offset:0 sc1
  v_cvt_pk_bf16_f32 v64, v64, v65
  v_cvt_pk_bf16_f32 v65, v66, v67
  v_cvt_pk_bf16_f32 v66, v80, v81
  v_cvt_pk_bf16_f32 v67, v82, v83
  s_add_u32 s3, s6, 0
  buffer_store_dwordx4 v[64:67], v0, s[8:11], s3 offen offset:1024 sc1
  v_cvt_pk_bf16_f32 v68, v68, v69
  v_cvt_pk_bf16_f32 v69, v70, v71
  v_cvt_pk_bf16_f32 v70, v84, v85
  v_cvt_pk_bf16_f32 v71, v86, v87
  s_add_u32 s3, s6, 4096
  buffer_store_dwordx4 v[68:71], v0, s[8:11], s3 offen offset:1024 sc1
  v_cvt_pk_bf16_f32 v72, v72, v73
  v_cvt_pk_bf16_f32 v73, v74, v75
  v_cvt_pk_bf16_f32 v74, v88, v89
  v_cvt_pk_bf16_f32 v75, v90, v91
  s_add_u32 s3, s6, 24576
  buffer_store_dwordx4 v[72:75], v0, s[8:11], s3 offen offset:1024 sc1
  v_cvt_pk_bf16_f32 v76, v76, v77
  v_cvt_pk_bf16_f32 v77, v78, v79
  v_cvt_pk_bf16_f32 v78, v92, v93
  v_cvt_pk_bf16_f32 v79, v94, v95
  s_add_u32 s3, s6, 28672
  buffer_store_dwordx4 v[76:79], v0, s[8:11], s3 offen offset:1024 sc1
  s_add_u32 s6, s6, s7
  v_cvt_pk_bf16_f32 v96, v96, v97
  v_cvt_pk_bf16_f32 v97, v98, v99
  v_cvt_pk_bf16_f32 v98, v112, v113
  v_cvt_pk_bf16_f32 v99, v114, v115
  s_add_u32 s3, s6, 0
  buffer_store_dwordx4 v[96:99], v0, s[8:11], s3 offen offset:0 sc1
  v_cvt_pk_bf16_f32 v100, v100, v101
  v_cvt_pk_bf16_f32 v101, v102, v103
  v_cvt_pk_bf16_f32 v102, v116, v117
  v_cvt_pk_bf16_f32 v103, v118, v119
  s_add_u32 s3, s6, 4096
  buffer_store_dwordx4 v[100:103], v0, s[8:11], s3 offen offset:0 sc1
  v_cvt_pk_bf16_f32 v104, v104, v105
  v_cvt_pk_bf16_f32 v105, v106, v107
  v_cvt_pk_bf16_f32 v106, v120, v121
  v_cvt_pk_bf16_f32 v107, v122, v123
  s_add_u32 s3, s6, 24576
  buffer_store_dwordx4 v[104:107], v0, s[8:11], s3 offen offset:0 sc1
  v_cvt_pk_bf16_f32 v108, v108, v109
  v_cvt_pk_bf16_f32 v109, v110, v111
  v_cvt_pk_bf16_f32 v110, v124, v125
  v_cvt_pk_bf16_f32 v111, v126, v127
  s_add_u32 s3, s6, 28672
  buffer_store_dwordx4 v[108:111], v0, s[8:11], s3 offen offset:0 sc1
  v_cvt_pk_bf16_f32 v128, v128, v129
  v_cvt_pk_bf16_f32 v129, v130, v131
  v_cvt_pk_bf16_f32 v130, v144, v145
  v_cvt_pk_bf16_f32 v131, v146, v147
  s_add_u32 s3, s6, 0
  buffer_store_dwordx4 v[128:131], v0, s[8:11], s3 offen offset:1024 sc1
  v_cvt_pk_bf16_f32 v132, v132, v133
  v_cvt_pk_bf16_f32 v133, v134, v135
  v_cvt_pk_bf16_f32 v134, v148, v149
  v_cvt_pk_bf16_f32 v135, v150, v151
  s_add_u32 s3, s6, 4096
  buffer_store_dwordx4 v[132:135], v0, s[8:11], s3 offen offset:1024 sc1
  v_cvt_pk_bf16_f32 v136, v136, v137
  v_cvt_pk_bf16_f32 v137, v138, v139
  v_cvt_pk_bf16_f32 v138, v152, v153
  v_cvt_pk_bf16_f32 v139, v154, v155
  s_add_u32 s3, s6, 24576
  buffer_store_dwordx4 v[136:139], v0, s[8:11], s3 offen offset:1024 sc1
  v_cvt_pk_bf16_f32 v140, v140, v141
  v_cvt_pk_bf16_f32 v141, v142, v143
  v_cvt_pk_bf16_f32 v142, v156, v157
  v_cvt_pk_bf16_f32 v143, v158, v159
  s_add_u32 s3, s6, 28672
  buffer_store_dwordx4 v[140:143], v0, s[8:11], s3 offen offset:1024 sc1
G4_done:
  s_bitcmp1_b32 s31, 4
  s_cbranch_scc0 L_drain
  s_mov_b32 s30, s31
  s_add_u32 s38, s38, 4
  s_addc_u32 s39, s39, 0
  s_load_dword s31, s[38:39], 0
  s_branch G4_task
G4_fd:
  s_lshl_b32 s35, s4, 2
  s_add_u32 s35, s35, s5
  s_lshl_b32 s35, s35, 7
  s_add_u32 s35, s35, 99622912
  s_mov_b32 s36, 0
  s_mov_b32 s37, 2
  s_lshl_b32 s6, s6, 15
  s_lshl_b32 s5, s5, 9
  s_add_u32 s6, s6, s5
  s_lshl_b32 s5, s29, 7
  s_add_u32 s6, s6, s5
  v_lshrrev_b32 v20, 4, v0
  v_and_b32 v21, 15, v20
  v_lshlrev_b32 v21, 11, v21
  v_bfe_u32 v22, v20, 4, 1
  v_lshl_add_u32 v21, v22, 5, v21
  v_lshrrev_b32 v22, 5, v20
  v_lshl_add_u32 v21, v22, 4, v21
  s_mov_b32 s44, s56
  s_mov_b32 s45, s57
  s_mov_b32 s46, 0x400000
  s_mov_b32 s47, 0x20000
  s_mov_b32 s48, s82
  s_mov_b32 s49, s83
  s_mov_b32 s50, 0x10000000
  s_mov_b32 s51, 0x20000
  s_mov_b32 s7, s6
  s_bfe_u32 s5, s30, 327706
  s_lshl_b32 s5, s5, 22
  s_add_u32 s5, s5, 100663296
  s_cmp_eq_u32 s5, 100663296
  s_cselect_b32 s46, s46, 0
  s_bitcmp1_b32 s30, 5
  s_cbranch_scc0 G4_fd2
  s_cmp_lg_u32 s27, 0
  s_cbranch_scc1 Wy0_19_ok
  s_mov_b32 s4, 0
Wy0_19:
  buffer_load_dword v18, off, s[8:11], s35 offset:0 sc1
  s_add_u32 s4, s4, 1
  s_cmp_gt_u32 s4, 65536
  s_cbranch_scc1 L_abort
  s_waitcnt vmcnt(0)
  v_readfirstlane_b32 s3, v18
  s_cmp_ge_u32 s3, 2
  s_cbranch_scc1 Wy0_19_ok
  s_sleep 8
  s_branch Wy0_19
Wy0_19_ok:
  s_barrier
  s_mov_b32 s44, s82
  s_mov_b32 s45, s83
  s_mov_b32 s46, 0x10000000
  s_mov_b32 s47, 0x20000
  s_mov_b32 s48, s78
  s_mov_b32 s49, s79
  s_mov_b32 s50, 0x400000
  s_mov_b32 s51, 0x20000
  s_add_u32 s7, s6, 100663296
  s_mov_b32 s5, 0
G4_fd2:
  s_add_u32 s6, s6, s5
  s_add_u32 s3, s7, 0
  buffer_load_dwordx4 v[160:163], v21, s[44:47], s3 offen offset:0 sc1
  buffer_load_dwordx4 v[164:167], v21, s[44:47], s3 offen offset:64 sc1
  buffer_load_dwordx4 v[168:171], v21, s[44:47], s3 offen offset:256 sc1
  buffer_load_dwordx4 v[172:175], v21, s[44:47], s3 offen offset:320 sc1
  s_add_u32 s3, s7, 32768
  buffer_load_dwordx4 v[176:179], v21, s[44:47], s3 offen offset:0 sc1
  buffer_load_dwordx4 v[180:183], v21, s[44:47], s3 offen offset:64 sc1
  buffer_load_dwordx4 v[184:187], v21, s[44:47], s3 offen offset:256 sc1
  buffer_load_dwordx4 v[188:191], v21, s[44:47], s3 offen offset:320 sc1
  s_add_u32 s3, s7, 65536
  buffer_load_dwordx4 v[192:195], v21, s[44:47], s3 offen offset:0 sc1
  buffer_load_dwordx4 v[196:199], v21, s[44:47], s3 offen offset:64 sc1
  buffer_load_dwordx4 v[200:203], v21, s[44:47], s3 offen offset:256 sc1
  buffer_load_dwordx4 v[204:207], v21, s[44:47], s3 offen offset:320 sc1
  s_add_u32 s3, s7, 98304
  buffer_load_dwordx4 v[208:211], v21, s[44:47], s3 offen offset:0 sc1
  buffer_load_dwordx4 v[212:215], v21, s[44:47], s3 offen offset:64 sc1
  buffer_load_dwordx4 v[216:219], v21, s[44:47], s3 offen offset:256 sc1
  buffer_load_dwordx4 v[220:223], v21, s[44:47], s3 offen offset:320 sc1
  v_permlane16_swap_b32 v32, v48
  v_permlane16_swap_b32 v33, v49
  v_permlane16_swap_b32 v34, v50
  v_permlane16_swap_b32 v35, v51
  v_permlane16_swap_b32 v64, v80
  v_permlane16_swap_b32 v65, v81
  v_permlane16_swap_b32 v66, v82
  v_permlane16_swap_b32 v67, v83
  v_permlane16_swap_b32 v96, v112
  v_permlane16_swap_b32 v97, v113
  v_permlane16_swap_b32 v98, v114
  v_permlane16_swap_b32 v99, v115
  v_permlane16_swap_b32 v128, v144
  v_permlane16_swap_b32 v129, v145
  v_permlane16_swap_b32 v130, v146
  v_permlane16_swap_b32 v131, v147
  v_permlane16_swap_b32 v36, v52
  v_permlane16_swap_b32 v37, v53
  v_permlane16_swap_b32 v38, v54
  v_permlane16_swap_b32 v39, v55
  v_permlane16_swap_b32 v68, v84
  v_permlane16_swap_b32 v69, v85
  v_permlane16_swap_b32 v70, v86
  v_permlane16_swap_b32 v71, v87
  v_permlane16_swap_b32 v100, v116
  v_permlane16_swap_b32 v101, v117
  v_permlane16_swap_b32 v102, v118
  v_permlane16_swap_b32 v103, v119
  v_permlane16_swap_b32 v132, v148
  v_permlane16_swap_b32 v133, v149
  v_permlane16_swap_b32 v134, v150
  v_permlane16_swap_b32 v135, v151
  v_permlane16_swap_b32 v40, v56
  v_permlane16_swap_b32 v41, v57
  v_permlane16_swap_b32 v42, v58
  v_permlane16_swap_b32 v43, v59
  v_permlane16_swap_b32 v72, v88
  v_permlane16_swap_b32 v73, v89
  v_permlane16_swap_b32 v74, v90
  v_permlane16_swap_b32 v75, v91
  v_permlane16_swap_b32 v104, v120
  v_permlane16_swap_b32 v105, v121
  v_permlane16_swap_b32 v106, v122
  v_permlane16_swap_b32 v107, v123
  v_permlane16_swap_b32 v136, v152
  v_permlane16_swap_b32 v137, v153
  v_permlane16_swap_b32 v138, v154
  v_permlane16_swap_b32 v139, v155
  v_permlane16_swap_b32 v44, v60
  v_permlane16_swap_b32 v45, v61
  v_permlane16_swap_b32 v46, v62
  v_permlane16_swap_b32 v47, v63
  v_permlane16_swap_b32 v76, v92
  v_permlane16_swap_b32 v77, v93
  v_permlane16_swap_b32 v78, v94
  v_permlane16_swap_b32 v79, v95
  v_permlane16_swap_b32 v108, v124
  v_permlane16_swap_b32 v109, v125
  v_permlane16_swap_b32 v110, v126
  v_permlane16_swap_b32 v111, v127
  v_permlane16_swap_b32 v140, v156
  v_permlane16_swap_b32 v141, v157
  v_permlane16_swap_b32 v142, v158
  v_permlane16_swap_b32 v143, v159
  s_add_u32 s3, s6, 0
  s_waitcnt vmcnt(12)
  v_lshlrev_b32 v22, 16, v160
  v_and_b32 v23, 0xffff0000, v160
  v_pk_add_f32 v[22:23], v[22:23], v[32:33]
  v_cvt_pk_bf16_f32 v160, v22, v23
  v_lshlrev_b32 v22, 16, v161
  v_and_b32 v23, 0xffff0000, v161
  v_pk_add_f32 v[22:23], v[22:23], v[34:35]
  v_cvt_pk_bf16_f32 v161, v22, v23
  v_lshlrev_b32 v22, 16, v162
  v_and_b32 v23, 0xffff0000, v162
  v_pk_add_f32 v[22:23], v[22:23], v[48:49]
  v_cvt_pk_bf16_f32 v162, v22, v23
  v_lshlrev_b32 v22, 16, v163
  v_and_b32 v23, 0xffff0000, v163
  v_pk_add_f32 v[22:23], v[22:23], v[50:51]
  v_cvt_pk_bf16_f32 v163, v22, v23
  buffer_store_dwordx4 v[160:163], v21, s[48:51], s3 offen offset:0 sc1
  v_lshlrev_b32 v22, 16, v164
  v_and_b32 v23, 0xffff0000, v164
  v_pk_add_f32 v[22:23], v[22:23], v[64:65]
  v_cvt_pk_bf16_f32 v164, v22, v23
  v_lshlrev_b32 v22, 16, v165
  v_and_b32 v23, 0xffff0000, v165
  v_pk_add_f32 v[22:23], v[22:23], v[66:67]
  v_cvt_pk_bf16_f32 v165, v22, v23
  v_lshlrev_b32 v22, 16, v166
  v_and_b32 v23, 0xffff0000, v166
  v_pk_add_f32 v[22:23], v[22:23], v[80:81]
  v_cvt_pk_bf16_f32 v166, v22, v23
  v_lshlrev_b32 v22, 16, v167
  v_and_b32 v23, 0xffff0000, v167
  v_pk_add_f32 v[22:23], v[22:23], v[82:83]
  v_cvt_pk_bf16_f32 v167, v22, v23
  buffer_store_dwordx4 v[164:167], v21, s[48:51], s3 offen offset:64 sc1
  v_lshlrev_b32 v22, 16, v168
  v_and_b32 v23, 0xffff0000, v168
  v_pk_add_f32 v[22:23], v[22:23], v[96:97]
  v_cvt_pk_bf16_f32 v168, v22, v23
  v_lshlrev_b32 v22, 16, v169
  v_and_b32 v23, 0xffff0000, v169
  v_pk_add_f32 v[22:23], v[22:23], v[98:99]
  v_cvt_pk_bf16_f32 v169, v22, v23
  v_lshlrev_b32 v22, 16, v170
  v_and_b32 v23, 0xffff0000, v170
  v_pk_add_f32 v[22:23], v[22:23], v[112:113]
  v_cvt_pk_bf16_f32 v170, v22, v23
  v_lshlrev_b32 v22, 16, v171
  v_and_b32 v23, 0xffff0000, v171
  v_pk_add_f32 v[22:23], v[22:23], v[114:115]
  v_cvt_pk_bf16_f32 v171, v22, v23
  buffer_store_dwordx4 v[168:171], v21, s[48:51], s3 offen offset:256 sc1
  v_lshlrev_b32 v22, 16, v172
  v_and_b32 v23, 0xffff0000, v172
  v_pk_add_f32 v[22:23], v[22:23], v[128:129]
  v_cvt_pk_bf16_f32 v172, v22, v23
  v_lshlrev_b32 v22, 16, v173
  v_and_b32 v23, 0xffff0000, v173
  v_pk_add_f32 v[22:23], v[22:23], v[130:131]
  v_cvt_pk_bf16_f32 v173, v22, v23
  v_lshlrev_b32 v22, 16, v174
  v_and_b32 v23, 0xffff0000, v174
  v_pk_add_f32 v[22:23], v[22:23], v[144:145]
  v_cvt_pk_bf16_f32 v174, v22, v23
  v_lshlrev_b32 v22, 16, v175
  v_and_b32 v23, 0xffff0000, v175
  v_pk_add_f32 v[22:23], v[22:23], v[146:147]
  v_cvt_pk_bf16_f32 v175, v22, v23
  buffer_store_dwordx4 v[172:175], v21, s[48:51], s3 offen offset:320 sc1
  s_add_u32 s3, s6, 32768
  s_waitcnt vmcnt(12)
  v_lshlrev_b32 v22, 16, v176
  v_and_b32 v23, 0xffff0000, v176
  v_pk_add_f32 v[22:23], v[22:23], v[36:37]
  v_cvt_pk_bf16_f32 v176, v22, v23
  v_lshlrev_b32 v22, 16, v177
  v_and_b32 v23, 0xffff0000, v177
  v_pk_add_f32 v[22:23], v[22:23], v[38:39]
  v_cvt_pk_bf16_f32 v177, v22, v23
  v_lshlrev_b32 v22, 16, v178
  v_and_b32 v23, 0xffff0000, v178
  v_pk_add_f32 v[22:23], v[22:23], v[52:53]
  v_cvt_pk_bf16_f32 v178, v22, v23
  v_lshlrev_b32 v22, 16, v179
  v_and_b32 v23, 0xffff0000, v179
  v_pk_add_f32 v[22:23], v[22:23], v[54:55]
  v_cvt_pk_bf16_f32 v179, v22, v23
  buffer_store_dwordx4 v[176:179], v21, s[48:51], s3 offen offset:0 sc1
  v_lshlrev_b32 v22, 16, v180
  v_and_b32 v23, 0xffff0000, v180
  v_pk_add_f32 v[22:23], v[22:23], v[68:69]
  v_cvt_pk_bf16_f32 v180, v22, v23
  v_lshlrev_b32 v22, 16, v181
  v_and_b32 v23, 0xffff0000, v181
  v_pk_add_f32 v[22:23], v[22:23], v[70:71]
  v_cvt_pk_bf16_f32 v181, v22, v23
  v_lshlrev_b32 v22, 16, v182
  v_and_b32 v23, 0xffff0000, v182
  v_pk_add_f32 v[22:23], v[22:23], v[84:85]
  v_cvt_pk_bf16_f32 v182, v22, v23
  v_lshlrev_b32 v22, 16, v183
  v_and_b32 v23, 0xffff0000, v183
  v_pk_add_f32 v[22:23], v[22:23], v[86:87]
  v_cvt_pk_bf16_f32 v183, v22, v23
  buffer_store_dwordx4 v[180:183], v21, s[48:51], s3 offen offset:64 sc1
  v_lshlrev_b32 v22, 16, v184
  v_and_b32 v23, 0xffff0000, v184
  v_pk_add_f32 v[22:23], v[22:23], v[100:101]
  v_cvt_pk_bf16_f32 v184, v22, v23
  v_lshlrev_b32 v22, 16, v185
  v_and_b32 v23, 0xffff0000, v185
  v_pk_add_f32 v[22:23], v[22:23], v[102:103]
  v_cvt_pk_bf16_f32 v185, v22, v23
  v_lshlrev_b32 v22, 16, v186
  v_and_b32 v23, 0xffff0000, v186
  v_pk_add_f32 v[22:23], v[22:23], v[116:117]
  v_cvt_pk_bf16_f32 v186, v22, v23
  v_lshlrev_b32 v22, 16, v187
  v_and_b32 v23, 0xffff0000, v187
  v_pk_add_f32 v[22:23], v[22:23], v[118:119]
  v_cvt_pk_bf16_f32 v187, v22, v23
  buffer_store_dwordx4 v[184:187], v21, s[48:51], s3 offen offset:256 sc1
  v_lshlrev_b32 v22, 16, v188
  v_and_b32 v23, 0xffff0000, v188
  v_pk_add_f32 v[22:23], v[22:23], v[132:133]
  v_cvt_pk_bf16_f32 v188, v22, v23
  v_lshlrev_b32 v22, 16, v189
  v_and_b32 v23, 0xffff0000, v189
  v_pk_add_f32 v[22:23], v[22:23], v[134:135]
  v_cvt_pk_bf16_f32 v189, v22, v23
  v_lshlrev_b32 v22, 16, v190
  v_and_b32 v23, 0xffff0000, v190
  v_pk_add_f32 v[22:23], v[22:23], v[148:149]
  v_cvt_pk_bf16_f32 v190, v22, v23
  v_lshlrev_b32 v22, 16, v191
  v_and_b32 v23, 0xffff0000, v191
  v_pk_add_f32 v[22:23], v[22:23], v[150:151]
  v_cvt_pk_bf16_f32 v191, v22, v23
  buffer_store_dwordx4 v[188:191], v21, s[48:51], s3 offen offset:320 sc1
  s_add_u32 s3, s6, 65536
  s_waitcnt vmcnt(12)
  v_lshlrev_b32 v22, 16, v192
  v_and_b32 v23, 0xffff0000, v192
  v_pk_add_f32 v[22:23], v[22:23], v[40:41]
  v_cvt_pk_bf16_f32 v192, v22, v23
  v_lshlrev_b32 v22, 16, v193
  v_and_b32 v23, 0xffff0000, v193
  v_pk_add_f32 v[22:23], v[22:23], v[42:43]
  v_cvt_pk_bf16_f32 v193, v22, v23
  v_lshlrev_b32 v22, 16, v194
  v_and_b32 v23, 0xffff0000, v194
  v_pk_add_f32 v[22:23], v[22:23], v[56:57]
  v_cvt_pk_bf16_f32 v194, v22, v23
  v_lshlrev_b32 v22, 16, v195
  v_and_b32 v23, 0xffff0000, v195
  v_pk_add_f32 v[22:23], v[22:23], v[58:59]
  v_cvt_pk_bf16_f32 v195, v22, v23
  buffer_store_dwordx4 v[192:195], v21, s[48:51], s3 offen offset:0 sc1
  v_lshlrev_b32 v22, 16, v196
  v_and_b32 v23, 0xffff0000, v196
  v_pk_add_f32 v[22:23], v[22:23], v[72:73]
  v_cvt_pk_bf16_f32 v196, v22, v23
  v_lshlrev_b32 v22, 16, v197
  v_and_b32 v23, 0xffff0000, v197
  v_pk_add_f32 v[22:23], v[22:23], v[74:75]
  v_cvt_pk_bf16_f32 v197, v22, v23
  v_lshlrev_b32 v22, 16, v198
  v_and_b32 v23, 0xffff0000, v198
  v_pk_add_f32 v[22:23], v[22:23], v[88:89]
  v_cvt_pk_bf16_f32 v198, v22, v23
  v_lshlrev_b32 v22, 16, v199
  v_and_b32 v23, 0xffff0000, v199
  v_pk_add_f32 v[22:23], v[22:23], v[90:91]
  v_cvt_pk_bf16_f32 v199, v22, v23
  buffer_store_dwordx4 v[196:199], v21, s[48:51], s3 offen offset:64 sc1
  v_lshlrev_b32 v22, 16, v200
  v_and_b32 v23, 0xffff0000, v200
  v_pk_add_f32 v[22:23], v[22:23], v[104:105]
  v_cvt_pk_bf16_f32 v200, v22, v23
  v_lshlrev_b32 v22, 16, v201
  v_and_b32 v23, 0xffff0000, v201
  v_pk_add_f32 v[22:23], v[22:23], v[106:107]
  v_cvt_pk_bf16_f32 v201, v22, v23
  v_lshlrev_b32 v22, 16, v202
  v_and_b32 v23, 0xffff0000, v202
  v_pk_add_f32 v[22:23], v[22:23], v[120:121]
  v_cvt_pk_bf16_f32 v202, v22, v23
  v_lshlrev_b32 v22, 16, v203
  v_and_b32 v23, 0xffff0000, v203
  v_pk_add_f32 v[22:23], v[22:23], v[122:123]
  v_cvt_pk_bf16_f32 v203, v22, v23
  buffer_store_dwordx4 v[200:203], v21, s[48:51], s3 offen offset:256 sc1
  v_lshlrev_b32 v22, 16, v204
  v_and_b32 v23, 0xffff0000, v204
  v_pk_add_f32 v[22:23], v[22:23], v[136:137]
  v_cvt_pk_bf16_f32 v204, v22, v23
  v_lshlrev_b32 v22, 16, v205
  v_and_b32 v23, 0xffff0000, v205
  v_pk_add_f32 v[22:23], v[22:23], v[138:139]
  v_cvt_pk_bf16_f32 v205, v22, v23
  v_lshlrev_b32 v22, 16, v206
  v_and_b32 v23, 0xffff0000, v206
  v_pk_add_f32 v[22:23], v[22:23], v[152:153]
  v_cvt_pk_bf16_f32 v206, v22, v23
  v_lshlrev_b32 v22, 16, v207
  v_and_b32 v23, 0xffff0000, v207
  v_pk_add_f32 v[22:23], v[22:23], v[154:155]
  v_cvt_pk_bf16_f32 v207, v22, v23
  buffer_store_dwordx4 v[204:207], v21, s[48:51], s3 offen offset:320 sc1
  s_add_u32 s3, s6, 98304
  s_waitcnt vmcnt(12)
  v_lshlrev_b32 v22, 16, v208
  v_and_b32 v23, 0xffff0000, v208
  v_pk_add_f32 v[22:23], v[22:23], v[44:45]
  v_cvt_pk_bf16_f32 v208, v22, v23
  v_lshlrev_b32 v22, 16, v209
  v_and_b32 v23, 0xffff0000, v209
  v_pk_add_f32 v[22:23], v[22:23], v[46:47]
  v_cvt_pk_bf16_f32 v209, v22, v23
  v_lshlrev_b32 v22, 16, v210
  v_and_b32 v23, 0xffff0000, v210
  v_pk_add_f32 v[22:23], v[22:23], v[60:61]
  v_cvt_pk_bf16_f32 v210, v22, v23
  v_lshlrev_b32 v22, 16, v211
  v_and_b32 v23, 0xffff0000, v211
  v_pk_add_f32 v[22:23], v[22:23], v[62:63]
  v_cvt_pk_bf16_f32 v211, v22, v23
  buffer_store_dwordx4 v[208:211], v21, s[48:51], s3 offen offset:0 sc1
  v_lshlrev_b32 v22, 16, v212
  v_and_b32 v23, 0xffff0000, v212
  v_pk_add_f32 v[22:23], v[22:23], v[76:77]
  v_cvt_pk_bf16_f32 v212, v22, v23
  v_lshlrev_b32 v22, 16, v213
  v_and_b32 v23, 0xffff0000, v213
  v_pk_add_f32 v[22:23], v[22:23], v[78:79]
  v_cvt_pk_bf16_f32 v213, v22, v23
  v_lshlrev_b32 v22, 16, v214
  v_and_b32 v23, 0xffff0000, v214
  v_pk_add_f32 v[22:23], v[22:23], v[92:93]
  v_cvt_pk_bf16_f32 v214, v22, v23
  v_lshlrev_b32 v22, 16, v215
  v_and_b32 v23, 0xffff0000, v215
  v_pk_add_f32 v[22:23], v[22:23], v[94:95]
  v_cvt_pk_bf16_f32 v215, v22, v23
  buffer_store_dwordx4 v[212:215], v21, s[48:51], s3 offen offset:64 sc1
  v_lshlrev_b32 v22, 16, v216
  v_and_b32 v23, 0xffff0000, v216
  v_pk_add_f32 v[22:23], v[22:23], v[108:109]
  v_cvt_pk_bf16_f32 v216, v22, v23
  v_lshlrev_b32 v22, 16, v217
  v_and_b32 v23, 0xffff0000, v217
  v_pk_add_f32 v[22:23], v[22:23], v[110:111]
  v_cvt_pk_bf16_f32 v217, v22, v23
  v_lshlrev_b32 v22, 16, v218
  v_and_b32 v23, 0xffff0000, v218
  v_pk_add_f32 v[22:23], v[22:23], v[124:125]
  v_cvt_pk_bf16_f32 v218, v22, v23
  v_lshlrev_b32 v22, 16, v219
  v_and_b32 v23, 0xffff0000, v219
  v_pk_add_f32 v[22:23], v[22:23], v[126:127]
  v_cvt_pk_bf16_f32 v219, v22, v23
  buffer_store_dwordx4 v[216:219], v21, s[48:51], s3 offen offset:256 sc1
  v_lshlrev_b32 v22, 16, v220
  v_and_b32 v23, 0xffff0000, v220
  v_pk_add_f32 v[22:23], v[22:23], v[140:141]
  v_cvt_pk_bf16_f32 v220, v22, v23
  v_lshlrev_b32 v22, 16, v221
  v_and_b32 v23, 0xffff0000, v221
  v_pk_add_f32 v[22:23], v[22:23], v[142:143]
  v_cvt_pk_bf16_f32 v221, v22, v23
  v_lshlrev_b32 v22, 16, v222
  v_and_b32 v23, 0xffff0000, v222
  v_pk_add_f32 v[22:23], v[22:23], v[156:157]
  v_cvt_pk_bf16_f32 v222, v22, v23
  v_lshlrev_b32 v22, 16, v223
  v_and_b32 v23, 0xffff0000, v223
  v_pk_add_f32 v[22:23], v[22:23], v[158:159]
  v_cvt_pk_bf16_f32 v223, v22, v23
  buffer_store_dwordx4 v[220:223], v21, s[48:51], s3 offen offset:320 sc1
  s_branch G4_done
G2_cold:
  s_mul_i32 s41, s27, 1024
  s_lshl_b32 s42, s27, 12
  s_add_u32 s42, s42, 4096
  v_add_u32 v11, s41, v0
  s_mul_i32 s3, s28, 2048
  v_add_u32 v1, s3, v0
  s_bfe_u32 s4, s30, 262152
  s_bfe_u32 s5, s30, 393228
  s_bfe_u32 s20, s30, 0x50007
  s_lshl_b32 s20, s20, 12
  s_mov_b32 s18, s10
  s_mov_b32 s40, 32
  s_and_b32 s3, s30, 7
  s_cmp_eq_u32 s3, 2
  s_cbranch_scc1 SLG2c_v
  s_cmp_eq_u32 s3, 3
  s_cbranch_scc1 SLG2c_fu
  s_cmp_eq_u32 s3, 4
  s_cbranch_scc1 SLG2c_fd
  s_cmp_eq_u32 s3, 5
  s_cbranch_scc1 SLG2c_wo
  s_cmp_eq_u32 s28, 0
  s_cselect_b32 s12, s60, s62
  s_cselect_b32 s13, s61, s63
  s_mov_b32 s14, 8388608
  s_mov_b32 s22, 262144
  s_lshl_b32 s21, s5, 8
  v_mul_u32_u24 v18, 8192, v16
  v_xor_b32 v20, 0x80, v17
  v_add_u32 v12, v18, v17
  v_add_u32 v13, v18, v20
  v_add_u32 v13, 31744, v13
  v_add_u32 v14, 63488, v12
  v_add_u32 v15, 63488, v13
  s_branch SLG2c_done
SLG2c_v:
  s_mov_b32 s12, s64
  s_mov_b32 s13, s65
  s_mov_b32 s14, 8388608
  s_mov_b32 s22, 262144
  s_lshl_b32 s21, s5, 9
  s_lshl_b32 s3, s28, 8
  s_add_u32 s21, s21, s3
  v_mul_u32_u24 v18, 8192, v16
  v_xor_b32 v20, 0x80, v17
  v_add_u32 v12, v18, v17
  v_add_u32 v13, v18, v20
  v_add_u32 v13, 31744, v13
  v_add_u32 v14, 63488, v12
  v_add_u32 v15, 63488, v13
  s_branch SLG2c_done
SLG2c_fu:
  s_cmp_eq_u32 s28, 0
  s_cselect_b32 s12, s72, s74
  s_cselect_b32 s13, s73, s75
  s_mov_b32 s14, 7340032
  s_mov_b32 s22, 229376
  s_lshl_b32 s21, s5, 8
  v_mul_u32_u24 v18, 7168, v16
  v_xor_b32 v20, 0x80, v17
  v_add_u32 v12, v18, v17
  v_add_u32 v13, v18, v20
  v_add_u32 v13, 27648, v13
  v_add_u32 v14, 55296, v12
  v_add_u32 v15, 55296, v13
  s_branch SLG2c_done
SLG2c_fd:
  s_mov_b32 s12, s76
  s_mov_b32 s13, s77
  s_mov_b32 s14, 7340032
  s_mov_b32 s22, 65536
  s_lshl_b32 s21, s5, 9
  s_lshl_b32 s3, s28, 8
  s_add_u32 s21, s21, s3
  s_add_u32 s20, s20, 54525952
  s_mov_b32 s40, 112
  v_mul_u32_u24 v18, 2048, v16
  v_xor_b32 v20, 0x80, v17
  v_add_u32 v12, v18, v17
  v_add_u32 v13, v18, v20
  v_add_u32 v13, 7168, v13
  v_add_u32 v14, 14336, v12
  v_add_u32 v15, 14336, v13
  s_branch SLG2c_done
SLG2c_wo:
  s_mov_b32 s12, s66
  s_mov_b32 s13, s67
  s_mov_b32 s14, 8388608
  s_mov_b32 s22, 65536
  s_lshl_b32 s21, s5, 9
  s_lshl_b32 s3, s28, 8
  s_add_u32 s21, s21, s3
  s_bfe_u32 s3, s30, 262162
  s_lshl_b32 s4, s3, 19
  s_add_u32 s21, s21, s4
  s_lshl_b32 s4, s3, 20
  s_add_u32 s20, s20, s4
  s_add_u32 s20, s20, 69206016
  s_bfe_u32 s40, s30, 262166
  s_add_u32 s40, s40, 1
  s_lshl_b32 s40, s40, 3
  v_mul_u32_u24 v18, 2048, v16
  v_xor_b32 v20, 0x80, v17
  v_add_u32 v12, v18, v17
  v_add_u32 v13, v18, v20
  v_add_u32 v13, 7168, v13
  v_add_u32 v14, 14336, v12
  v_add_u32 v15, 14336, v13
SLG2c_done:
  s_mov_b32 s24, 0
  s_mov_b32 s25, 0
  s_add_u32 m0, s24, s42
  s_nop 0
  buffer_load_dwordx4 v12, s[12:15], s21 offen offset:0 lds
  buffer_load_dwordx4 v13, s[12:15], s21 offen offset:1024 lds
  buffer_load_dwordx4 v14, s[12:15], s21 offen offset:2048 lds
  buffer_load_dwordx4 v15, s[12:15], s21 offen offset:3072 lds
  s_add_u32 s21, s21, s22
  s_add_u32 s24, s24, 20480
  s_cmp_eq_u32 s24, 163840
  s_cselect_b32 s24, 0, s24
  s_add_u32 m0, s24, s42
  s_nop 0
  buffer_load_dwordx4 v12, s[12:15], s21 offen offset:0 lds
  buffer_load_dwordx4 v13, s[12:15], s21 offen offset:1024 lds
  buffer_load_dwordx4 v14, s[12:15], s21 offen offset:2048 lds
  buffer_load_dwordx4 v15, s[12:15], s21 offen offset:3072 lds
  s_add_u32 s21, s21, s22
  s_add_u32 s24, s24, 20480
  s_cmp_eq_u32 s24, 163840
  s_cselect_b32 s24, 0, s24
  s_add_u32 m0, s24, s42
  s_nop 0
  buffer_load_dwordx4 v12, s[12:15], s21 offen offset:0 lds
  buffer_load_dwordx4 v13, s[12:15], s21 offen offset:1024 lds
  buffer_load_dwordx4 v14, s[12:15], s21 offen offset:2048 lds
  buffer_load_dwordx4 v15, s[12:15], s21 offen offset:3072 lds
  s_add_u32 s21, s21, s22
  s_add_u32 s24, s24, 20480
  s_cmp_eq_u32 s24, 163840
  s_cselect_b32 s24, 0, s24
  s_add_u32 m0, s24, s42
  s_nop 0
  buffer_load_dwordx4 v12, s[12:15], s21 offen offset:0 lds
  buffer_load_dwordx4 v13, s[12:15], s21 offen offset:1024 lds
  buffer_load_dwordx4 v14, s[12:15], s21 offen offset:2048 lds
  buffer_load_dwordx4 v15, s[12:15], s21 offen offset:3072 lds
  s_add_u32 s21, s21, s22
  s_add_u32 s24, s24, 20480
  s_cmp_eq_u32 s24, 163840
  s_cselect_b32 s24, 0, s24
  s_add_u32 m0, s24, s42
  s_nop 0
  buffer_load_dwordx4 v12, s[12:15], s21 offen offset:0 lds
  buffer_load_dwordx4 v13, s[12:15], s21 offen offset:1024 lds
  buffer_load_dwordx4 v14, s[12:15], s21 offen offset:2048 lds
  buffer_load_dwordx4 v15, s[12:15], s21 offen offset:3072 lds
  s_add_u32 s21, s21, s22
  s_add_u32 s24, s24, 20480
  s_cmp_eq_u32 s24, 163840
  s_cselect_b32 s24, 0, s24
  s_add_u32 m0, s24, s42
  s_nop 0
  buffer_load_dwordx4 v12, s[12:15], s21 offen offset:0 lds
  buffer_load_dwordx4 v13, s[12:15], s21 offen offset:1024 lds
  buffer_load_dwordx4 v14, s[12:15], s21 offen offset:2048 lds
  buffer_load_dwordx4 v15, s[12:15], s21 offen offset:3072 lds
  s_add_u32 s21, s21, s22
  s_add_u32 s24, s24, 20480
  s_cmp_eq_u32 s24, 163840
  s_cselect_b32 s24, 0, s24
  s_add_u32 m0, s24, s42
  s_nop 0
  buffer_load_dwordx4 v12, s[12:15], s21 offen offset:0 lds
  buffer_load_dwordx4 v13, s[12:15], s21 offen offset:1024 lds
  buffer_load_dwordx4 v14, s[12:15], s21 offen offset:2048 lds
  buffer_load_dwordx4 v15, s[12:15], s21 offen offset:3072 lds
  s_add_u32 s21, s21, s22
  s_add_u32 s24, s24, 20480
  s_cmp_eq_u32 s24, 163840
  s_cselect_b32 s24, 0, s24
  s_cmp_lg_u32 s87, 0
  s_cbranch_scc1 DW_20_x
  s_and_b32 s3, s30, 0xf07
  s_cmp_gt_u32 s3, 2
  s_cbranch_scc1 DW_20_all
  s_and_b32 s3, s30, 0x48
  s_cbranch_scc0 DW_20_all
  s_cmp_lg_u32 s27, 0
  s_cbranch_scc1 Wx0_21_ok
  s_mov_b32 s4, 0
Wx0_21:
  buffer_load_dword v18, off, s[68:71], 0 offset:140 sc1
  s_add_u32 s4, s4, 1
  s_cmp_gt_u32 s4, 65536
  s_cbranch_scc1 L_abort
  s_waitcnt vmcnt(0)
  v_readfirstlane_b32 s3, v18
  s_cmp_ge_u32 s3, 9
  s_cbranch_scc1 Wx0_21_ok
  s_sleep 2
  s_branch Wx0_21
Wx0_21_ok:
  s_barrier
  s_branch DW_20
DW_20_all:
  s_cmp_lg_u32 s27, 0
  s_cbranch_scc1 Wxn_22_ok
  s_mov_b32 s4, 0
Wxn_22:
  buffer_load_dword v18, off, s[68:71], 0 offset:132 sc1
  s_add_u32 s4, s4, 1
  s_cmp_gt_u32 s4, 65536
  s_cbranch_scc1 L_abort
  s_waitcnt vmcnt(0)
  v_readfirstlane_b32 s3, v18
  s_cmp_ge_u32 s3, 1
  s_cbranch_scc1 Wxn_22_ok
  s_sleep 2
  s_branch Wxn_22
Wxn_22_ok:
  s_barrier
  s_mov_b32 s87, 1
DW_20_x:
  s_and_b32 s3, s30, 7
  s_cmp_lt_u32 s3, 4
  s_cbranch_scc1 DW_20
  s_bfe_u32 s7, s30, 262152
  s_cmp_eq_u32 s3, 4
  s_cbranch_scc0 DW_20_o
  s_lshl_b32 s7, s7, 7
  s_add_u32 s7, s7, 99616768
  s_cmp_lg_u32 s27, 0
  s_cbranch_scc1 Wdep_23_ok
  s_mov_b32 s4, 0
Wdep_23:
  buffer_load_dword v18, off, s[8:11], s7 offset:0 sc1
  s_add_u32 s4, s4, 1
  s_cmp_gt_u32 s4, 65536
  s_cbranch_scc1 L_abort
  s_waitcnt vmcnt(0)
  v_readfirstlane_b32 s3, v18
  s_cmp_ge_u32 s3, 28
  s_cbranch_scc1 Wdep_23_ok
  s_sleep 8
  s_branch Wdep_23
Wdep_23_ok:
  s_barrier
  s_branch DW_20
DW_20_o:
  s_cmp_lg_u32 s27, 0
  s_cbranch_scc1 DW_20_b
  s_bfe_u32 s5, s30, 262162
  s_lshl_b32 s5, s5, 8
  s_add_u32 s5, s5, 99618816
  s_lshr_b32 s3, s40, 2
  s_bfm_b64 exec, s3, 0
  v_lshlrev_b32 v19, 3, v0
  s_mov_b32 s4, 0
DW_20_p:
  buffer_load_dword v18, v19, s[8:11], s5 offen sc1
  s_add_u32 s4, s4, 1
  s_cmp_gt_u32 s4, 65536
  s_cbranch_scc1 L_abort
  s_waitcnt vmcnt(0)
  v_cmp_ge_u32 vcc, s7, v18
  s_cbranch_vccz DW_20_q
  v_cmp_gt_u32 vcc, s7, v18
  s_cbranch_vccz DW_20_r
  s_sleep 127
DW_20_r:
  s_sleep 3
  s_branch DW_20_p
DW_20_q:
  s_mov_b64 exec, -1
DW_20_b:
  s_barrier
DW_20:
  s_add_u32 m0, s41, 0
  s_nop 0
  buffer_load_dwordx4 v11, s[16:19], s20 offen offset:0 sc1 lds
  s_add_u32 s20, s20, 131072
  s_add_u32 m0, s41, 20480
  s_nop 0
  buffer_load_dwordx4 v11, s[16:19], s20 offen offset:0 sc1 lds
  s_add_u32 s20, s20, 131072
  s_add_u32 m0, s41, 40960
  s_nop 0
  buffer_load_dwordx4 v11, s[16:19], s20 offen offset:0 sc1 lds
  s_add_u32 s20, s20, 131072
  s_add_u32 m0, s41, 61440
  s_nop 0
  buffer_load_dwordx4 v11, s[16:19], s20 offen offset:0 sc1 lds
  s_add_u32 s20, s20, 131072
  s_add_u32 m0, s41, 81920
  s_nop 0
  buffer_load_dwordx4 v11, s[16:19], s20 offen offset:0 sc1 lds
  s_add_u32 s20, s20, 131072
  s_add_u32 m0, s41, 102400
  s_nop 0
  buffer_load_dwordx4 v11, s[16:19], s20 offen offset:0 sc1 lds
  s_add_u32 s20, s20, 131072
  s_add_u32 m0, s41, 122880
  s_nop 0
  buffer_load_dwordx4 v11, s[16:19], s20 offen offset:0 sc1 lds
  s_add_u32 s20, s20, 131072
  s_add_u32 m0, s41, 143360
  s_nop 0
  buffer_load_dwordx4 v11, s[16:19], s20 offen offset:0 sc1 lds
  s_add_u32 s20, s20, 131072
  v_mov_b32 v6, v1
  v_mov_b32 v7, v2
  v_mov_b32 v8, v3
  v_mov_b32 v9, v4
  v_mov_b32 v10, v5
  s_waitcnt vmcnt(1)
  s_barrier
  ds_read_b64_tr_b16 a[32:33], v7 offset:4096
  ds_read_b64_tr_b16 a[34:35], v7 offset:8192
  ds_read_b64_tr_b16 a[36:37], v8 offset:4096
  ds_read_b64_tr_b16 a[38:39], v8 offset:8192
  ds_read_b64_tr_b16 a[40:41], v9 offset:4096
  ds_read_b64_tr_b16 a[42:43], v9 offset:8192
  ds_read_b64_tr_b16 a[44:45], v10 offset:4096
  ds_read_b64_tr_b16 a[46:47], v10 offset:8192
  ds_read_b128 a[64:67], v6 offset:0
  ds_read_b128 a[68:71], v6 offset:1024
G2_task:
  s_sub_u32 s32, s40, 9
  s_sub_u32 s33, s40, 1
  s_cmp_lg_u32 s35, 0
  s_cselect_b32 s43, 7, s32
  s_waitcnt lgkmcnt(0)
  v_mfma_f32_16x16x32_bf16 v[32:35], a[32:35], a[64:67], 0
  ds_read_b64_tr_b16 a[48:49], v7 offset:12288
  ds_read_b64_tr_b16 a[50:51], v7 offset:16384
  ds_read_b64_tr_b16 a[52:53], v8 offset:12288
  v_mfma_f32_16x16x32_bf16 v[36:39], a[32:35], a[68:71], 0
  ds_read_b64_tr_b16 a[54:55], v8 offset:16384
  ds_read_b64_tr_b16 a[56:57], v9 offset:12288
  ds_read_b64_tr_b16 a[58:59], v9 offset:16384
  v_mfma_f32_16x16x32_bf16 v[40:43], a[36:39], a[64:67], 0
  ds_read_b64_tr_b16 a[60:61], v10 offset:12288
  ds_read_b64_tr_b16 a[62:63], v10 offset:16384
  s_add_u32 m0, s24, s42
  v_mfma_f32_16x16x32_bf16 v[44:47], a[36:39], a[68:71], 0
  s_add_u32 s25, s25, 20480
  s_cmp_eq_u32 s25, 163840
  s_cselect_b32 s25, 0, s25
  v_add_u32 v6, s25, v1
  v_add_u32 v7, s25, v2
  buffer_load_dwordx4 v12, s[12:15], s21 offen offset:0 lds
  v_mfma_f32_16x16x32_bf16 v[48:51], a[40:43], a[64:67], 0
  v_add_u32 v8, s25, v3
  v_add_u32 v9, s25, v4
  v_add_u32 v10, s25, v5
  buffer_load_dwordx4 v13, s[12:15], s21 offen offset:1024 lds
  v_mfma_f32_16x16x32_bf16 v[52:55], a[40:43], a[68:71], 0
  buffer_load_dwordx4 v14, s[12:15], s21 offen offset:2048 lds
  v_mfma_f32_16x16x32_bf16 v[56:59], a[44:47], a[64:67], 0
  buffer_load_dwordx4 v15, s[12:15], s21 offen offset:3072 lds
  v_mfma_f32_16x16x32_bf16 v[60:63], a[44:47], a[68:71], 0
  s_add_u32 s21, s21, s22
  s_add_u32 s24, s24, 20480
  s_cmp_eq_u32 s24, 163840
  s_cselect_b32 s24, 0, s24
  s_cmp_eq_u32 s40, 8
  s_cselect_b32 s14, 0, s14
  s_cselect_b32 s18, 0, s18
  s_waitcnt lgkmcnt(0) vmcnt(30)
  s_barrier
  v_mfma_f32_16x16x32_bf16 v[64:67], a[48:51], a[64:67], 0
  ds_read_b64_tr_b16 a[32:33], v7 offset:4096
  ds_read_b64_tr_b16 a[34:35], v7 offset:8192
  ds_read_b128 a[96:99], v6 offset:0
  v_mfma_f32_16x16x32_bf16 v[68:71], a[48:51], a[68:71], 0
  ds_read_b128 a[100:103], v6 offset:1024
  ds_read_b64_tr_b16 a[36:37], v8 offset:4096
  ds_read_b64_tr_b16 a[38:39], v8 offset:8192
  v_mfma_f32_16x16x32_bf16 v[72:75], a[52:55], a[64:67], 0
  ds_read_b64_tr_b16 a[40:41], v9 offset:4096
  ds_read_b64_tr_b16 a[42:43], v9 offset:8192
  ds_read_b64_tr_b16 a[44:45], v10 offset:4096
  v_mfma_f32_16x16x32_bf16 v[76:79], a[52:55], a[68:71], 0
  ds_read_b64_tr_b16 a[46:47], v10 offset:8192
  v_mfma_f32_16x16x32_bf16 v[80:83], a[56:59], a[64:67], 0
  s_add_u32 m0, s24, s41
  v_mfma_f32_16x16x32_bf16 v[84:87], a[56:59], a[68:71], 0
  buffer_load_dwordx4 v11, s[16:19], s20 offen offset:0 sc1 lds
  v_mfma_f32_16x16x32_bf16 v[88:91], a[60:63], a[64:67], 0
  v_mfma_f32_16x16x32_bf16 v[92:95], a[60:63], a[68:71], 0
  s_add_u32 s20, s20, 131072
  s_waitcnt lgkmcnt(0)
  v_mfma_f32_16x16x32_bf16 v[32:35], a[32:35], a[96:99], v[32:35]
  ds_read_b64_tr_b16 a[48:49], v7 offset:12288
  ds_read_b64_tr_b16 a[50:51], v7 offset:16384
  ds_read_b64_tr_b16 a[52:53], v8 offset:12288
  v_mfma_f32_16x16x32_bf16 v[36:39], a[32:35], a[100:103], v[36:39]
  ds_read_b64_tr_b16 a[54:55], v8 offset:16384
  ds_read_b64_tr_b16 a[56:57], v9 offset:12288
  ds_read_b64_tr_b16 a[58:59], v9 offset:16384
  v_mfma_f32_16x16x32_bf16 v[40:43], a[36:39], a[96:99], v[40:43]
  ds_read_b64_tr_b16 a[60:61], v10 offset:12288
  ds_read_b64_tr_b16 a[62:63], v10 offset:16384
  s_add_u32 m0, s24, s42
  v_mfma_f32_16x16x32_bf16 v[44:47], a[36:39], a[100:103], v[44:47]
  s_add_u32 s25, s25, 20480
  s_cmp_eq_u32 s25, 163840
  s_cselect_b32 s25, 0, s25
  v_add_u32 v6, s25, v1
  v_add_u32 v7, s25, v2
  buffer_load_dwordx4 v12, s[12:15], s21 offen offset:0 lds
  v_mfma_f32_16x16x32_bf16 v[48:51], a[40:43], a[96:99], v[48:51]
  v_add_u32 v8, s25, v3
  v_add_u32 v9, s25, v4
  v_add_u32 v10, s25, v5
  buffer_load_dwordx4 v13, s[12:15], s21 offen offset:1024 lds
  v_mfma_f32_16x16x32_bf16 v[52:55], a[40:43], a[100:103], v[52:55]
  buffer_load_dwordx4 v14, s[12:15], s21 offen offset:2048 lds
  v_mfma_f32_16x16x32_bf16 v[56:59], a[44:47], a[96:99], v[56:59]
  buffer_load_dwordx4 v15, s[12:15], s21 offen offset:3072 lds
  v_mfma_f32_16x16x32_bf16 v[60:63], a[44:47], a[100:103], v[60:63]
  s_add_u32 s21, s21, s22
  s_add_u32 s24, s24, 20480
  s_cmp_eq_u32 s24, 163840
  s_cselect_b32 s24, 0, s24
  s_mov_b32 s26, 1
.p2align 6
G2_loop:
  s_waitcnt lgkmcnt(0) vmcnt(30)
  s_barrier
  v_mfma_f32_16x16x32_bf16 v[64:67], a[48:51], a[96:99], v[64:67]
  ds_read_b64_tr_b16 a[32:33], v7 offset:4096
  ds_read_b64_tr_b16 a[34:35], v7 offset:8192
  ds_read_b128 a[64:67], v6 offset:0
  v_mfma_f32_16x16x32_bf16 v[68:71], a[48:51], a[100:103], v[68:71]
  ds_read_b128 a[68:71], v6 offset:1024
  ds_read_b64_tr_b16 a[36:37], v8 offset:4096
  ds_read_b64_tr_b16 a[38:39], v8 offset:8192
  v_mfma_f32_16x16x32_bf16 v[72:75], a[52:55], a[96:99], v[72:75]
  ds_read_b64_tr_b16 a[40:41], v9 offset:4096
  ds_read_b64_tr_b16 a[42:43], v9 offset:8192
  ds_read_b64_tr_b16 a[44:45], v10 offset:4096
  v_mfma_f32_16x16x32_bf16 v[76:79], a[52:55], a[100:103], v[76:79]
  ds_read_b64_tr_b16 a[46:47], v10 offset:8192
  v_mfma_f32_16x16x32_bf16 v[80:83], a[56:59], a[96:99], v[80:83]
  s_add_u32 m0, s24, s41
  v_mfma_f32_16x16x32_bf16 v[84:87], a[56:59], a[100:103], v[84:87]
  buffer_load_dwordx4 v11, s[16:19], s20 offen offset:0 sc1 lds
  v_mfma_f32_16x16x32_bf16 v[88:91], a[60:63], a[96:99], v[88:91]
  v_mfma_f32_16x16x32_bf16 v[92:95], a[60:63], a[100:103], v[92:95]
  s_add_u32 s20, s20, 131072
  s_cmp_eq_u32 s26, s33
  s_cbranch_scc1 G2_epi
  s_waitcnt lgkmcnt(0)
  v_mfma_f32_16x16x32_bf16 v[32:35], a[32:35], a[64:67], v[32:35]
  ds_read_b64_tr_b16 a[48:49], v7 offset:12288
  ds_read_b64_tr_b16 a[50:51], v7 offset:16384
  ds_read_b64_tr_b16 a[52:53], v8 offset:12288
  v_mfma_f32_16x16x32_bf16 v[36:39], a[32:35], a[68:71], v[36:39]
  ds_read_b64_tr_b16 a[54:55], v8 offset:16384
  ds_read_b64_tr_b16 a[56:57], v9 offset:12288
  ds_read_b64_tr_b16 a[58:59], v9 offset:16384
  v_mfma_f32_16x16x32_bf16 v[40:43], a[36:39], a[64:67], v[40:43]
  ds_read_b64_tr_b16 a[60:61], v10 offset:12288
  ds_read_b64_tr_b16 a[62:63], v10 offset:16384
  s_add_u32 m0, s24, s42
  v_mfma_f32_16x16x32_bf16 v[44:47], a[36:39], a[68:71], v[44:47]
  s_add_u32 s25, s25, 20480
  s_cmp_eq_u32 s25, 163840
  s_cselect_b32 s25, 0, s25
  v_add_u32 v6, s25, v1
  v_add_u32 v7, s25, v2
  buffer_load_dwordx4 v12, s[12:15], s21 offen offset:0 lds
  v_mfma_f32_16x16x32_bf16 v[48:51], a[40:43], a[64:67], v[48:51]
  v_add_u32 v8, s25, v3
  v_add_u32 v9, s25, v4
  v_add_u32 v10, s25, v5
  buffer_load_dwordx4 v13, s[12:15], s21 offen offset:1024 lds
  v_mfma_f32_16x16x32_bf16 v[52:55], a[40:43], a[68:71], v[52:55]
  buffer_load_dwordx4 v14, s[12:15], s21 offen offset:2048 lds
  v_mfma_f32_16x16x32_bf16 v[56:59], a[44:47], a[64:67], v[56:59]
  buffer_load_dwordx4 v15, s[12:15], s21 offen offset:3072 lds
  v_mfma_f32_16x16x32_bf16 v[60:63], a[44:47], a[68:71], v[60:63]
  s_add_u32 s21, s21, s22
  s_add_u32 s24, s24, 20480
  s_cmp_eq_u32 s24, 163840
  s_cselect_b32 s24, 0, s24
  s_cmp_eq_u32 s26, s43
  s_cbranch_scc1 G2_event
G2_back:
  s_waitcnt lgkmcnt(0) vmcnt(30)
  s_barrier
  v_mfma_f32_16x16x32_bf16 v[64:67], a[48:51], a[64:67], v[64:67]
  ds_read_b64_tr_b16 a[32:33], v7 offset:4096
  ds_read_b64_tr_b16 a[34:35], v7 offset:8192
  ds_read_b128 a[96:99], v6 offset:0
  v_mfma_f32_16x16x32_bf16 v[68:71], a[48:51], a[68:71], v[68:71]
  ds_read_b128 a[100:103], v6 offset:1024
  ds_read_b64_tr_b16 a[36:37], v8 offset:4096
  ds_read_b64_tr_b16 a[38:39], v8 offset:8192
  v_mfma_f32_16x16x32_bf16 v[72:75], a[52:55], a[64:67], v[72:75]
  ds_read_b64_tr_b16 a[40:41], v9 offset:4096
  ds_read_b64_tr_b16 a[42:43], v9 offset:8192
  ds_read_b64_tr_b16 a[44:45], v10 offset:4096
  v_mfma_f32_16x16x32_bf16 v[76:79], a[52:55], a[68:71], v[76:79]
  ds_read_b64_tr_b16 a[46:47], v10 offset:8192
  v_mfma_f32_16x16x32_bf16 v[80:83], a[56:59], a[64:67], v[80:83]
  s_add_u32 m0, s24, s41
  v_mfma_f32_16x16x32_bf16 v[84:87], a[56:59], a[68:71], v[84:87]
  buffer_load_dwordx4 v11, s[16:19], s20 offen offset:0 sc1 lds
  v_mfma_f32_16x16x32_bf16 v[88:91], a[60:63], a[64:67], v[88:91]
  v_mfma_f32_16x16x32_bf16 v[92:95], a[60:63], a[68:71], v[92:95]
  s_add_u32 s20, s20, 131072
  s_waitcnt lgkmcnt(0)
  v_mfma_f32_16x16x32_bf16 v[32:35], a[32:35], a[96:99], v[32:35]
  ds_read_b64_tr_b16 a[48:49], v7 offset:12288
  ds_read_b64_tr_b16 a[50:51], v7 offset:16384
  ds_read_b64_tr_b16 a[52:53], v8 offset:12288
  v_mfma_f32_16x16x32_bf16 v[36:39], a[32:35], a[100:103], v[36:39]
  ds_read_b64_tr_b16 a[54:55], v8 offset:16384
  ds_read_b64_tr_b16 a[56:57], v9 offset:12288
  ds_read_b64_tr_b16 a[58:59], v9 offset:16384
  v_mfma_f32_16x16x32_bf16 v[40:43], a[36:39], a[96:99], v[40:43]
  ds_read_b64_tr_b16 a[60:61], v10 offset:12288
  ds_read_b64_tr_b16 a[62:63], v10 offset:16384
  s_add_u32 m0, s24, s42
  v_mfma_f32_16x16x32_bf16 v[44:47], a[36:39], a[100:103], v[44:47]
  s_add_u32 s25, s25, 20480
  s_cmp_eq_u32 s25, 163840
  s_cselect_b32 s25, 0, s25
  v_add_u32 v6, s25, v1
  v_add_u32 v7, s25, v2
  buffer_load_dwordx4 v12, s[12:15], s21 offen offset:0 lds
  v_mfma_f32_16x16x32_bf16 v[48:51], a[40:43], a[96:99], v[48:51]
  v_add_u32 v8, s25, v3
  v_add_u32 v9, s25, v4
  v_add_u32 v10, s25, v5
  buffer_load_dwordx4 v13, s[12:15], s21 offen offset:1024 lds
  v_mfma_f32_16x16x32_bf16 v[52:55], a[40:43], a[100:103], v[52:55]
  buffer_load_dwordx4 v14, s[12:15], s21 offen offset:2048 lds
  v_mfma_f32_16x16x32_bf16 v[56:59], a[44:47], a[96:99], v[56:59]
  buffer_load_dwordx4 v15, s[12:15], s21 offen offset:3072 lds
  v_mfma_f32_16x16x32_bf16 v[60:63], a[44:47], a[100:103], v[60:63]
  s_add_u32 s21, s21, s22
  s_add_u32 s24, s24, 20480
  s_cmp_eq_u32 s24, 163840
  s_cselect_b32 s24, 0, s24
  s_add_u32 s26, s26, 2
  s_branch G2_loop
G2_event:
  s_cmp_eq_u32 s26, s32
  s_cbranch_scc1 G2_switch
  s_cmp_lg_u32 s27, 0
  s_cbranch_scc1 SIG_24
  v_mov_b32 v18, s37
  s_mov_b64 exec, 1
  buffer_atomic_add v18, off, s[8:11], s35 sc1
  s_cmp_eq_u32 s36, 0
  s_cbranch_scc1 SIG_24_1
  buffer_atomic_add v18, off, s[8:11], s36 sc1
SIG_24_1:
  s_mov_b64 exec, -1
SIG_24:
  s_mov_b32 s35, 0
  s_mov_b32 s43, s32
  s_branch G2_back
G2_switch:
  s_bitcmp1_b32 s31, 4
  s_cbranch_scc1 G2_sw1
  s_mov_b32 s14, 0
  s_mov_b32 s18, 0
  s_branch G2_back
G2_sw1:
  s_bfe_u32 s4, s31, 262152
  s_bfe_u32 s5, s31, 393228
  s_bfe_u32 s20, s31, 0x50007
  s_lshl_b32 s20, s20, 12
  s_mov_b32 s18, s10
  s_mov_b32 s40, 32
  s_and_b32 s3, s31, 7
  s_cmp_eq_u32 s3, 2
  s_cbranch_scc1 SLG2s_v
  s_cmp_eq_u32 s3, 3
  s_cbranch_scc1 SLG2s_fu
  s_cmp_eq_u32 s3, 4
  s_cbranch_scc1 SLG2s_fd
  s_cmp_eq_u32 s3, 5
  s_cbranch_scc1 SLG2s_wo
  s_cmp_eq_u32 s28, 0
  s_cselect_b32 s12, s60, s62
  s_cselect_b32 s13, s61, s63
  s_mov_b32 s14, 8388608
  s_mov_b32 s22, 262144
  s_lshl_b32 s21, s5, 8
  v_mul_u32_u24 v18, 8192, v16
  v_xor_b32 v20, 0x80, v17
  v_add_u32 v12, v18, v17
  v_add_u32 v13, v18, v20
  v_add_u32 v13, 31744, v13
  v_add_u32 v14, 63488, v12
  v_add_u32 v15, 63488, v13
  s_branch SLG2s_done
SLG2s_v:
  s_mov_b32 s12, s64
  s_mov_b32 s13, s65
  s_mov_b32 s14, 8388608
  s_mov_b32 s22, 262144
  s_lshl_b32 s21, s5, 9
  s_lshl_b32 s3, s28, 8
  s_add_u32 s21, s21, s3
  v_mul_u32_u24 v18, 8192, v16
  v_xor_b32 v20, 0x80, v17
  v_add_u32 v12, v18, v17
  v_add_u32 v13, v18, v20
  v_add_u32 v13, 31744, v13
  v_add_u32 v14, 63488, v12
  v_add_u32 v15, 63488, v13
  s_branch SLG2s_done
SLG2s_fu:
  s_cmp_eq_u32 s28, 0
  s_cselect_b32 s12, s72, s74
  s_cselect_b32 s13, s73, s75
  s_mov_b32 s14, 7340032
  s_mov_b32 s22, 229376
  s_lshl_b32 s21, s5, 8
  v_mul_u32_u24 v18, 7168, v16
  v_xor_b32 v20, 0x80, v17
  v_add_u32 v12, v18, v17
  v_add_u32 v13, v18, v20
  v_add_u32 v13, 27648, v13
  v_add_u32 v14, 55296, v12
  v_add_u32 v15, 55296, v13
  s_branch SLG2s_done
SLG2s_fd:
  s_mov_b32 s12, s76
  s_mov_b32 s13, s77
  s_mov_b32 s14, 7340032
  s_mov_b32 s22, 65536
  s_lshl_b32 s21, s5, 9
  s_lshl_b32 s3, s28, 8
  s_add_u32 s21, s21, s3
  s_add_u32 s20, s20, 54525952
  s_mov_b32 s40, 112
  v_mul_u32_u24 v18, 2048, v16
  v_xor_b32 v20, 0x80, v17
  v_add_u32 v12, v18, v17
  v_add_u32 v13, v18, v20
  v_add_u32 v13, 7168, v13
  v_add_u32 v14, 14336, v12
  v_add_u32 v15, 14336, v13
  s_branch SLG2s_done
SLG2s_wo:
  s_mov_b32 s12, s66
  s_mov_b32 s13, s67
  s_mov_b32 s14, 8388608
  s_mov_b32 s22, 65536
  s_lshl_b32 s21, s5, 9
  s_lshl_b32 s3, s28, 8
  s_add_u32 s21, s21, s3
  s_bfe_u32 s3, s31, 262162
  s_lshl_b32 s4, s3, 19
  s_add_u32 s21, s21, s4
  s_lshl_b32 s4, s3, 20
  s_add_u32 s20, s20, s4
  s_add_u32 s20, s20, 69206016
  s_bfe_u32 s40, s31, 262166
  s_add_u32 s40, s40, 1
  s_lshl_b32 s40, s40, 3
  v_mul_u32_u24 v18, 2048, v16
  v_xor_b32 v20, 0x80, v17
  v_add_u32 v12, v18, v17
  v_add_u32 v13, v18, v20
  v_add_u32 v13, 7168, v13
  v_add_u32 v14, 14336, v12
  v_add_u32 v15, 14336, v13
SLG2s_done:
  s_branch G2_back
G2_epi:
  s_bfe_u32 s4, s30, 262152
  s_bfe_u32 s5, s30, 393228
  s_bfe_u32 s6, s30, 0x50007
  s_lshl_b32 s6, s6, 2
  s_mul_i32 s3, s28, 2
  s_add_u32 s6, s6, s3
  s_lshl_b32 s35, s4, 7
  s_add_u32 s35, s35, 99614720
  s_mov_b32 s37, 1
  s_and_b32 s3, s30, 7
  s_cmp_ge_u32 s3, 4
  s_cbranch_scc1 G2_fd
  s_add_u32 s35, s35, 0
  s_mov_b32 s36, 0
  s_lshr_b32 s6, s6, 1
  s_mul_i32 s6, s6, 24576
  s_mul_i32 s5, s5, 1572864
  s_add_u32 s6, s6, s5
  s_add_u32 s5, s5, 16384
  s_cmp_eq_u32 s3, 2
  s_cselect_b32 s5, s5, 0
  s_mov_b32 s7, 8192
  s_cmov_b32 s7, 1572864
  s_add_u32 s6, s6, s5
  s_lshl_b32 s3, s29, 11
  s_add_u32 s6, s6, s3
  s_add_u32 s6, s6, 4194304
  v_cvt_pk_bf16_f32 v32, v32, v33
  v_cvt_pk_bf16_f32 v33, v34, v35
  v_cvt_pk_bf16_f32 v34, v40, v41
  v_cvt_pk_bf16_f32 v35, v42, v43
  s_add_u32 s3, s6, 0
  buffer_store_dwordx4 v[32:35], v0, s[8:11], s3 offen offset:0 sc1
  v_cvt_pk_bf16_f32 v36, v36, v37
  v_cvt_pk_bf16_f32 v37, v38, v39
  v_cvt_pk_bf16_f32 v38, v44, v45
  v_cvt_pk_bf16_f32 v39, v46, v47
  s_add_u32 s3, s6, 4096
  buffer_store_dwordx4 v[36:39], v0, s[8:11], s3 offen offset:0 sc1
  v_cvt_pk_bf16_f32 v48, v48, v49
  v_cvt_pk_bf16_f32 v49, v50, v51
  v_cvt_pk_bf16_f32 v50, v56, v57
  v_cvt_pk_bf16_f32 v51, v58, v59
  s_add_u32 s3, s6, 0
  buffer_store_dwordx4 v[48:51], v0, s[8:11], s3 offen offset:1024 sc1
  v_cvt_pk_bf16_f32 v52, v52, v53
  v_cvt_pk_bf16_f32 v53, v54, v55
  v_cvt_pk_bf16_f32 v54, v60, v61
  v_cvt_pk_bf16_f32 v55, v62, v63
  s_add_u32 s3, s6, 4096
  buffer_store_dwordx4 v[52:55], v0, s[8:11], s3 offen offset:1024 sc1
  s_add_u32 s6, s6, s7
  v_cvt_pk_bf16_f32 v64, v64, v65
  v_cvt_pk_bf16_f32 v65, v66, v67
  v_cvt_pk_bf16_f32 v66, v72, v73
  v_cvt_pk_bf16_f32 v67, v74, v75
  s_add_u32 s3, s6, 0
  buffer_store_dwordx4 v[64:67], v0, s[8:11], s3 offen offset:0 sc1
  v_cvt_pk_bf16_f32 v68, v68, v69
  v_cvt_pk_bf16_f32 v69, v70, v71
  v_cvt_pk_bf16_f32 v70, v76, v77
  v_cvt_pk_bf16_f32 v71, v78, v79
  s_add_u32 s3, s6, 4096
  buffer_store_dwordx4 v[68:71], v0, s[8:11], s3 offen offset:0 sc1
  v_cvt_pk_bf16_f32 v80, v80, v81
  v_cvt_pk_bf16_f32 v81, v82, v83
  v_cvt_pk_bf16_f32 v82, v88, v89
  v_cvt_pk_bf16_f32 v83, v90, v91
  s_add_u32 s3, s6, 0
  buffer_store_dwordx4 v[80:83], v0, s[8:11], s3 offen offset:1024 sc1
  v_cvt_pk_bf16_f32 v84, v84, v85
  v_cvt_pk_bf16_f32 v85, v86, v87
  v_cvt_pk_bf16_f32 v86, v92, v93
  v_cvt_pk_bf16_f32 v87, v94, v95
  s_add_u32 s3, s6, 4096
  buffer_store_dwordx4 v[84:87], v0, s[8:11], s3 offen offset:1024 sc1
G2_done:
  s_bitcmp1_b32 s31, 4
  s_cbranch_scc0 L_drain
  s_mov_b32 s30, s31
  s_add_u32 s38, s38, 4
  s_addc_u32 s39, s39, 0
  s_load_dword s31, s[38:39], 0
  s_branch G2_task
G2_fd:
  s_lshl_b32 s35, s4, 2
  s_add_u32 s35, s35, s5
  s_lshl_b32 s35, s35, 7
  s_add_u32 s35, s35, 99622912
  s_mov_b32 s36, 0
  s_mov_b32 s37, 1
  s_lshl_b32 s6, s6, 15
  s_lshl_b32 s5, s5, 9
  s_add_u32 s6, s6, s5
  s_lshl_b32 s5, s29, 7
  s_add_u32 s6, s6, s5
  v_lshrrev_b32 v20, 4, v0
  v_and_b32 v21, 15, v20
  v_lshlrev_b32 v21, 11, v21
  v_bfe_u32 v22, v20, 4, 1
  v_lshl_add_u32 v21, v22, 5, v21
  v_lshrrev_b32 v22, 5, v20
  v_lshl_add_u32 v21, v22, 4, v21
  s_mov_b32 s44, s56
  s_mov_b32 s45, s57
  s_mov_b32 s46, 0x400000
  s_mov_b32 s47, 0x20000
  s_mov_b32 s48, s82
  s_mov_b32 s49, s83
  s_mov_b32 s50, 0x10000000
  s_mov_b32 s51, 0x20000
  s_mov_b32 s7, s6
  s_bfe_u32 s5, s30, 327706
  s_lshl_b32 s5, s5, 22
  s_add_u32 s5, s5, 100663296
  s_cmp_eq_u32 s5, 100663296
  s_cselect_b32 s46, s46, 0
  s_bitcmp1_b32 s30, 5
  s_cbranch_scc0 G2_fd2
  s_cmp_lg_u32 s27, 0
  s_cbranch_scc1 Wy0_25_ok
  s_mov_b32 s4, 0
Wy0_25:
  buffer_load_dword v18, off, s[8:11], s35 offset:0 sc1
  s_add_u32 s4, s4, 1
  s_cmp_gt_u32 s4, 65536
  s_cbranch_scc1 L_abort
  s_waitcnt vmcnt(0)
  v_readfirstlane_b32 s3, v18
  s_cmp_ge_u32 s3, 2
  s_cbranch_scc1 Wy0_25_ok
  s_sleep 8
  s_branch Wy0_25
Wy0_25_ok:
  s_barrier
  s_mov_b32 s44, s82
  s_mov_b32 s45, s83
  s_mov_b32 s46, 0x10000000
  s_mov_b32 s47, 0x20000
  s_mov_b32 s48, s78
  s_mov_b32 s49, s79
  s_mov_b32 s50, 0x400000
  s_mov_b32 s51, 0x20000
  s_add_u32 s7, s6, 100663296
  s_mov_b32 s5, 0
G2_fd2:
  s_add_u32 s6, s6, s5
  s_add_u32 s3, s7, 0
  buffer_load_dwordx4 v[160:163], v21, s[44:47], s3 offen offset:0 sc1
  buffer_load_dwordx4 v[164:167], v21, s[44:47], s3 offen offset:64 sc1
  buffer_load_dwordx4 v[168:171], v21, s[44:47], s3 offen offset:256 sc1
  buffer_load_dwordx4 v[172:175], v21, s[44:47], s3 offen offset:320 sc1
  s_add_u32 s3, s7, 32768
  buffer_load_dwordx4 v[176:179], v21, s[44:47], s3 offen offset:0 sc1
  buffer_load_dwordx4 v[180:183], v21, s[44:47], s3 offen offset:64 sc1
  buffer_load_dwordx4 v[184:187], v21, s[44:47], s3 offen offset:256 sc1
  buffer_load_dwordx4 v[188:191], v21, s[44:47], s3 offen offset:320 sc1
  v_permlane16_swap_b32 v32, v40
  v_permlane16_swap_b32 v33, v41
  v_permlane16_swap_b32 v34, v42
  v_permlane16_swap_b32 v35, v43
  v_permlane16_swap_b32 v48, v56
  v_permlane16_swap_b32 v49, v57
  v_permlane16_swap_b32 v50, v58
  v_permlane16_swap_b32 v51, v59
  v_permlane16_swap_b32 v64, v72
  v_permlane16_swap_b32 v65, v73
  v_permlane16_swap_b32 v66, v74
  v_permlane16_swap_b32 v67, v75
  v_permlane16_swap_b32 v80, v88
  v_permlane16_swap_b32 v81, v89
  v_permlane16_swap_b32 v82, v90
  v_permlane16_swap_b32 v83, v91
  v_permlane16_swap_b32 v36, v44
  v_permlane16_swap_b32 v37, v45
  v_permlane16_swap_b32 v38, v46
  v_permlane16_swap_b32 v39, v47
  v_permlane16_swap_b32 v52, v60
  v_permlane16_swap_b32 v53, v61
  v_permlane16_swap_b32 v54, v62
  v_permlane16_swap_b32 v55, v63
  v_permlane16_swap_b32 v68, v76
  v_permlane16_swap_b32 v69, v77
  v_permlane16_swap_b32 v70, v78
  v_permlane16_swap_b32 v71, v79
  v_permlane16_swap_b32 v84, v92
  v_permlane16_swap_b32 v85, v93
  v_permlane16_swap_b32 v86, v94
  v_permlane16_swap_b32 v87, v95
  s_add_u32 s3, s6, 0
  s_waitcnt vmcnt(4)
  v_lshlrev_b32 v22, 16, v160
  v_and_b32 v23, 0xffff0000, v160
  v_pk_add_f32 v[22:23], v[22:23], v[32:33]
  v_cvt_pk_bf16_f32 v160, v22, v23
  v_lshlrev_b32 v22, 16, v161
  v_and_b32 v23, 0xffff0000, v161
  v_pk_add_f32 v[22:23], v[22:23], v[34:35]
  v_cvt_pk_bf16_f32 v161, v22, v23
  v_lshlrev_b32 v22, 16, v162
  v_and_b32 v23, 0xffff0000, v162
  v_pk_add_f32 v[22:23], v[22:23], v[40:41]
  v_cvt_pk_bf16_f32 v162, v22, v23
  v_lshlrev_b32 v22, 16, v163
  v_and_b32 v23, 0xffff0000, v163
  v_pk_add_f32 v[22:23], v[22:23], v[42:43]
  v_cvt_pk_bf16_f32 v163, v22, v23
  buffer_store_dwordx4 v[160:163], v21, s[48:51], s3 offen offset:0 sc1
  v_lshlrev_b32 v22, 16, v164
  v_and_b32 v23, 0xffff0000, v164
  v_pk_add_f32 v[22:23], v[22:23], v[48:49]
  v_cvt_pk_bf16_f32 v164, v22, v23
  v_lshlrev_b32 v22, 16, v165
  v_and_b32 v23, 0xffff0000, v165
  v_pk_add_f32 v[22:23], v[22:23], v[50:51]
  v_cvt_pk_bf16_f32 v165, v22, v23
  v_lshlrev_b32 v22, 16, v166
  v_and_b32 v23, 0xffff0000, v166
  v_pk_add_f32 v[22:23], v[22:23], v[56:57]
  v_cvt_pk_bf16_f32 v166, v22, v23
  v_lshlrev_b32 v22, 16, v167
  v_and_b32 v23, 0xffff0000, v167
  v_pk_add_f32 v[22:23], v[22:23], v[58:59]
  v_cvt_pk_bf16_f32 v167, v22, v23
  buffer_store_dwordx4 v[164:167], v21, s[48:51], s3 offen offset:64 sc1
  v_lshlrev_b32 v22, 16, v168
  v_and_b32 v23, 0xffff0000, v168
  v_pk_add_f32 v[22:23], v[22:23], v[64:65]
  v_cvt_pk_bf16_f32 v168, v22, v23
  v_lshlrev_b32 v22, 16, v169
  v_and_b32 v23, 0xffff0000, v169
  v_pk_add_f32 v[22:23], v[22:23], v[66:67]
  v_cvt_pk_bf16_f32 v169, v22, v23
  v_lshlrev_b32 v22, 16, v170
  v_and_b32 v23, 0xffff0000, v170
  v_pk_add_f32 v[22:23], v[22:23], v[72:73]
  v_cvt_pk_bf16_f32 v170, v22, v23
  v_lshlrev_b32 v22, 16, v171
  v_and_b32 v23, 0xffff0000, v171
  v_pk_add_f32 v[22:23], v[22:23], v[74:75]
  v_cvt_pk_bf16_f32 v171, v22, v23
  buffer_store_dwordx4 v[168:171], v21, s[48:51], s3 offen offset:256 sc1
  v_lshlrev_b32 v22, 16, v172
  v_and_b32 v23, 0xffff0000, v172
  v_pk_add_f32 v[22:23], v[22:23], v[80:81]
  v_cvt_pk_bf16_f32 v172, v22, v23
  v_lshlrev_b32 v22, 16, v173
  v_and_b32 v23, 0xffff0000, v173
  v_pk_add_f32 v[22:23], v[22:23], v[82:83]
  v_cvt_pk_bf16_f32 v173, v22, v23
  v_lshlrev_b32 v22, 16, v174
  v_and_b32 v23, 0xffff0000, v174
  v_pk_add_f32 v[22:23], v[22:23], v[88:89]
  v_cvt_pk_bf16_f32 v174, v22, v23
  v_lshlrev_b32 v22, 16, v175
  v_and_b32 v23, 0xffff0000, v175
  v_pk_add_f32 v[22:23], v[22:23], v[90:91]
  v_cvt_pk_bf16_f32 v175, v22, v23
  buffer_store_dwordx4 v[172:175], v21, s[48:51], s3 offen offset:320 sc1
  s_add_u32 s3, s6, 32768
  s_waitcnt vmcnt(4)
  v_lshlrev_b32 v22, 16, v176
  v_and_b32 v23, 0xffff0000, v176
  v_pk_add_f32 v[22:23], v[22:23], v[36:37]
  v_cvt_pk_bf16_f32 v176, v22, v23
  v_lshlrev_b32 v22, 16, v177
  v_and_b32 v23, 0xffff0000, v177
  v_pk_add_f32 v[22:23], v[22:23], v[38:39]
  v_cvt_pk_bf16_f32 v177, v22, v23
  v_lshlrev_b32 v22, 16, v178
  v_and_b32 v23, 0xffff0000, v178
  v_pk_add_f32 v[22:23], v[22:23], v[44:45]
  v_cvt_pk_bf16_f32 v178, v22, v23
  v_lshlrev_b32 v22, 16, v179
  v_and_b32 v23, 0xffff0000, v179
  v_pk_add_f32 v[22:23], v[22:23], v[46:47]
  v_cvt_pk_bf16_f32 v179, v22, v23
  buffer_store_dwordx4 v[176:179], v21, s[48:51], s3 offen offset:0 sc1
  v_lshlrev_b32 v22, 16, v180
  v_and_b32 v23, 0xffff0000, v180
  v_pk_add_f32 v[22:23], v[22:23], v[52:53]
  v_cvt_pk_bf16_f32 v180, v22, v23
  v_lshlrev_b32 v22, 16, v181
  v_and_b32 v23, 0xffff0000, v181
  v_pk_add_f32 v[22:23], v[22:23], v[54:55]
  v_cvt_pk_bf16_f32 v181, v22, v23
  v_lshlrev_b32 v22, 16, v182
  v_and_b32 v23, 0xffff0000, v182
  v_pk_add_f32 v[22:23], v[22:23], v[60:61]
  v_cvt_pk_bf16_f32 v182, v22, v23
  v_lshlrev_b32 v22, 16, v183
  v_and_b32 v23, 0xffff0000, v183
  v_pk_add_f32 v[22:23], v[22:23], v[62:63]
  v_cvt_pk_bf16_f32 v183, v22, v23
  buffer_store_dwordx4 v[180:183], v21, s[48:51], s3 offen offset:64 sc1
  v_lshlrev_b32 v22, 16, v184
  v_and_b32 v23, 0xffff0000, v184
  v_pk_add_f32 v[22:23], v[22:23], v[68:69]
  v_cvt_pk_bf16_f32 v184, v22, v23
  v_lshlrev_b32 v22, 16, v185
  v_and_b32 v23, 0xffff0000, v185
  v_pk_add_f32 v[22:23], v[22:23], v[70:71]
  v_cvt_pk_bf16_f32 v185, v22, v23
  v_lshlrev_b32 v22, 16, v186
  v_and_b32 v23, 0xffff0000, v186
  v_pk_add_f32 v[22:23], v[22:23], v[76:77]
  v_cvt_pk_bf16_f32 v186, v22, v23
  v_lshlrev_b32 v22, 16, v187
  v_and_b32 v23, 0xffff0000, v187
  v_pk_add_f32 v[22:23], v[22:23], v[78:79]
  v_cvt_pk_bf16_f32 v187, v22, v23
  buffer_store_dwordx4 v[184:187], v21, s[48:51], s3 offen offset:256 sc1
  v_lshlrev_b32 v22, 16, v188
  v_and_b32 v23, 0xffff0000, v188
  v_pk_add_f32 v[22:23], v[22:23], v[84:85]
  v_cvt_pk_bf16_f32 v188, v22, v23
  v_lshlrev_b32 v22, 16, v189
  v_and_b32 v23, 0xffff0000, v189
  v_pk_add_f32 v[22:23], v[22:23], v[86:87]
  v_cvt_pk_bf16_f32 v189, v22, v23
  v_lshlrev_b32 v22, 16, v190
  v_and_b32 v23, 0xffff0000, v190
  v_pk_add_f32 v[22:23], v[22:23], v[92:93]
  v_cvt_pk_bf16_f32 v190, v22, v23
  v_lshlrev_b32 v22, 16, v191
  v_and_b32 v23, 0xffff0000, v191
  v_pk_add_f32 v[22:23], v[22:23], v[94:95]
  v_cvt_pk_bf16_f32 v191, v22, v23
  buffer_store_dwordx4 v[188:191], v21, s[48:51], s3 offen offset:320 sc1
  s_branch G2_done
L_fin:
  s_bfe_u32 s4, s30, 262152
  s_bfe_u32 s5, s30, 393228
  s_bfe_u32 s33, s30, 262162
  s_lshl_b32 s6, s4, 18
  s_lshl_b32 s5, s5, 14
  s_add_u32 s6, s6, s5
  s_lshl_b32 s5, s27, 12
  s_add_u32 s6, s6, s5
  s_lshl_b32 s5, s33, 9
  s_add_u32 s6, s6, s5
  v_and_b32 v20, 0x200, v0
  v_mul_u32_u24 v20, 3, v20
  v_add_u32 v20, v20, v0
  s_bfe_u32 s40, s30, 327706
  s_lshl_b32 s7, s4, 2
  s_add_u32 s7, s7, s33
  s_lshl_b32 s7, s7, 7
  s_add_u32 s7, s7, 99622912
  s_lshl_b32 s41, s40, 1
  s_cmp_lg_u32 s27, 0
  s_cbranch_scc1 Wfin_26_ok
  s_mov_b32 s4, 0
Wfin_26:
  buffer_load_dword v18, off, s[8:11], s7 offset:0 sc1
  s_add_u32 s4, s4, 1
  s_cmp_gt_u32 s4, 65536
  s_cbranch_scc1 L_abort
  s_waitcnt vmcnt(0)
  v_readfirstlane_b32 s3, v18
  s_cmp_ge_u32 s3, s41
  s_cbranch_scc1 Wfin_26_ok
  s_sleep 2
  s_branch Wfin_26
Wfin_26_ok:
  s_barrier
  s_mov_b32 s48, s78
  s_mov_b32 s49, s79
  s_mov_b32 s50, 0x400000
  s_mov_b32 s51, 0x20000
  s_bfe_u32 s26, s30, 262166
FIN_u:
  s_add_u32 s7, s6, 100663296
  s_cmp_gt_u32 s40, 0
  s_cselect_b32 s18, s10, 0
  buffer_load_dwordx4 v[64:67], v20, s[16:19], s7 offen sc1
  s_add_u32 s7, s7, 4194304
  s_cmp_gt_u32 s40, 1
  s_cselect_b32 s18, s10, 0
  buffer_load_dwordx4 v[68:71], v20, s[16:19], s7 offen sc1
  s_add_u32 s7, s7, 4194304
  s_cmp_gt_u32 s40, 2
  s_cselect_b32 s18, s10, 0
  buffer_load_dwordx4 v[72:75], v20, s[16:19], s7 offen sc1
  s_add_u32 s7, s7, 4194304
  s_cmp_gt_u32 s40, 3
  s_cselect_b32 s18, s10, 0
  buffer_load_dwordx4 v[76:79], v20, s[16:19], s7 offen sc1
  s_add_u32 s7, s7, 4194304
  s_cmp_gt_u32 s40, 4
  s_cselect_b32 s18, s10, 0
  buffer_load_dwordx4 v[80:83], v20, s[16:19], s7 offen sc1
  s_add_u32 s7, s7, 4194304
  s_cmp_gt_u32 s40, 5
  s_cselect_b32 s18, s10, 0
  buffer_load_dwordx4 v[84:87], v20, s[16:19], s7 offen sc1
  s_add_u32 s7, s7, 4194304
  s_cmp_gt_u32 s40, 6
  s_cselect_b32 s18, s10, 0
  buffer_load_dwordx4 v[88:91], v20, s[16:19], s7 offen sc1
  s_add_u32 s7, s7, 4194304
  s_cmp_gt_u32 s40, 7
  s_cselect_b32 s18, s10, 0
  buffer_load_dwordx4 v[92:95], v20, s[16:19], s7 offen sc1
  s_add_u32 s7, s7, 4194304
  s_cmp_gt_u32 s40, 8
  s_cselect_b32 s18, s10, 0
  buffer_load_dwordx4 v[96:99], v20, s[16:19], s7 offen sc1
  s_add_u32 s7, s7, 4194304
  s_cmp_gt_u32 s40, 9
  s_cselect_b32 s18, s10, 0
  buffer_load_dwordx4 v[100:103], v20, s[16:19], s7 offen sc1
  s_add_u32 s7, s7, 4194304
  s_cmp_gt_u32 s40, 10
  s_cselect_b32 s18, s10, 0
  buffer_load_dwordx4 v[104:107], v20, s[16:19], s7 offen sc1
  s_add_u32 s7, s7, 4194304
  s_cmp_gt_u32 s40, 11
  s_cselect_b32 s18, s10, 0
  buffer_load_dwordx4 v[108:111], v20, s[16:19], s7 offen sc1
  s_add_u32 s7, s7, 4194304
  s_cmp_gt_u32 s40, 12
  s_cselect_b32 s18, s10, 0
  buffer_load_dwordx4 v[112:115], v20, s[16:19], s7 offen sc1
  s_add_u32 s7, s7, 4194304
  s_cmp_gt_u32 s40, 13
  s_cselect_b32 s18, s10, 0
  buffer_load_dwordx4 v[116:119], v20, s[16:19], s7 offen sc1
  s_add_u32 s7, s7, 4194304
  s_cmp_gt_u32 s40, 14
  s_cselect_b32 s18, s10, 0
  buffer_load_dwordx4 v[120:123], v20, s[16:19], s7 offen sc1
  s_add_u32 s7, s7, 4194304
  s_cmp_gt_u32 s40, 15
  s_cselect_b32 s18, s10, 0
  buffer_load_dwordx4 v[124:127], v20, s[16:19], s7 offen sc1
  s_add_u32 s7, s7, 4194304
  s_cmp_gt_u32 s40, 16
  s_cselect_b32 s18, s10, 0
  buffer_load_dwordx4 v[128:131], v20, s[16:19], s7 offen sc1
  s_add_u32 s7, s7, 4194304
  s_waitcnt vmcnt(16)
  v_lshlrev_b32 v32, 16, v64
  v_and_b32 v33, 0xffff0000, v64
  v_lshlrev_b32 v34, 16, v65
  v_and_b32 v35, 0xffff0000, v65
  v_lshlrev_b32 v36, 16, v66
  v_and_b32 v37, 0xffff0000, v66
  v_lshlrev_b32 v38, 16, v67
  v_and_b32 v39, 0xffff0000, v67
  s_waitcnt vmcnt(15)
  v_lshlrev_b32 v22, 16, v68
  v_and_b32 v23, 0xffff0000, v68
  v_pk_add_f32 v[32:33], v[32:33], v[22:23]
  v_lshlrev_b32 v22, 16, v69
  v_and_b32 v23, 0xffff0000, v69
  v_pk_add_f32 v[34:35], v[34:35], v[22:23]
  v_lshlrev_b32 v22, 16, v70
  v_and_b32 v23, 0xffff0000, v70
  v_pk_add_f32 v[36:37], v[36:37], v[22:23]
  v_lshlrev_b32 v22, 16, v71
  v_and_b32 v23, 0xffff0000, v71
  v_pk_add_f32 v[38:39], v[38:39], v[22:23]
  s_waitcnt vmcnt(14)
  v_lshlrev_b32 v22, 16, v72
  v_and_b32 v23, 0xffff0000, v72
  v_pk_add_f32 v[32:33], v[32:33], v[22:23]
  v_lshlrev_b32 v22, 16, v73
  v_and_b32 v23, 0xffff0000, v73
  v_pk_add_f32 v[34:35], v[34:35], v[22:23]
  v_lshlrev_b32 v22, 16, v74
  v_and_b32 v23, 0xffff0000, v74
  v_pk_add_f32 v[36:37], v[36:37], v[22:23]
  v_lshlrev_b32 v22, 16, v75
  v_and_b32 v23, 0xffff0000, v75
  v_pk_add_f32 v[38:39], v[38:39], v[22:23]
  s_waitcnt vmcnt(13)
  v_lshlrev_b32 v22, 16, v76
  v_and_b32 v23, 0xffff0000, v76
  v_pk_add_f32 v[32:33], v[32:33], v[22:23]
  v_lshlrev_b32 v22, 16, v77
  v_and_b32 v23, 0xffff0000, v77
  v_pk_add_f32 v[34:35], v[34:35], v[22:23]
  v_lshlrev_b32 v22, 16, v78
  v_and_b32 v23, 0xffff0000, v78
  v_pk_add_f32 v[36:37], v[36:37], v[22:23]
  v_lshlrev_b32 v22, 16, v79
  v_and_b32 v23, 0xffff0000, v79
  v_pk_add_f32 v[38:39], v[38:39], v[22:23]
  s_waitcnt vmcnt(12)
  v_lshlrev_b32 v22, 16, v80
  v_and_b32 v23, 0xffff0000, v80
  v_pk_add_f32 v[32:33], v[32:33], v[22:23]
  v_lshlrev_b32 v22, 16, v81
  v_and_b32 v23, 0xffff0000, v81
  v_pk_add_f32 v[34:35], v[34:35], v[22:23]
  v_lshlrev_b32 v22, 16, v82
  v_and_b32 v23, 0xffff0000, v82
  v_pk_add_f32 v[36:37], v[36:37], v[22:23]
  v_lshlrev_b32 v22, 16, v83
  v_and_b32 v23, 0xffff0000, v83
  v_pk_add_f32 v[38:39], v[38:39], v[22:23]
  s_waitcnt vmcnt(11)
  v_lshlrev_b32 v22, 16, v84
  v_and_b32 v23, 0xffff0000, v84
  v_pk_add_f32 v[32:33], v[32:33], v[22:23]
  v_lshlrev_b32 v22, 16, v85
  v_and_b32 v23, 0xffff0000, v85
  v_pk_add_f32 v[34:35], v[34:35], v[22:23]
  v_lshlrev_b32 v22, 16, v86
  v_and_b32 v23, 0xffff0000, v86
  v_pk_add_f32 v[36:37], v[36:37], v[22:23]
  v_lshlrev_b32 v22, 16, v87
  v_and_b32 v23, 0xffff0000, v87
  v_pk_add_f32 v[38:39], v[38:39], v[22:23]
  s_waitcnt vmcnt(10)
  v_lshlrev_b32 v22, 16, v88
  v_and_b32 v23, 0xffff0000, v88
  v_pk_add_f32 v[32:33], v[32:33], v[22:23]
  v_lshlrev_b32 v22, 16, v89
  v_and_b32 v23, 0xffff0000, v89
  v_pk_add_f32 v[34:35], v[34:35], v[22:23]
  v_lshlrev_b32 v22, 16, v90
  v_and_b32 v23, 0xffff0000, v90
  v_pk_add_f32 v[36:37], v[36:37], v[22:23]
  v_lshlrev_b32 v22, 16, v91
  v_and_b32 v23, 0xffff0000, v91
  v_pk_add_f32 v[38:39], v[38:39], v[22:23]
  s_waitcnt vmcnt(9)
  v_lshlrev_b32 v22, 16, v92
  v_and_b32 v23, 0xffff0000, v92
  v_pk_add_f32 v[32:33], v[32:33], v[22:23]
  v_lshlrev_b32 v22, 16, v93
  v_and_b32 v23, 0xffff0000, v93
  v_pk_add_f32 v[34:35], v[34:35], v[22:23]
  v_lshlrev_b32 v22, 16, v94
  v_and_b32 v23, 0xffff0000, v94
  v_pk_add_f32 v[36:37], v[36:37], v[22:23]
  v_lshlrev_b32 v22, 16, v95
  v_and_b32 v23, 0xffff0000, v95
  v_pk_add_f32 v[38:39], v[38:39], v[22:23]
  s_waitcnt vmcnt(8)
  v_lshlrev_b32 v22, 16, v96
  v_and_b32 v23, 0xffff0000, v96
  v_pk_add_f32 v[32:33], v[32:33], v[22:23]
  v_lshlrev_b32 v22, 16, v97
  v_and_b32 v23, 0xffff0000, v97
  v_pk_add_f32 v[34:35], v[34:35], v[22:23]
  v_lshlrev_b32 v22, 16, v98
  v_and_b32 v23, 0xffff0000, v98
  v_pk_add_f32 v[36:37], v[36:37], v[22:23]
  v_lshlrev_b32 v22, 16, v99
  v_and_b32 v23, 0xffff0000, v99
  v_pk_add_f32 v[38:39], v[38:39], v[22:23]
  s_waitcnt vmcnt(7)
  v_lshlrev_b32 v22, 16, v100
  v_and_b32 v23, 0xffff0000, v100
  v_pk_add_f32 v[32:33], v[32:33], v[22:23]
  v_lshlrev_b32 v22, 16, v101
  v_and_b32 v23, 0xffff0000, v101
  v_pk_add_f32 v[34:35], v[34:35], v[22:23]
  v_lshlrev_b32 v22, 16, v102
  v_and_b32 v23, 0xffff0000, v102
  v_pk_add_f32 v[36:37], v[36:37], v[22:23]
  v_lshlrev_b32 v22, 16, v103
  v_and_b32 v23, 0xffff0000, v103
  v_pk_add_f32 v[38:39], v[38:39], v[22:23]
  s_waitcnt vmcnt(6)
  v_lshlrev_b32 v22, 16, v104
  v_and_b32 v23, 0xffff0000, v104
  v_pk_add_f32 v[32:33], v[32:33], v[22:23]
  v_lshlrev_b32 v22, 16, v105
  v_and_b32 v23, 0xffff0000, v105
  v_pk_add_f32 v[34:35], v[34:35], v[22:23]
  v_lshlrev_b32 v22, 16, v106
  v_and_b32 v23, 0xffff0000, v106
  v_pk_add_f32 v[36:37], v[36:37], v[22:23]
  v_lshlrev_b32 v22, 16, v107
  v_and_b32 v23, 0xffff0000, v107
  v_pk_add_f32 v[38:39], v[38:39], v[22:23]
  s_waitcnt vmcnt(5)
  v_lshlrev_b32 v22, 16, v108
  v_and_b32 v23, 0xffff0000, v108
  v_pk_add_f32 v[32:33], v[32:33], v[22:23]
  v_lshlrev_b32 v22, 16, v109
  v_and_b32 v23, 0xffff0000, v109
  v_pk_add_f32 v[34:35], v[34:35], v[22:23]
  v_lshlrev_b32 v22, 16, v110
  v_and_b32 v23, 0xffff0000, v110
  v_pk_add_f32 v[36:37], v[36:37], v[22:23]
  v_lshlrev_b32 v22, 16, v111
  v_and_b32 v23, 0xffff0000, v111
  v_pk_add_f32 v[38:39], v[38:39], v[22:23]
  s_waitcnt vmcnt(4)
  v_lshlrev_b32 v22, 16, v112
  v_and_b32 v23, 0xffff0000, v112
  v_pk_add_f32 v[32:33], v[32:33], v[22:23]
  v_lshlrev_b32 v22, 16, v113
  v_and_b32 v23, 0xffff0000, v113
  v_pk_add_f32 v[34:35], v[34:35], v[22:23]
  v_lshlrev_b32 v22, 16, v114
  v_and_b32 v23, 0xffff0000, v114
  v_pk_add_f32 v[36:37], v[36:37], v[22:23]
  v_lshlrev_b32 v22, 16, v115
  v_and_b32 v23, 0xffff0000, v115
  v_pk_add_f32 v[38:39], v[38:39], v[22:23]
  s_waitcnt vmcnt(3)
  v_lshlrev_b32 v22, 16, v116
  v_and_b32 v23, 0xffff0000, v116
  v_pk_add_f32 v[32:33], v[32:33], v[22:23]
  v_lshlrev_b32 v22, 16, v117
  v_and_b32 v23, 0xffff0000, v117
  v_pk_add_f32 v[34:35], v[34:35], v[22:23]
  v_lshlrev_b32 v22, 16, v118
  v_and_b32 v23, 0xffff0000, v118
  v_pk_add_f32 v[36:37], v[36:37], v[22:23]
  v_lshlrev_b32 v22, 16, v119
  v_and_b32 v23, 0xffff0000, v119
  v_pk_add_f32 v[38:39], v[38:39], v[22:23]
  s_waitcnt vmcnt(2)
  v_lshlrev_b32 v22, 16, v120
  v_and_b32 v23, 0xffff0000, v120
  v_pk_add_f32 v[32:33], v[32:33], v[22:23]
  v_lshlrev_b32 v22, 16, v121
  v_and_b32 v23, 0xffff0000, v121
  v_pk_add_f32 v[34:35], v[34:35], v[22:23]
  v_lshlrev_b32 v22, 16, v122
  v_and_b32 v23, 0xffff0000, v122
  v_pk_add_f32 v[36:37], v[36:37], v[22:23]
  v_lshlrev_b32 v22, 16, v123
  v_and_b32 v23, 0xffff0000, v123
  v_pk_add_f32 v[38:39], v[38:39], v[22:23]
  s_waitcnt vmcnt(1)
  v_lshlrev_b32 v22, 16, v124
  v_and_b32 v23, 0xffff0000, v124
  v_pk_add_f32 v[32:33], v[32:33], v[22:23]
  v_lshlrev_b32 v22, 16, v125
  v_and_b32 v23, 0xffff0000, v125
  v_pk_add_f32 v[34:35], v[34:35], v[22:23]
  v_lshlrev_b32 v22, 16, v126
  v_and_b32 v23, 0xffff0000, v126
  v_pk_add_f32 v[36:37], v[36:37], v[22:23]
  v_lshlrev_b32 v22, 16, v127
  v_and_b32 v23, 0xffff0000, v127
  v_pk_add_f32 v[38:39], v[38:39], v[22:23]
  s_waitcnt vmcnt(0)
  v_lshlrev_b32 v22, 16, v128
  v_and_b32 v23, 0xffff0000, v128
  v_pk_add_f32 v[32:33], v[32:33], v[22:23]
  v_lshlrev_b32 v22, 16, v129
  v_and_b32 v23, 0xffff0000, v129
  v_pk_add_f32 v[34:35], v[34:35], v[22:23]
  v_lshlrev_b32 v22, 16, v130
  v_and_b32 v23, 0xffff0000, v130
  v_pk_add_f32 v[36:37], v[36:37], v[22:23]
  v_lshlrev_b32 v22, 16, v131
  v_and_b32 v23, 0xffff0000, v131
  v_pk_add_f32 v[38:39], v[38:39], v[22:23]
  v_cvt_pk_bf16_f32 v40, v32, v33
  v_cvt_pk_bf16_f32 v41, v34, v35
  v_cvt_pk_bf16_f32 v42, v36, v37
  v_cvt_pk_bf16_f32 v43, v38, v39
  buffer_store_dwordx4 v[40:43], v20, s[48:51], s6 offen
  s_add_u32 s6, s6, 16384
  s_sub_u32 s26, s26, 1
  s_cbranch_scc0 FIN_u
  s_branch L_sched
L_pf:
  s_bfe_u32 s5, s30, 393228
  s_mul_i32 s5, s5, 114688
  s_mul_i32 s3, s27, 28672
  s_add_u32 s5, s5, s3
  v_lshlrev_b32 v18, 3, v0
  s_bitcmp1_b32 s30, 8
  s_cbranch_scc0 PF_0
  s_mov_b32 s44, s72
  s_mov_b32 s45, s73
  s_mov_b32 s46, 0x700000
  s_mov_b32 s47, 0x20000
  s_add_u32 s3, s5, 0
  buffer_load_dword v200, v18, s[44:47], s3 offen
  s_add_u32 s3, s5, 8192
  buffer_load_dword v200, v18, s[44:47], s3 offen
  s_add_u32 s3, s5, 16384
  buffer_load_dword v200, v18, s[44:47], s3 offen
  s_add_u32 s3, s5, 20480
  buffer_load_dword v200, v18, s[44:47], s3 offen
  s_waitcnt vmcnt(0)
PF_0:
  s_bitcmp1_b32 s30, 9
  s_cbranch_scc0 PF_1
  s_mov_b32 s44, s74
  s_mov_b32 s45, s75
  s_mov_b32 s46, 0x700000
  s_mov_b32 s47, 0x20000
  s_add_u32 s3, s5, 0
  buffer_load_dword v200, v18, s[44:47], s3 offen
  s_add_u32 s3, s5, 8192
  buffer_load_dword v200, v18, s[44:47], s3 offen
  s_add_u32 s3, s5, 16384
  buffer_load_dword v200, v18, s[44:47], s3 offen
  s_add_u32 s3, s5, 20480
  buffer_load_dword v200, v18, s[44:47], s3 offen
  s_waitcnt vmcnt(0)
PF_1:
  s_bitcmp1_b32 s30, 10
  s_cbranch_scc0 PF_2
  s_mov_b32 s44, s76
  s_mov_b32 s45, s77
  s_mov_b32 s46, 0x700000
  s_mov_b32 s47, 0x20000
  s_add_u32 s3, s5, 0
  buffer_load_dword v200, v18, s[44:47], s3 offen
  s_add_u32 s3, s5, 8192
  buffer_load_dword v200, v18, s[44:47], s3 offen
  s_add_u32 s3, s5, 16384
  buffer_load_dword v200, v18, s[44:47], s3 offen
  s_add_u32 s3, s5, 20480
  buffer_load_dword v200, v18, s[44:47], s3 offen
  s_waitcnt vmcnt(0)
PF_2:
  s_branch L_sched
L_chainP:
  s_and_b32 s30, s34, 15
  s_lshl_b32 s3, s33, 4
  s_add_u32 s30, s30, s3
  v_and_b32 v30, 63, v0
  v_lshlrev_b32 v0, 4, v30
  v_lshrrev_b32 v19, 4, v30
  s_lshl_b32 s3, s29, 4
  v_add_u32 v16, s3, v19
  v_bfe_u32 v20, v30, 1, 3
  v_xor_b32 v20, v20, v19
  v_and_b32 v21, 1, v30
  v_lshlrev_b32 v21, 4, v21
  v_lshl_add_u32 v17, v20, 5, v21
  s_mov_b32 s15, 0x20000
  s_mov_b32 s14, 8388608
  v_lshrrev_b32 v29, 2, v30
  v_and_b32 v28, 7, v29
  v_lshlrev_b32 v29, 8, v29
  v_and_b32 v21, 3, v30
  v_lshl_add_u32 v29, v21, 3, v29
  s_lshl_b32 s41, s27, 12
  s_cmp_eq_u32 s28, 0
  s_cselect_b32 s12, s60, s62
  s_cselect_b32 s13, s61, s63
  v_mul_u32_u24 v18, 8192, v16
  v_xor_b32 v20, 0x80, v17
  v_add_u32 v12, v18, v17
  v_add_u32 v13, v18, v20
  v_add_u32 v13, 31744, v13
  v_add_u32 v14, 63488, v12
  v_add_u32 v15, 63488, v13
  s_lshl_b32 s21, s30, 8
  s_lshl_b32 s3, s27, 1
  v_xor_b32 v18, s3, v28
  s_lshl_b32 s3, s27, 15
  v_add_u32 v19, s3, v29
  v_lshl_add_u32 v2, v18, 5, v19
  v_xor_b32 v3, 32, v2
  s_add_u32 m0, s41, 0
  s_add_u32 s20, s21, 0
  buffer_load_dwordx4 v12, s[12:15], s20 offen offset:0 lds
  buffer_load_dwordx4 v13, s[12:15], s20 offen offset:1024 lds
  buffer_load_dwordx4 v14, s[12:15], s20 offen offset:2048 lds
  buffer_load_dwordx4 v15, s[12:15], s20 offen offset:3072 lds
  s_add_u32 m0, s41, 32768
  s_add_u32 s20, s21, 2097152
  buffer_load_dwordx4 v12, s[12:15], s20 offen offset:0 lds
  buffer_load_dwordx4 v13, s[12:15], s20 offen offset:1024 lds
  buffer_load_dwordx4 v14, s[12:15], s20 offen offset:2048 lds
  buffer_load_dwordx4 v15, s[12:15], s20 offen offset:3072 lds
  s_add_u32 m0, s41, 65536
  s_add_u32 s20, s21, 4194304
  buffer_load_dwordx4 v12, s[12:15], s20 offen offset:0 lds
  buffer_load_dwordx4 v13, s[12:15], s20 offen offset:1024 lds
  buffer_load_dwordx4 v14, s[12:15], s20 offen offset:2048 lds
  buffer_load_dwordx4 v15, s[12:15], s20 offen offset:3072 lds
  s_add_u32 m0, s41, 98304
  s_add_u32 s20, s21, 6291456
  buffer_load_dwordx4 v12, s[12:15], s20 offen offset:0 lds
  buffer_load_dwordx4 v13, s[12:15], s20 offen offset:1024 lds
  buffer_load_dwordx4 v14, s[12:15], s20 offen offset:2048 lds
  buffer_load_dwordx4 v15, s[12:15], s20 offen offset:3072 lds
  s_add_u32 m0, s41, 16384
  s_add_u32 s20, s21, 262144
  buffer_load_dwordx4 v12, s[12:15], s20 offen offset:0 lds
  buffer_load_dwordx4 v13, s[12:15], s20 offen offset:1024 lds
  buffer_load_dwordx4 v14, s[12:15], s20 offen offset:2048 lds
  buffer_load_dwordx4 v15, s[12:15], s20 offen offset:3072 lds
  s_add_u32 m0, s41, 49152
  s_add_u32 s20, s21, 2359296
  buffer_load_dwordx4 v12, s[12:15], s20 offen offset:0 lds
  buffer_load_dwordx4 v13, s[12:15], s20 offen offset:1024 lds
  buffer_load_dwordx4 v14, s[12:15], s20 offen offset:2048 lds
  buffer_load_dwordx4 v15, s[12:15], s20 offen offset:3072 lds
  s_add_u32 m0, s41, 81920
  s_add_u32 s20, s21, 4456448
  buffer_load_dwordx4 v12, s[12:15], s20 offen offset:0 lds
  buffer_load_dwordx4 v13, s[12:15], s20 offen offset:1024 lds
  buffer_load_dwordx4 v14, s[12:15], s20 offen offset:2048 lds
  buffer_load_dwordx4 v15, s[12:15], s20 offen offset:3072 lds
  s_add_u32 m0, s41, 114688
  s_add_u32 s20, s21, 6553600
  buffer_load_dwordx4 v12, s[12:15], s20 offen offset:0 lds
  buffer_load_dwordx4 v13, s[12:15], s20 offen offset:1024 lds
  buffer_load_dwordx4 v14, s[12:15], s20 offen offset:2048 lds
  buffer_load_dwordx4 v15, s[12:15], s20 offen offset:3072 lds
  s_waitcnt vmcnt(16)
  s_barrier
  ds_read_b64_tr_b16 a[0:1], v2 offset:0
  ds_read_b64_tr_b16 a[2:3], v2 offset:4096
  ds_read_b64_tr_b16 a[8:9], v3 offset:0
  ds_read_b64_tr_b16 a[10:11], v3 offset:4096
  ds_read_b64_tr_b16 a[16:17], v2 offset:8192
  ds_read_b64_tr_b16 a[18:19], v2 offset:12288
  ds_read_b64_tr_b16 a[24:25], v3 offset:8192
  ds_read_b64_tr_b16 a[26:27], v3 offset:12288
  v_add_u32 v2, 0x8000, v2
  v_and_b32 v2, 0x1ffff, v2
  v_add_u32 v3, 0x8000, v3
  v_and_b32 v3, 0x1ffff, v3
  ds_read_b64_tr_b16 a[96:97], v2 offset:0
  ds_read_b64_tr_b16 a[98:99], v2 offset:4096
  ds_read_b64_tr_b16 a[104:105], v3 offset:0
  ds_read_b64_tr_b16 a[106:107], v3 offset:4096
  ds_read_b64_tr_b16 a[112:113], v2 offset:8192
  ds_read_b64_tr_b16 a[114:115], v2 offset:12288
  ds_read_b64_tr_b16 a[120:121], v3 offset:8192
  ds_read_b64_tr_b16 a[122:123], v3 offset:12288
  v_add_u32 v2, 0x8000, v2
  v_and_b32 v2, 0x1ffff, v2
  v_add_u32 v3, 0x8000, v3
  v_and_b32 v3, 0x1ffff, v3
  ds_read_b64_tr_b16 a[192:193], v2 offset:0
  ds_read_b64_tr_b16 a[194:195], v2 offset:4096
  ds_read_b64_tr_b16 a[200:201], v3 offset:0
  ds_read_b64_tr_b16 a[202:203], v3 offset:4096
  ds_read_b64_tr_b16 a[208:209], v2 offset:8192
  ds_read_b64_tr_b16 a[210:211], v2 offset:12288
  ds_read_b64_tr_b16 a[216:217], v3 offset:8192
  ds_read_b64_tr_b16 a[218:219], v3 offset:12288
  v_add_u32 v2, 0x8000, v2
  v_and_b32 v2, 0x1ffff, v2
  v_add_u32 v3, 0x8000, v3
  v_and_b32 v3, 0x1ffff, v3
  ds_read_b64_tr_b16 v[160:161], v2 offset:0
  ds_read_b64_tr_b16 v[162:163], v2 offset:4096
  ds_read_b64_tr_b16 v[168:169], v3 offset:0
  ds_read_b64_tr_b16 v[170:171], v3 offset:4096
  ds_read_b64_tr_b16 v[176:177], v2 offset:8192
  ds_read_b64_tr_b16 v[178:179], v2 offset:12288
  ds_read_b64_tr_b16 v[184:185], v3 offset:8192
  ds_read_b64_tr_b16 v[186:187], v3 offset:12288
  v_add_u32 v2, 0x8000, v2
  v_and_b32 v2, 0x1ffff, v2
  v_add_u32 v3, 0x8000, v3
  v_and_b32 v3, 0x1ffff, v3
  s_waitcnt lgkmcnt(0)
  s_barrier
  buffer_load_dword v31, off, s[68:71], 0 offset:136 sc1
  s_add_u32 m0, s41, 0
  s_add_u32 s20, s21, 524288
  buffer_load_dwordx4 v12, s[12:15], s20 offen offset:0 lds
  buffer_load_dwordx4 v13, s[12:15], s20 offen offset:1024 lds
  buffer_load_dwordx4 v14, s[12:15], s20 offen offset:2048 lds
  buffer_load_dwordx4 v15, s[12:15], s20 offen offset:3072 lds
  s_add_u32 m0, s41, 32768
  s_add_u32 s20, s21, 2621440
  buffer_load_dwordx4 v12, s[12:15], s20 offen offset:0 lds
  buffer_load_dwordx4 v13, s[12:15], s20 offen offset:1024 lds
  buffer_load_dwordx4 v14, s[12:15], s20 offen offset:2048 lds
  buffer_load_dwordx4 v15, s[12:15], s20 offen offset:3072 lds
  s_add_u32 m0, s41, 65536
  s_add_u32 s20, s21, 4718592
  buffer_load_dwordx4 v12, s[12:15], s20 offen offset:0 lds
  buffer_load_dwordx4 v13, s[12:15], s20 offen offset:1024 lds
  buffer_load_dwordx4 v14, s[12:15], s20 offen offset:2048 lds
  buffer_load_dwordx4 v15, s[12:15], s20 offen offset:3072 lds
  s_add_u32 m0, s41, 98304
  s_add_u32 s20, s21, 6815744
  buffer_load_dwordx4 v12, s[12:15], s20 offen offset:0 lds
  buffer_load_dwordx4 v13, s[12:15], s20 offen offset:1024 lds
  buffer_load_dwordx4 v14, s[12:15], s20 offen offset:2048 lds
  buffer_load_dwordx4 v15, s[12:15], s20 offen offset:3072 lds
  s_waitcnt vmcnt(16)
  s_mov_b32 s4, 0
  v_mov_b32 v18, v31
  s_branch VR_27_c
VR_27:
  s_sleep 4
  buffer_load_dword v18, off, s[68:71], 0 offset:136 sc1
  s_add_u32 s4, s4, 1
  s_cmp_gt_u32 s4, 0x10000
  s_cbranch_scc1 L_abort
  s_waitcnt vmcnt(0)
VR_27_c:
  v_readfirstlane_b32 s3, v18
  s_cmp_eq_u32 s3, 0
  s_cbranch_scc1 VR_27
  s_sub_u32 s3, s3, 1
  s_and_b32 s3, s3, 7
  s_cmp_lg_u32 s3, s89
  s_cbranch_scc1 L_redo
  s_getreg_b32 s47, hwreg(HW_REG_XCC_ID, 0, 3)
  s_lshl_b32 s47, s47, 3
  s_lshl_b64 s[4:5], 1, s47
  v_mov_b32 v18, s4
  v_mov_b32 v19, s5
  s_lshl_b32 s3, s33, 3
  s_cmp_eq_u32 s27, 0
  s_cselect_b32 s4, 1, 0
  s_mov_b32 s5, 0
  s_mov_b64 exec, s[4:5]
  buffer_atomic_add_x2 v[18:19], off, s[68:71], s3 offset:8 sc1
  s_mov_b64 exec, -1
  s_barrier
  ds_read_b64_tr_b16 a[4:5], v2 offset:16384
  ds_read_b64_tr_b16 a[6:7], v2 offset:20480
  ds_read_b64_tr_b16 a[12:13], v3 offset:16384
  ds_read_b64_tr_b16 a[14:15], v3 offset:20480
  ds_read_b64_tr_b16 a[20:21], v2 offset:24576
  ds_read_b64_tr_b16 a[22:23], v2 offset:28672
  ds_read_b64_tr_b16 a[28:29], v3 offset:24576
  ds_read_b64_tr_b16 a[30:31], v3 offset:28672
  v_add_u32 v2, 0x8000, v2
  v_and_b32 v2, 0x1ffff, v2
  v_add_u32 v3, 0x8000, v3
  v_and_b32 v3, 0x1ffff, v3
  ds_read_b64_tr_b16 a[100:101], v2 offset:16384
  ds_read_b64_tr_b16 a[102:103], v2 offset:20480
  ds_read_b64_tr_b16 a[108:109], v3 offset:16384
  ds_read_b64_tr_b16 a[110:111], v3 offset:20480
  ds_read_b64_tr_b16 a[116:117], v2 offset:24576
  ds_read_b64_tr_b16 a[118:119], v2 offset:28672
  ds_read_b64_tr_b16 a[124:125], v3 offset:24576
  ds_read_b64_tr_b16 a[126:127], v3 offset:28672
  v_add_u32 v2, 0x8000, v2
  v_and_b32 v2, 0x1ffff, v2
  v_add_u32 v3, 0x8000, v3
  v_and_b32 v3, 0x1ffff, v3
  ds_read_b64_tr_b16 a[196:197], v2 offset:16384
  ds_read_b64_tr_b16 a[198:199], v2 offset:20480
  ds_read_b64_tr_b16 a[204:205], v3 offset:16384
  ds_read_b64_tr_b16 a[206:207], v3 offset:20480
  ds_read_b64_tr_b16 a[212:213], v2 offset:24576
  ds_read_b64_tr_b16 a[214:215], v2 offset:28672
  ds_read_b64_tr_b16 a[220:221], v3 offset:24576
  ds_read_b64_tr_b16 a[222:223], v3 offset:28672
  v_add_u32 v2, 0x8000, v2
  v_and_b32 v2, 0x1ffff, v2
  v_add_u32 v3, 0x8000, v3
  v_and_b32 v3, 0x1ffff, v3
  ds_read_b64_tr_b16 v[164:165], v2 offset:16384
  ds_read_b64_tr_b16 v[166:167], v2 offset:20480
  ds_read_b64_tr_b16 v[172:173], v3 offset:16384
  ds_read_b64_tr_b16 v[174:175], v3 offset:20480
  ds_read_b64_tr_b16 v[180:181], v2 offset:24576
  ds_read_b64_tr_b16 v[182:183], v2 offset:28672
  ds_read_b64_tr_b16 v[188:189], v3 offset:24576
  ds_read_b64_tr_b16 v[190:191], v3 offset:28672
  v_add_u32 v2, 0x8000, v2
  v_and_b32 v2, 0x1ffff, v2
  v_add_u32 v3, 0x8000, v3
  v_and_b32 v3, 0x1ffff, v3
  s_waitcnt lgkmcnt(0)
  s_barrier
  s_add_u32 m0, s41, 16384
  s_add_u32 s20, s21, 786432
  buffer_load_dwordx4 v12, s[12:15], s20 offen offset:0 lds
  buffer_load_dwordx4 v13, s[12:15], s20 offen offset:1024 lds
  buffer_load_dwordx4 v14, s[12:15], s20 offen offset:2048 lds
  buffer_load_dwordx4 v15, s[12:15], s20 offen offset:3072 lds
  s_add_u32 m0, s41, 49152
  s_add_u32 s20, s21, 2883584
  buffer_load_dwordx4 v12, s[12:15], s20 offen offset:0 lds
  buffer_load_dwordx4 v13, s[12:15], s20 offen offset:1024 lds
  buffer_load_dwordx4 v14, s[12:15], s20 offen offset:2048 lds
  buffer_load_dwordx4 v15, s[12:15], s20 offen offset:3072 lds
  s_add_u32 m0, s41, 81920
  s_add_u32 s20, s21, 4980736
  buffer_load_dwordx4 v12, s[12:15], s20 offen offset:0 lds
  buffer_load_dwordx4 v13, s[12:15], s20 offen offset:1024 lds
  buffer_load_dwordx4 v14, s[12:15], s20 offen offset:2048 lds
  buffer_load_dwordx4 v15, s[12:15], s20 offen offset:3072 lds
  s_add_u32 m0, s41, 114688
  s_add_u32 s20, s21, 7077888
  buffer_load_dwordx4 v12, s[12:15], s20 offen offset:0 lds
  buffer_load_dwordx4 v13, s[12:15], s20 offen offset:1024 lds
  buffer_load_dwordx4 v14, s[12:15], s20 offen offset:2048 lds
  buffer_load_dwordx4 v15, s[12:15], s20 offen offset:3072 lds
  s_waitcnt vmcnt(16)
  s_barrier
  ds_read_b64_tr_b16 a[32:33], v2 offset:0
  ds_read_b64_tr_b16 a[34:35], v2 offset:4096
  ds_read_b64_tr_b16 a[40:41], v3 offset:0
  ds_read_b64_tr_b16 a[42:43], v3 offset:4096
  ds_read_b64_tr_b16 a[48:49], v2 offset:8192
  ds_read_b64_tr_b16 a[50:51], v2 offset:12288
  ds_read_b64_tr_b16 a[56:57], v3 offset:8192
  ds_read_b64_tr_b16 a[58:59], v3 offset:12288
  v_add_u32 v2, 0x8000, v2
  v_and_b32 v2, 0x1ffff, v2
  v_add_u32 v3, 0x8000, v3
  v_and_b32 v3, 0x1ffff, v3
  ds_read_b64_tr_b16 a[128:129], v2 offset:0
  ds_read_b64_tr_b16 a[130:131], v2 offset:4096
  ds_read_b64_tr_b16 a[136:137], v3 offset:0
  ds_read_b64_tr_b16 a[138:139], v3 offset:4096
  ds_read_b64_tr_b16 a[144:145], v2 offset:8192
  ds_read_b64_tr_b16 a[146:147], v2 offset:12288
  ds_read_b64_tr_b16 a[152:153], v3 offset:8192
  ds_read_b64_tr_b16 a[154:155], v3 offset:12288
  v_add_u32 v2, 0x8000, v2
  v_and_b32 v2, 0x1ffff, v2
  v_add_u32 v3, 0x8000, v3
  v_and_b32 v3, 0x1ffff, v3
  ds_read_b64_tr_b16 a[224:225], v2 offset:0
  ds_read_b64_tr_b16 a[226:227], v2 offset:4096
  ds_read_b64_tr_b16 a[232:233], v3 offset:0
  ds_read_b64_tr_b16 a[234:235], v3 offset:4096
  ds_read_b64_tr_b16 a[240:241], v2 offset:8192
  ds_read_b64_tr_b16 a[242:243], v2 offset:12288
  ds_read_b64_tr_b16 a[248:249], v3 offset:8192
  ds_read_b64_tr_b16 a[250:251], v3 offset:12288
  v_add_u32 v2, 0x8000, v2
  v_and_b32 v2, 0x1ffff, v2
  v_add_u32 v3, 0x8000, v3
  v_and_b32 v3, 0x1ffff, v3
  ds_read_b64_tr_b16 v[192:193], v2 offset:0
  ds_read_b64_tr_b16 v[194:195], v2 offset:4096
  ds_read_b64_tr_b16 v[200:201], v3 offset:0
  ds_read_b64_tr_b16 v[202:203], v3 offset:4096
  ds_read_b64_tr_b16 v[208:209], v2 offset:8192
  ds_read_b64_tr_b16 v[210:211], v2 offset:12288
  ds_read_b64_tr_b16 v[216:217], v3 offset:8192
  ds_read_b64_tr_b16 v[218:219], v3 offset:12288
  v_add_u32 v2, 0x8000, v2
  v_and_b32 v2, 0x1ffff, v2
  v_add_u32 v3, 0x8000, v3
  v_and_b32 v3, 0x1ffff, v3
  s_waitcnt lgkmcnt(0)
  s_barrier
  s_add_u32 m0, s41, 0
  s_add_u32 s20, s21, 1048576
  buffer_load_dwordx4 v12, s[12:15], s20 offen offset:0 lds
  buffer_load_dwordx4 v13, s[12:15], s20 offen offset:1024 lds
  buffer_load_dwordx4 v14, s[12:15], s20 offen offset:2048 lds
  buffer_load_dwordx4 v15, s[12:15], s20 offen offset:3072 lds
  s_add_u32 m0, s41, 32768
  s_add_u32 s20, s21, 3145728
  buffer_load_dwordx4 v12, s[12:15], s20 offen offset:0 lds
  buffer_load_dwordx4 v13, s[12:15], s20 offen offset:1024 lds
  buffer_load_dwordx4 v14, s[12:15], s20 offen offset:2048 lds
  buffer_load_dwordx4 v15, s[12:15], s20 offen offset:3072 lds
  s_add_u32 m0, s41, 65536
  s_add_u32 s20, s21, 5242880
  buffer_load_dwordx4 v12, s[12:15], s20 offen offset:0 lds
  buffer_load_dwordx4 v13, s[12:15], s20 offen offset:1024 lds
  buffer_load_dwordx4 v14, s[12:15], s20 offen offset:2048 lds
  buffer_load_dwordx4 v15, s[12:15], s20 offen offset:3072 lds
  s_add_u32 m0, s41, 98304
  s_add_u32 s20, s21, 7340032
  buffer_load_dwordx4 v12, s[12:15], s20 offen offset:0 lds
  buffer_load_dwordx4 v13, s[12:15], s20 offen offset:1024 lds
  buffer_load_dwordx4 v14, s[12:15], s20 offen offset:2048 lds
  buffer_load_dwordx4 v15, s[12:15], s20 offen offset:3072 lds
  s_waitcnt vmcnt(16)
  s_barrier
  ds_read_b64_tr_b16 a[36:37], v2 offset:16384
  ds_read_b64_tr_b16 a[38:39], v2 offset:20480
  ds_read_b64_tr_b16 a[44:45], v3 offset:16384
  ds_read_b64_tr_b16 a[46:47], v3 offset:20480
  ds_read_b64_tr_b16 a[52:53], v2 offset:24576
  ds_read_b64_tr_b16 a[54:55], v2 offset:28672
  ds_read_b64_tr_b16 a[60:61], v3 offset:24576
  ds_read_b64_tr_b16 a[62:63], v3 offset:28672
  v_add_u32 v2, 0x8000, v2
  v_and_b32 v2, 0x1ffff, v2
  v_add_u32 v3, 0x8000, v3
  v_and_b32 v3, 0x1ffff, v3
  ds_read_b64_tr_b16 a[132:133], v2 offset:16384
  ds_read_b64_tr_b16 a[134:135], v2 offset:20480
  ds_read_b64_tr_b16 a[140:141], v3 offset:16384
  ds_read_b64_tr_b16 a[142:143], v3 offset:20480
  ds_read_b64_tr_b16 a[148:149], v2 offset:24576
  ds_read_b64_tr_b16 a[150:151], v2 offset:28672
  ds_read_b64_tr_b16 a[156:157], v3 offset:24576
  ds_read_b64_tr_b16 a[158:159], v3 offset:28672
  v_add_u32 v2, 0x8000, v2
  v_and_b32 v2, 0x1ffff, v2
  v_add_u32 v3, 0x8000, v3
  v_and_b32 v3, 0x1ffff, v3
  ds_read_b64_tr_b16 a[228:229], v2 offset:16384
  ds_read_b64_tr_b16 a[230:231], v2 offset:20480
  ds_read_b64_tr_b16 a[236:237], v3 offset:16384
  ds_read_b64_tr_b16 a[238:239], v3 offset:20480
  ds_read_b64_tr_b16 a[244:245], v2 offset:24576
  ds_read_b64_tr_b16 a[246:247], v2 offset:28672
  ds_read_b64_tr_b16 a[252:253], v3 offset:24576
  ds_read_b64_tr_b16 a[254:255], v3 offset:28672
  v_add_u32 v2, 0x8000, v2
  v_and_b32 v2, 0x1ffff, v2
  v_add_u32 v3, 0x8000, v3
  v_and_b32 v3, 0x1ffff, v3
  ds_read_b64_tr_b16 v[196:197], v2 offset:16384
  ds_read_b64_tr_b16 v[198:199], v2 offset:20480
  ds_read_b64_tr_b16 v[204:205], v3 offset:16384
  ds_read_b64_tr_b16 v[206:207], v3 offset:20480
  ds_read_b64_tr_b16 v[212:213], v2 offset:24576
  ds_read_b64_tr_b16 v[214:215], v2 offset:28672
  ds_read_b64_tr_b16 v[220:221], v3 offset:24576
  ds_read_b64_tr_b16 v[222:223], v3 offset:28672
  v_add_u32 v2, 0x8000, v2
  v_and_b32 v2, 0x1ffff, v2
  v_add_u32 v3, 0x8000, v3
  v_and_b32 v3, 0x1ffff, v3
  s_waitcnt lgkmcnt(0)
  s_barrier
  s_add_u32 m0, s41, 16384
  s_add_u32 s20, s21, 1310720
  buffer_load_dwordx4 v12, s[12:15], s20 offen offset:0 lds
  buffer_load_dwordx4 v13, s[12:15], s20 offen offset:1024 lds
  buffer_load_dwordx4 v14, s[12:15], s20 offen offset:2048 lds
  buffer_load_dwordx4 v15, s[12:15], s20 offen offset:3072 lds
  s_add_u32 m0, s41, 49152
  s_add_u32 s20, s21, 3407872
  buffer_load_dwordx4 v12, s[12:15], s20 offen offset:0 lds
  buffer_load_dwordx4 v13, s[12:15], s20 offen offset:1024 lds
  buffer_load_dwordx4 v14, s[12:15], s20 offen offset:2048 lds
  buffer_load_dwordx4 v15, s[12:15], s20 offen offset:3072 lds
  s_add_u32 m0, s41, 81920
  s_add_u32 s20, s21, 5505024
  buffer_load_dwordx4 v12, s[12:15], s20 offen offset:0 lds
  buffer_load_dwordx4 v13, s[12:15], s20 offen offset:1024 lds
  buffer_load_dwordx4 v14, s[12:15], s20 offen offset:2048 lds
  buffer_load_dwordx4 v15, s[12:15], s20 offen offset:3072 lds
  s_add_u32 m0, s41, 114688
  s_add_u32 s20, s21, 7602176
  buffer_load_dwordx4 v12, s[12:15], s20 offen offset:0 lds
  buffer_load_dwordx4 v13, s[12:15], s20 offen offset:1024 lds
  buffer_load_dwordx4 v14, s[12:15], s20 offen offset:2048 lds
  buffer_load_dwordx4 v15, s[12:15], s20 offen offset:3072 lds
  s_waitcnt vmcnt(16)
  s_barrier
  ds_read_b64_tr_b16 a[64:65], v2 offset:0
  ds_read_b64_tr_b16 a[66:67], v2 offset:4096
  ds_read_b64_tr_b16 a[72:73], v3 offset:0
  ds_read_b64_tr_b16 a[74:75], v3 offset:4096
  ds_read_b64_tr_b16 a[80:81], v2 offset:8192
  ds_read_b64_tr_b16 a[82:83], v2 offset:12288
  ds_read_b64_tr_b16 a[88:89], v3 offset:8192
  ds_read_b64_tr_b16 a[90:91], v3 offset:12288
  v_add_u32 v2, 0x8000, v2
  v_and_b32 v2, 0x1ffff, v2
  v_add_u32 v3, 0x8000, v3
  v_and_b32 v3, 0x1ffff, v3
  ds_read_b64_tr_b16 a[160:161], v2 offset:0
  ds_read_b64_tr_b16 a[162:163], v2 offset:4096
  ds_read_b64_tr_b16 a[168:169], v3 offset:0
  ds_read_b64_tr_b16 a[170:171], v3 offset:4096
  ds_read_b64_tr_b16 a[176:177], v2 offset:8192
  ds_read_b64_tr_b16 a[178:179], v2 offset:12288
  ds_read_b64_tr_b16 a[184:185], v3 offset:8192
  ds_read_b64_tr_b16 a[186:187], v3 offset:12288
  v_add_u32 v2, 0x8000, v2
  v_and_b32 v2, 0x1ffff, v2
  v_add_u32 v3, 0x8000, v3
  v_and_b32 v3, 0x1ffff, v3
  ds_read_b64_tr_b16 v[128:129], v2 offset:0
  ds_read_b64_tr_b16 v[130:131], v2 offset:4096
  ds_read_b64_tr_b16 v[136:137], v3 offset:0
  ds_read_b64_tr_b16 v[138:139], v3 offset:4096
  ds_read_b64_tr_b16 v[144:145], v2 offset:8192
  ds_read_b64_tr_b16 v[146:147], v2 offset:12288
  ds_read_b64_tr_b16 v[152:153], v3 offset:8192
  ds_read_b64_tr_b16 v[154:155], v3 offset:12288
  v_add_u32 v2, 0x8000, v2
  v_and_b32 v2, 0x1ffff, v2
  v_add_u32 v3, 0x8000, v3
  v_and_b32 v3, 0x1ffff, v3
  ds_read_b64_tr_b16 v[224:225], v2 offset:0
  ds_read_b64_tr_b16 v[226:227], v2 offset:4096
  ds_read_b64_tr_b16 v[232:233], v3 offset:0
  ds_read_b64_tr_b16 v[234:235], v3 offset:4096
  ds_read_b64_tr_b16 v[240:241], v2 offset:8192
  ds_read_b64_tr_b16 v[242:243], v2 offset:12288
  ds_read_b64_tr_b16 v[248:249], v3 offset:8192
  ds_read_b64_tr_b16 v[250:251], v3 offset:12288
  v_add_u32 v2, 0x8000, v2
  v_and_b32 v2, 0x1ffff, v2
  v_add_u32 v3, 0x8000, v3
  v_and_b32 v3, 0x1ffff, v3
  s_waitcnt lgkmcnt(0)
  s_barrier
  s_add_u32 m0, s41, 0
  s_add_u32 s20, s21, 1572864
  buffer_load_dwordx4 v12, s[12:15], s20 offen offset:0 lds
  buffer_load_dwordx4 v13, s[12:15], s20 offen offset:1024 lds
  buffer_load_dwordx4 v14, s[12:15], s20 offen offset:2048 lds
  buffer_load_dwordx4 v15, s[12:15], s20 offen offset:3072 lds
  s_add_u32 m0, s41, 32768
  s_add_u32 s20, s21, 3670016
  buffer_load_dwordx4 v12, s[12:15], s20 offen offset:0 lds
  buffer_load_dwordx4 v13, s[12:15], s20 offen offset:1024 lds
  buffer_load_dwordx4 v14, s[12:15], s20 offen offset:2048 lds
  buffer_load_dwordx4 v15, s[12:15], s20 offen offset:3072 lds
  s_add_u32 m0, s41, 65536
  s_add_u32 s20, s21, 5767168
  buffer_load_dwordx4 v12, s[12:15], s20 offen offset:0 lds
  buffer_load_dwordx4 v13, s[12:15], s20 offen offset:1024 lds
  buffer_load_dwordx4 v14, s[12:15], s20 offen offset:2048 lds
  buffer_load_dwordx4 v15, s[12:15], s20 offen offset:3072 lds
  s_add_u32 m0, s41, 98304
  s_add_u32 s20, s21, 7864320
  buffer_load_dwordx4 v12, s[12:15], s20 offen offset:0 lds
  buffer_load_dwordx4 v13, s[12:15], s20 offen offset:1024 lds
  buffer_load_dwordx4 v14, s[12:15], s20 offen offset:2048 lds
  buffer_load_dwordx4 v15, s[12:15], s20 offen offset:3072 lds
  s_waitcnt vmcnt(16)
  s_barrier
  ds_read_b64_tr_b16 a[68:69], v2 offset:16384
  ds_read_b64_tr_b16 a[70:71], v2 offset:20480
  ds_read_b64_tr_b16 a[76:77], v3 offset:16384
  ds_read_b64_tr_b16 a[78:79], v3 offset:20480
  ds_read_b64_tr_b16 a[84:85], v2 offset:24576
  ds_read_b64_tr_b16 a[86:87], v2 offset:28672
  ds_read_b64_tr_b16 a[92:93], v3 offset:24576
  ds_read_b64_tr_b16 a[94:95], v3 offset:28672
  v_add_u32 v2, 0x8000, v2
  v_and_b32 v2, 0x1ffff, v2
  v_add_u32 v3, 0x8000, v3
  v_and_b32 v3, 0x1ffff, v3
  ds_read_b64_tr_b16 a[164:165], v2 offset:16384
  ds_read_b64_tr_b16 a[166:167], v2 offset:20480
  ds_read_b64_tr_b16 a[172:173], v3 offset:16384
  ds_read_b64_tr_b16 a[174:175], v3 offset:20480
  ds_read_b64_tr_b16 a[180:181], v2 offset:24576
  ds_read_b64_tr_b16 a[182:183], v2 offset:28672
  ds_read_b64_tr_b16 a[188:189], v3 offset:24576
  ds_read_b64_tr_b16 a[190:191], v3 offset:28672
  v_add_u32 v2, 0x8000, v2
  v_and_b32 v2, 0x1ffff, v2
  v_add_u32 v3, 0x8000, v3
  v_and_b32 v3, 0x1ffff, v3
  ds_read_b64_tr_b16 v[132:133], v2 offset:16384
  ds_read_b64_tr_b16 v[134:135], v2 offset:20480
  ds_read_b64_tr_b16 v[140:141], v3 offset:16384
  ds_read_b64_tr_b16 v[142:143], v3 offset:20480
  ds_read_b64_tr_b16 v[148:149], v2 offset:24576
  ds_read_b64_tr_b16 v[150:151], v2 offset:28672
  ds_read_b64_tr_b16 v[156:157], v3 offset:24576
  ds_read_b64_tr_b16 v[158:159], v3 offset:28672
  v_add_u32 v2, 0x8000, v2
  v_and_b32 v2, 0x1ffff, v2
  v_add_u32 v3, 0x8000, v3
  v_and_b32 v3, 0x1ffff, v3
  ds_read_b64_tr_b16 v[228:229], v2 offset:16384
  ds_read_b64_tr_b16 v[230:231], v2 offset:20480
  ds_read_b64_tr_b16 v[236:237], v3 offset:16384
  ds_read_b64_tr_b16 v[238:239], v3 offset:20480
  ds_read_b64_tr_b16 v[244:245], v2 offset:24576
  ds_read_b64_tr_b16 v[246:247], v2 offset:28672
  ds_read_b64_tr_b16 v[252:253], v3 offset:24576
  ds_read_b64_tr_b16 v[254:255], v3 offset:28672
  v_add_u32 v2, 0x8000, v2
  v_and_b32 v2, 0x1ffff, v2
  v_add_u32 v3, 0x8000, v3
  v_and_b32 v3, 0x1ffff, v3
  s_waitcnt lgkmcnt(0)
  s_barrier
  s_add_u32 m0, s41, 16384
  s_add_u32 s20, s21, 1835008
  buffer_load_dwordx4 v12, s[12:15], s20 offen offset:0 lds
  buffer_load_dwordx4 v13, s[12:15], s20 offen offset:1024 lds
  buffer_load_dwordx4 v14, s[12:15], s20 offen offset:2048 lds
  buffer_load_dwordx4 v15, s[12:15], s20 offen offset:3072 lds
  s_add_u32 m0, s41, 49152
  s_add_u32 s20, s21, 3932160
  buffer_load_dwordx4 v12, s[12:15], s20 offen offset:0 lds
  buffer_load_dwordx4 v13, s[12:15], s20 offen offset:1024 lds
  buffer_load_dwordx4 v14, s[12:15], s20 offen offset:2048 lds
  buffer_load_dwordx4 v15, s[12:15], s20 offen offset:3072 lds
  s_add_u32 m0, s41, 81920
  s_add_u32 s20, s21, 6029312
  buffer_load_dwordx4 v12, s[12:15], s20 offen offset:0 lds
  buffer_load_dwordx4 v13, s[12:15], s20 offen offset:1024 lds
  buffer_load_dwordx4 v14, s[12:15], s20 offen offset:2048 lds
  buffer_load_dwordx4 v15, s[12:15], s20 offen offset:3072 lds
  s_add_u32 m0, s41, 114688
  s_add_u32 s20, s21, 8126464
  buffer_load_dwordx4 v12, s[12:15], s20 offen offset:0 lds
  buffer_load_dwordx4 v13, s[12:15], s20 offen offset:1024 lds
  buffer_load_dwordx4 v14, s[12:15], s20 offen offset:2048 lds
  buffer_load_dwordx4 v15, s[12:15], s20 offen offset:3072 lds
  s_waitcnt vmcnt(0)
  s_barrier
  s_lshl_b32 s3, s27, 15
  v_add_u32 v4, s3, v0
  ds_read_b64_tr_b16 v[64:65], v2 offset:0
  ds_read_b64_tr_b16 v[66:67], v2 offset:4096
  ds_read_b64_tr_b16 v[68:69], v3 offset:0
  ds_read_b64_tr_b16 v[70:71], v3 offset:4096
  ds_read_b64_tr_b16 v[72:73], v2 offset:8192
  ds_read_b64_tr_b16 v[74:75], v2 offset:12288
  ds_read_b64_tr_b16 v[76:77], v3 offset:8192
  ds_read_b64_tr_b16 v[78:79], v3 offset:12288
  v_add_u32 v2, 0x8000, v2
  v_and_b32 v2, 0x1ffff, v2
  v_add_u32 v3, 0x8000, v3
  v_and_b32 v3, 0x1ffff, v3
  ds_read_b64_tr_b16 v[80:81], v2 offset:0
  ds_read_b64_tr_b16 v[82:83], v2 offset:4096
  ds_read_b64_tr_b16 v[84:85], v3 offset:0
  ds_read_b64_tr_b16 v[86:87], v3 offset:4096
  ds_read_b64_tr_b16 v[88:89], v2 offset:8192
  ds_read_b64_tr_b16 v[90:91], v2 offset:12288
  ds_read_b64_tr_b16 v[92:93], v3 offset:8192
  ds_read_b64_tr_b16 v[94:95], v3 offset:12288
  v_add_u32 v2, 0x8000, v2
  v_and_b32 v2, 0x1ffff, v2
  v_add_u32 v3, 0x8000, v3
  v_and_b32 v3, 0x1ffff, v3
  ds_read_b64_tr_b16 v[96:97], v2 offset:0
  ds_read_b64_tr_b16 v[98:99], v2 offset:4096
  ds_read_b64_tr_b16 v[100:101], v3 offset:0
  ds_read_b64_tr_b16 v[102:103], v3 offset:4096
  ds_read_b64_tr_b16 v[104:105], v2 offset:8192
  ds_read_b64_tr_b16 v[106:107], v2 offset:12288
  ds_read_b64_tr_b16 v[108:109], v3 offset:8192
  ds_read_b64_tr_b16 v[110:111], v3 offset:12288
  v_add_u32 v2, 0x8000, v2
  v_and_b32 v2, 0x1ffff, v2
  v_add_u32 v3, 0x8000, v3
  v_and_b32 v3, 0x1ffff, v3
  ds_read_b64_tr_b16 v[112:113], v2 offset:0
  ds_read_b64_tr_b16 v[114:115], v2 offset:4096
  ds_read_b64_tr_b16 v[116:117], v3 offset:0
  ds_read_b64_tr_b16 v[118:119], v3 offset:4096
  ds_read_b64_tr_b16 v[120:121], v2 offset:8192
  ds_read_b64_tr_b16 v[122:123], v2 offset:12288
  ds_read_b64_tr_b16 v[124:125], v3 offset:8192
  ds_read_b64_tr_b16 v[126:127], v3 offset:12288
  v_add_u32 v2, 0x8000, v2
  v_and_b32 v2, 0x1ffff, v2
  v_add_u32 v3, 0x8000, v3
  v_and_b32 v3, 0x1ffff, v3
  s_waitcnt lgkmcnt(0)
  s_barrier
  ds_write_b128 v4, v[64:67] offset:0
  ds_write_b128 v4, v[68:71] offset:1024
  ds_write_b128 v4, v[72:75] offset:2048
  ds_write_b128 v4, v[76:79] offset:3072
  ds_write_b128 v4, v[80:83] offset:4096
  ds_write_b128 v4, v[84:87] offset:5120
  ds_write_b128 v4, v[88:91] offset:6144
  ds_write_b128 v4, v[92:95] offset:7168
  ds_write_b128 v4, v[96:99] offset:8192
  ds_write_b128 v4, v[100:103] offset:9216
  ds_write_b128 v4, v[104:107] offset:10240
  ds_write_b128 v4, v[108:111] offset:11264
  ds_write_b128 v4, v[112:115] offset:12288
  ds_write_b128 v4, v[116:119] offset:13312
  ds_write_b128 v4, v[120:123] offset:14336
  ds_write_b128 v4, v[124:127] offset:15360
  s_waitcnt lgkmcnt(0)
  ds_read_b64_tr_b16 v[64:65], v2 offset:16384
  ds_read_b64_tr_b16 v[66:67], v2 offset:20480
  ds_read_b64_tr_b16 v[68:69], v3 offset:16384
  ds_read_b64_tr_b16 v[70:71], v3 offset:20480
  ds_read_b64_tr_b16 v[72:73], v2 offset:24576
  ds_read_b64_tr_b16 v[74:75], v2 offset:28672
  ds_read_b64_tr_b16 v[76:77], v3 offset:24576
  ds_read_b64_tr_b16 v[78:79], v3 offset:28672
  v_add_u32 v2, 0x8000, v2
  v_and_b32 v2, 0x1ffff, v2
  v_add_u32 v3, 0x8000, v3
  v_and_b32 v3, 0x1ffff, v3
  ds_read_b64_tr_b16 v[80:81], v2 offset:16384
  ds_read_b64_tr_b16 v[82:83], v2 offset:20480
  ds_read_b64_tr_b16 v[84:85], v3 offset:16384
  ds_read_b64_tr_b16 v[86:87], v3 offset:20480
  ds_read_b64_tr_b16 v[88:89], v2 offset:24576
  ds_read_b64_tr_b16 v[90:91], v2 offset:28672
  ds_read_b64_tr_b16 v[92:93], v3 offset:24576
  ds_read_b64_tr_b16 v[94:95], v3 offset:28672
  v_add_u32 v2, 0x8000, v2
  v_and_b32 v2, 0x1ffff, v2
  v_add_u32 v3, 0x8000, v3
  v_and_b32 v3, 0x1ffff, v3
  ds_read_b64_tr_b16 v[96:97], v2 offset:16384
  ds_read_b64_tr_b16 v[98:99], v2 offset:20480
  ds_read_b64_tr_b16 v[100:101], v3 offset:16384
  ds_read_b64_tr_b16 v[102:103], v3 offset:20480
  ds_read_b64_tr_b16 v[104:105], v2 offset:24576
  ds_read_b64_tr_b16 v[106:107], v2 offset:28672
  ds_read_b64_tr_b16 v[108:109], v3 offset:24576
  ds_read_b64_tr_b16 v[110:111], v3 offset:28672
  v_add_u32 v2, 0x8000, v2
  v_and_b32 v2, 0x1ffff, v2
  v_add_u32 v3, 0x8000, v3
  v_and_b32 v3, 0x1ffff, v3
  ds_read_b64_tr_b16 v[112:113], v2 offset:16384
  ds_read_b64_tr_b16 v[114:115], v2 offset:20480
  ds_read_b64_tr_b16 v[116:117], v3 offset:16384
  ds_read_b64_tr_b16 v[118:119], v3 offset:20480
  ds_read_b64_tr_b16 v[120:121], v2 offset:24576
  ds_read_b64_tr_b16 v[122:123], v2 offset:28672
  ds_read_b64_tr_b16 v[124:125], v3 offset:24576
  ds_read_b64_tr_b16 v[126:127], v3 offset:28672
  v_add_u32 v2, 0x8000, v2
  v_and_b32 v2, 0x1ffff, v2
  v_add_u32 v3, 0x8000, v3
  v_and_b32 v3, 0x1ffff, v3
  s_waitcnt lgkmcnt(0)
  s_barrier
  ds_write_b128 v4, v[64:67] offset:16384
  ds_write_b128 v4, v[68:71] offset:17408
  ds_write_b128 v4, v[72:75] offset:18432
  ds_write_b128 v4, v[76:79] offset:19456
  ds_write_b128 v4, v[80:83] offset:20480
  ds_write_b128 v4, v[84:87] offset:21504
  ds_write_b128 v4, v[88:91] offset:22528
  ds_write_b128 v4, v[92:95] offset:23552
  ds_write_b128 v4, v[96:99] offset:24576
  ds_write_b128 v4, v[100:103] offset:25600
  ds_write_b128 v4, v[104:107] offset:26624
  ds_write_b128 v4, v[108:111] offset:27648
  ds_write_b128 v4, v[112:115] offset:28672
  ds_write_b128 v4, v[116:119] offset:29696
  ds_write_b128 v4, v[120:123] offset:30720
  ds_write_b128 v4, v[124:127] offset:31744
  s_waitcnt lgkmcnt(0)
  v_mov_b32 v2, v4
  v_and_b32 v18, 8, v30
  v_cmp_eq_u32 vcc, 0, v18
  v_mov_b32 v1, 0xeeee
  v_mov_b32 v18, 0x4444
  v_cndmask_b32 v1, v1, v18, vcc
  s_add_u32 s3, s41, 131072
  v_add_u32 v5, s3, v0
  s_mov_b32 s51, 0x3f80
  s_mov_b32 s52, 0x3f800000
  s_lshl_b32 s53, s33, 11
  s_add_u32 s53, s53, 229376
  s_cmp_eq_u32 s27, 3
  s_cselect_b32 s20, 1, 0
  s_mov_b32 s21, 0
  s_mov_b32 s31, 0
  s_mov_b32 s32, 85983232
  s_mov_b32 s25, 86769664
  s_mov_b32 s26, 86245376
  s_lshl_b32 s3, s33, 14
  s_add_u32 s48, s3, s41
  s_xor_b32 s49, s48, 16384
  s_and_b32 s3, s49, 0x6000
  s_add_u32 s49, s49, s3
  s_add_u32 s48, s48, 65536
  s_lshl_b32 s50, s30, 11
  s_lshl_b32 s22, s33, 11
  s_add_u32 s22, s22, 233472
  v_lshrrev_b32 v18, 5, v30
  v_lshlrev_b32 v6, 9, v18
  v_and_b32 v18, 15, v30
  v_lshl_add_u32 v6, v18, 5, v6
  v_bfe_u32 v18, v30, 4, 1
  v_lshl_add_u32 v6, v18, 3, v6
  s_lshl_b32 s3, s27, 10
  s_add_u32 s3, s3, 135168
  v_add_u32 v6, s3, v6
  v_lshlrev_b32 v7, 3, v30
  v_add_u32 v7, 135168, v7
  v_add_u32 v8, 147456, v0
  v_and_b32 v18, 3, v30
  v_lshlrev_b32 v9, 8, v18
  v_lshrrev_b32 v18, 2, v30
  v_lshl_add_u32 v9, v18, 4, v9
  v_and_b32 v18, 1, v30
  v_lshlrev_b32 v18, 7, v18
  v_xor_b32 v9, v9, v18
  s_lshl_b32 s3, s27, 10
  s_add_u32 s3, s3, 155648
  v_add_u32 v9, s3, v9
  v_xor_b32 v3, 0x400, v9
  v_and_b32 v18, 31, v30
  v_lshlrev_b32 v10, 4, v18
  s_lshl_b32 s3, s27, 9
  v_add_u32 v10, s3, v10
  v_xor_b32 v13, 0x200, v10
  v_and_b32 v18, 7, v30
  v_lshlrev_b32 v11, 4, v18
  v_lshrrev_b32 v18, 4, v30
  v_lshl_add_u32 v11, v18, 7, v11
  s_lshl_b32 s3, s27, 9
  v_add_u32 v11, s3, v11
  s_lshl_b32 s3, s34, 4
  s_add_u32 s53, s53, s3
  s_lshl_b32 s3, s27, 2
  s_add_u32 s53, s53, s3
  s_mov_b32 s20, 1
  v_mov_b32 v108, 0xffbfffbf
  v_mov_b32 v109, 0xffbfffbf
  v_mov_b32 v110, 0xffbfffbf
  v_mov_b32 v111, 0xffbfffbf
  s_getpc_b64 s[4:5]
HS_28_pc:
  s_add_u32 s4, s4, CP1_top-HS_28_pc
  s_addc_u32 s5, s5, 0
  v_lshlrev_b32 v18, 2, v0
  v_add_u32 v18, s41, v18
  v_min_u32 v18, CP0_top-CP1_top-4, v18
  global_load_dword v19, v18, s[4:5]
  s_mov_b32 s40, 0
  s_lshl_b32 s7, s33, 3
HS_28:
  buffer_load_dwordx2 v[20:21], off, s[68:71], s7 offset:8 sc1
  buffer_load_dwordx2 v[22:23], off, s[68:71], 0 offset:128 sc1
  s_add_u32 s40, s40, 1
  s_cmp_gt_u32 s40, 65536
  s_cbranch_scc1 L_abort
  s_waitcnt vmcnt(0)
  v_readfirstlane_b32 s4, v20
  v_readfirstlane_b32 s5, v21
  v_readfirstlane_b32 s6, v22
  v_readfirstlane_b32 s3, v23
  s_cmp_eq_u32 s3, 0
  s_cbranch_scc1 HS_28_s
  s_cmp_eq_u32 s6, 0
  s_cbranch_scc1 HS_28_s
  s_add_u32 s3, s4, s5
  s_mul_i32 s3, s3, 0x01010101
  s_lshr_b32 s3, s3, 24
  s_cmp_eq_u32 s3, 32
  s_cbranch_scc1 HS_28_ok
HS_28_s:
  s_sleep 4
  s_branch HS_28
HS_28_ok:
  s_lshr_b64 s[4:5], s[4:5], s47
  s_and_b32 s4, s4, 0xff
  s_cmp_eq_u32 s4, 32
  s_cselect_b32 s37, 1, 0
  s_and_b32 s6, s6, 1
  s_lshl_b32 s6, s6, 13
  s_add_u32 s49, s49, s6
  s_xor_b32 s45, s33, 1
  s_lshl_b32 s45, s45, 7
  s_add_u32 s45, s45, s6
  s_add_u32 s45, s45, 246784
  s_sub_u32 s45, s45, s22
  s_cmp_eq_u32 s37, 0
  s_cbranch_scc1 CP_nl
  s_add_u32 s3, s50, 86081536
  s_add_u32 s4, s53, 85983232
  buffer_load_dword v18, v11, s[8:11], s3 offen sc1
  buffer_load_dword v18, off, s[8:11], s4 sc1
  s_add_u32 s3, s50, 86343680
  s_add_u32 s4, s53, 86245376
  buffer_load_dword v18, v11, s[8:11], s3 offen sc1
  buffer_load_dword v18, off, s[8:11], s4 sc1
  s_add_u32 s3, s50, 86605824
  s_add_u32 s4, s53, 86507520
  buffer_load_dword v18, v11, s[8:11], s3 offen sc1
  buffer_load_dword v18, off, s[8:11], s4 sc1
  s_add_u32 s3, s50, 86867968
  s_add_u32 s4, s53, 86769664
  buffer_load_dword v18, v11, s[8:11], s3 offen sc1
  buffer_load_dword v18, off, s[8:11], s4 sc1
  s_waitcnt vmcnt(0)
  s_add_u32 s3, s50, 86081536
  s_add_u32 s4, s53, 85983232
  buffer_store_dwordx4 v[108:111], v11, s[8:11], s3 offen
  s_mov_b64 exec, s[20:21]
  buffer_store_dword v108, off, s[8:11], s4
  s_mov_b64 exec, -1
  s_add_u32 s3, s50, 86343680
  s_add_u32 s4, s53, 86245376
  buffer_store_dwordx4 v[108:111], v11, s[8:11], s3 offen
  s_mov_b64 exec, s[20:21]
  buffer_store_dword v108, off, s[8:11], s4
  s_mov_b64 exec, -1
  s_add_u32 s3, s50, 86605824
  s_add_u32 s4, s53, 86507520
  buffer_store_dwordx4 v[108:111], v11, s[8:11], s3 offen
  s_mov_b64 exec, s[20:21]
  buffer_store_dword v108, off, s[8:11], s4
  s_mov_b64 exec, -1
  s_add_u32 s3, s50, 86867968
  s_add_u32 s4, s53, 86769664
  buffer_store_dwordx4 v[108:111], v11, s[8:11], s3 offen
  s_mov_b64 exec, s[20:21]
  buffer_store_dword v108, off, s[8:11], s4
  s_mov_b64 exec, -1
CP_nl:
  s_lshl_b32 s3, s29, 4
  v_and_b32 v18, 15, v30
  v_add_u32 v18, s3, v18
  v_lshrrev_b32 v19, 4, v30
  v_lshlrev_b32 v19, 2, v19
  v_sub_u32 v18, v18, v19
  v_cmp_le_i32 s[68:69], 0, v18
  v_cmp_le_i32 s[70:71], 1, v18
  v_cmp_le_i32 s[72:73], 2, v18
  v_cmp_le_i32 s[74:75], 3, v18
  v_cmp_le_i32 s[76:77], 16, v18
  v_cmp_le_i32 s[78:79], 17, v18
  v_cmp_le_i32 s[80:81], 18, v18
  v_cmp_le_i32 s[82:83], 19, v18
  s_mul_i32 s35, s30, 1572864
  s_add_u32 s35, s35, 4194304
  s_lshl_b32 s36, s30, 2
  s_add_u32 s36, s36, s27
  s_lshl_b32 s36, s36, 17
  s_lshl_b32 s3, s29, 10
  s_add_u32 s36, s36, s3
  s_mov_b32 s100, 0x3e0293ee
  s_mov_b32 s101, 0x3e0293ee
  s_add_u32 s46, s41, 147456
  s_mov_b32 s7, 99614720
  s_cmp_lg_u32 s27, 0
  s_cbranch_scc1 Wkv0_29_ok
  s_mov_b32 s4, 0
Wkv0_29:
  buffer_load_dword v18, off, s[8:11], s7 offset:0 sc1
  s_add_u32 s4, s4, 1
  s_cmp_gt_u32 s4, 65536
  s_cbranch_scc1 L_abort
  s_waitcnt vmcnt(0)
  v_readfirstlane_b32 s3, v18
  s_cmp_ge_u32 s3, 96
  s_cbranch_scc1 Wkv0_29_ok
  s_sleep 4
  s_branch Wkv0_29
Wkv0_29_ok:
  s_barrier
  s_mov_b32 m0, s46
  s_add_u32 s5, s35, s41
  s_add_u32 s5, s5, 8192
  s_lshl_b32 s4, s28, 7
  v_lshrrev_b32 v15, 1, v0
  v_and_b32 v15, s4, v15
  v_xor_b32 v15, v15, v0
  buffer_load_dwordx4 v15, s[8:11], s5 offen offset:0 sc1 lds
  buffer_load_dwordx4 v15, s[8:11], s5 offen offset:1024 sc1 lds
  buffer_load_dwordx4 v15, s[8:11], s5 offen offset:2048 sc1 lds
  buffer_load_dwordx4 v15, s[8:11], s5 offen offset:3072 sc1 lds
  s_lshr_b32 s5, s41, 1
  s_add_u32 s5, s5, s35
  s_add_u32 s5, s5, 0
  v_lshlrev_b32 v15, 3, v0
  s_mov_b64 exec, 0xffff
  buffer_load_dword v14, v15, s[8:11], s5 offen sc1
  s_mov_b64 exec, -1
  s_add_u32 s5, s31, 1
  s_lshr_b32 s5, s5, 2
  s_lshl_b32 s5, s5, 7
  s_add_u32 s5, s5, 99614720
  buffer_load_dword v12, off, s[8:11], s5 sc1
  s_mov_b32 s16, s8
  s_mov_b32 s17, s9
  s_mov_b32 s18, 0
  s_mov_b32 s19, 0x20000
  s_mov_b32 s38, 0
  s_mov_b32 s39, 0
  s_cmp_eq_u32 s27, 0
  s_cselect_b32 s23, 4, -1
  s_cmp_eq_u32 s37, 0
  s_cbranch_scc1 CP0_top
.p2align 6
CP1_top:
  s_mov_b32 s40, 0
  ds_read_b128 v[64:67], v2 offset:0
  ds_read_b128 v[68:71], v2 offset:16384
  ds_read_b128 v[72:75], v2 offset:1024
  ds_read_b128 v[76:79], v2 offset:17408
  v_mov_b64 v[16:17], 0
  v_mov_b64 v[18:19], 0
  v_mov_b64 v[20:21], 0
  v_mov_b64 v[22:23], 0
  v_mov_b64 v[24:25], 0
  v_mov_b64 v[26:27], 0
  v_mov_b64 v[28:29], 0
  v_mov_b64 v[30:31], 0
  v_add_u32 v4, 4096, v5
  v_and_b32 v4, 0x23fff, v4
  s_add_u32 s44, s32, s50
  s_add_u32 s54, s44, 98304
  s_add_u32 s44, s44, 163840
  s_add_u32 s55, s32, s53
  s_lshl_b32 s24, s29, 12
  s_add_u32 s24, s24, s35
  s_add_u32 s42, s32, s48
  s_add_u32 s43, s32, s49
  v_lshrrev_b32 v15, 2, v0
  s_add_u32 s3, s32, s22
  v_writelane_b32 v15, s45, 16
  s_cmp_lg_u32 s27, 3
  s_cbranch_scc1 Ql_30_w
  s_mov_b64 exec, 0x1ffff
  buffer_load_dword v14, v15, s[8:11], s3 offen sc1
  s_nop 15
  buffer_load_dword v32, v15, s[8:11], s3 offen sc1
  s_nop 15
  buffer_load_dword v33, v15, s[8:11], s3 offen sc1
  s_nop 15
Ql_30:
  buffer_load_dword v34, v15, s[8:11], s3 offen sc1
  s_waitcnt vmcnt(3)
  v_cmp_eq_u32 vcc, 0xffbfffbf, v14
  s_cbranch_vccz Ql_30_ok
  buffer_load_dword v14, v15, s[8:11], s3 offen sc1
  s_waitcnt vmcnt(3)
  v_cmp_eq_u32 vcc, 0xffbfffbf, v32
  s_cbranch_vccz Ql_30_ok
  buffer_load_dword v32, v15, s[8:11], s3 offen sc1
  s_waitcnt vmcnt(3)
  v_cmp_eq_u32 vcc, 0xffbfffbf, v33
  s_cbranch_vccz Ql_30_ok
  buffer_load_dword v33, v15, s[8:11], s3 offen sc1
  s_waitcnt vmcnt(3)
  v_cmp_eq_u32 vcc, 0xffbfffbf, v34
  s_cbranch_vccz Ql_30_ok
  s_add_u32 s40, s40, 1
  s_cmp_gt_u32 s40, 65536
  s_cbranch_scc1 L_abort
  s_branch Ql_30
Ql_30_ok:
  s_mov_b64 exec, -1
Ql_30_w:
  s_barrier
  s_nop 15
  buffer_load_dwordx4 v[96:99], v0, s[8:11], s42 offen offset:0 sc1
  buffer_load_dwordx4 v[100:103], v0, s[8:11], s42 offen offset:1024 sc1
  buffer_load_dwordx4 v[104:107], v0, s[8:11], s42 offen offset:2048 sc1
  buffer_load_dwordx4 v[108:111], v0, s[8:11], s42 offen offset:3072 sc1
  s_nop 15
  s_nop 15
  buffer_load_dwordx4 v[48:51], v0, s[8:11], s43 offen offset:0 sc1
  buffer_load_dwordx4 v[52:55], v0, s[8:11], s43 offen offset:1024 sc1
  buffer_load_dwordx4 v[56:59], v0, s[8:11], s43 offen offset:2048 sc1
  buffer_load_dwordx4 v[60:63], v0, s[8:11], s43 offen offset:3072 sc1
  s_waitcnt vmcnt(4)
Pa_32:
  v_max3_u32 v14, v96, v97, v98
  v_max3_u32 v15, v99, v100, v101
  v_max3_u32 v14, v14, v102, v103
  v_max3_u32 v15, v15, v104, v105
  v_max3_u32 v14, v14, v106, v107
  v_max3_u32 v15, v15, v108, v109
  v_max3_u32 v14, v14, v110, v111
  v_max_u32 v14, v14, v15
  v_cmp_eq_u32 vcc, 0xffbfffbf, v14
  s_cbranch_vccnz Pa_32_re
  v_lshlrev_b32 v80, 16, v96
  v_and_b32 v81, 0xffff0000, v96
  v_lshlrev_b32 v82, 16, v97
  v_and_b32 v83, 0xffff0000, v97
  v_lshlrev_b32 v84, 16, v98
  v_and_b32 v85, 0xffff0000, v98
  v_lshlrev_b32 v86, 16, v99
  v_and_b32 v87, 0xffff0000, v99
  v_lshlrev_b32 v88, 16, v100
  v_and_b32 v89, 0xffff0000, v100
  v_lshlrev_b32 v90, 16, v101
  v_and_b32 v91, 0xffff0000, v101
  v_lshlrev_b32 v92, 16, v102
  v_and_b32 v93, 0xffff0000, v102
  v_lshlrev_b32 v94, 16, v103
  v_and_b32 v95, 0xffff0000, v103
  v_lshlrev_b32 v96, 16, v104
  v_and_b32 v97, 0xffff0000, v104
  v_lshlrev_b32 v98, 16, v105
  v_and_b32 v99, 0xffff0000, v105
  v_lshlrev_b32 v100, 16, v106
  v_and_b32 v101, 0xffff0000, v106
  v_lshlrev_b32 v102, 16, v107
  v_and_b32 v103, 0xffff0000, v107
  v_lshlrev_b32 v104, 16, v108
  v_and_b32 v105, 0xffff0000, v108
  v_lshlrev_b32 v106, 16, v109
  v_and_b32 v107, 0xffff0000, v109
  v_lshlrev_b32 v108, 16, v110
  v_and_b32 v109, 0xffff0000, v110
  v_lshlrev_b32 v110, 16, v111
  v_and_b32 v111, 0xffff0000, v111
GA_31_u:
.p2align 3
  s_waitcnt vmcnt(3)
  s_nop 0
  v_dot2_f32_bf16 v120, v48, s51, v80
  v_dot2_f32_bf16 v121, v48, s52, v81
  v_dot2_f32_bf16 v122, v49, s51, v82
  v_dot2_f32_bf16 v123, v49, s52, v83
  v_dot2_f32_bf16 v124, v50, s51, v84
  v_dot2_f32_bf16 v125, v50, s52, v85
  v_dot2_f32_bf16 v126, v51, s51, v86
  v_dot2_f32_bf16 v127, v51, s52, v87
  v_max3_u32 v14, v48, v49, v49
  v_max3_u32 v14, v50, v51, v14
  v_cvt_pk_bf16_f32 v32, v120, v121
  v_cvt_pk_bf16_f32 v33, v122, v123
  v_cvt_pk_bf16_f32 v34, v124, v125
  v_cvt_pk_bf16_f32 v35, v126, v127
  ds_write_b128 v5, v[32:35] offset:0
  s_waitcnt vmcnt(2)
  s_nop 0
  v_dot2_f32_bf16 v120, v52, s51, v88
  v_dot2_f32_bf16 v121, v52, s52, v89
  v_dot2_f32_bf16 v122, v53, s51, v90
  v_dot2_f32_bf16 v123, v53, s52, v91
  v_dot2_f32_bf16 v124, v54, s51, v92
  v_dot2_f32_bf16 v125, v54, s52, v93
  v_dot2_f32_bf16 v126, v55, s51, v94
  v_dot2_f32_bf16 v127, v55, s52, v95
  v_max3_u32 v14, v52, v53, v14
  v_max3_u32 v14, v54, v55, v14
  v_cvt_pk_bf16_f32 v36, v120, v121
  v_cvt_pk_bf16_f32 v37, v122, v123
  v_cvt_pk_bf16_f32 v38, v124, v125
  v_cvt_pk_bf16_f32 v39, v126, v127
  ds_write_b128 v5, v[36:39] offset:1024
  s_waitcnt vmcnt(1)
  s_nop 0
  v_dot2_f32_bf16 v120, v56, s51, v96
  v_dot2_f32_bf16 v121, v56, s52, v97
  v_dot2_f32_bf16 v122, v57, s51, v98
  v_dot2_f32_bf16 v123, v57, s52, v99
  v_dot2_f32_bf16 v124, v58, s51, v100
  v_dot2_f32_bf16 v125, v58, s52, v101
  v_dot2_f32_bf16 v126, v59, s51, v102
  v_dot2_f32_bf16 v127, v59, s52, v103
  v_max3_u32 v14, v56, v57, v14
  v_max3_u32 v14, v58, v59, v14
  v_cvt_pk_bf16_f32 v40, v120, v121
  v_cvt_pk_bf16_f32 v41, v122, v123
  v_cvt_pk_bf16_f32 v42, v124, v125
  v_cvt_pk_bf16_f32 v43, v126, v127
  ds_write_b128 v5, v[40:43] offset:2048
  s_waitcnt vmcnt(0)
  s_nop 0
  v_dot2_f32_bf16 v120, v60, s51, v104
  v_dot2_f32_bf16 v121, v60, s52, v105
  v_dot2_f32_bf16 v122, v61, s51, v106
  v_dot2_f32_bf16 v123, v61, s52, v107
  v_dot2_f32_bf16 v124, v62, s51, v108
  v_dot2_f32_bf16 v125, v62, s52, v109
  v_dot2_f32_bf16 v126, v63, s51, v110
  v_dot2_f32_bf16 v127, v63, s52, v111
  v_max3_u32 v14, v60, v61, v14
  v_max3_u32 v14, v62, v63, v14
  v_cmp_eq_u32 vcc, 0xffbfffbf, v14
  v_cvt_pk_bf16_f32 v44, v120, v121
  v_cvt_pk_bf16_f32 v45, v122, v123
  v_cvt_pk_bf16_f32 v46, v124, v125
  v_cvt_pk_bf16_f32 v47, v126, v127
  ds_write_b128 v5, v[44:47] offset:3072
  s_cbranch_vccnz GA_31_re
  v_smfmac_f32_16x16x64_bf16 v[16:19], v[32:35], a[0:7], v1
  buffer_store_dwordx4 v[112:115], v0, s[16:19], s38 offen sc1
  v_smfmac_f32_16x16x64_bf16 v[16:19], v[36:39], a[32:39], v1
  buffer_store_dwordx4 v[116:119], v0, s[16:19], s39 offen sc1
  v_smfmac_f32_16x16x64_bf16 v[16:19], v[40:43], a[64:71], v1
  s_waitcnt lgkmcnt(0)
  s_barrier
  ds_read_b128 v[48:51], v4 offset:0
  ds_read_b128 v[52:55], v4 offset:1024
  v_smfmac_f32_16x16x64_bf16 v[16:19], v[44:47], v[64:71], v1
  ds_read_b128 v[64:67], v2 offset:2048
  v_smfmac_f32_16x16x64_bf16 v[20:23], v[32:35], a[8:15], v1
  ds_read_b128 v[68:71], v2 offset:18432
  v_smfmac_f32_16x16x64_bf16 v[20:23], v[36:39], a[40:47], v1
  ds_read_b128 v[56:59], v4 offset:2048
  v_smfmac_f32_16x16x64_bf16 v[20:23], v[40:43], a[72:79], v1
  ds_read_b128 v[60:63], v4 offset:3072
  v_smfmac_f32_16x16x64_bf16 v[20:23], v[44:47], v[72:79], v1
  ds_read_b128 v[72:75], v2 offset:3072
  v_smfmac_f32_16x16x64_bf16 v[24:27], v[32:35], a[16:23], v1
  ds_read_b128 v[76:79], v2 offset:19456
  v_smfmac_f32_16x16x64_bf16 v[24:27], v[36:39], a[48:55], v1
  v_add_u32 v4, 4096, v4
  v_smfmac_f32_16x16x64_bf16 v[24:27], v[40:43], a[80:87], v1
  v_and_b32 v4, 0x23fff, v4
  s_waitcnt lgkmcnt(4)
  v_smfmac_f32_16x16x64_bf16 v[24:27], v[44:47], v[64:71], v1
  ds_read_b128 v[64:67], v2 offset:4096
  v_smfmac_f32_16x16x64_bf16 v[28:31], v[32:35], a[24:31], v1
  ds_read_b128 v[68:71], v2 offset:20480
  v_smfmac_f32_16x16x64_bf16 v[28:31], v[36:39], a[56:63], v1
  ds_read_b128 v[80:83], v8 offset:4096
  v_smfmac_f32_16x16x64_bf16 v[28:31], v[40:43], a[88:95], v1
  ds_read_b128 v[84:87], v8 offset:5120
  s_waitcnt lgkmcnt(4)
  v_smfmac_f32_16x16x64_bf16 v[28:31], v[44:47], v[72:79], v1
  ds_read_b128 v[72:75], v2 offset:5120
  v_smfmac_f32_16x16x64_bf16 v[16:19], v[48:51], a[96:103], v1
  ds_read_b128 v[76:79], v2 offset:21504
  v_smfmac_f32_16x16x64_bf16 v[16:19], v[52:55], a[128:135], v1
  ds_read_b128 v[32:35], v4 offset:0
  v_smfmac_f32_16x16x64_bf16 v[16:19], v[56:59], a[160:167], v1
  ds_read_b128 v[36:39], v4 offset:1024
  s_waitcnt lgkmcnt(6)
  v_smfmac_f32_16x16x64_bf16 v[16:19], v[60:63], v[64:71], v1
  ds_read_b128 v[64:67], v2 offset:6144
  v_smfmac_f32_16x16x64_bf16 v[20:23], v[48:51], a[104:111], v1
  ds_read_b128 v[68:71], v2 offset:22528
  v_smfmac_f32_16x16x64_bf16 v[20:23], v[52:55], a[136:143], v1
  ds_read_b128 v[40:43], v4 offset:2048
  v_smfmac_f32_16x16x64_bf16 v[20:23], v[56:59], a[168:175], v1
  ds_read_b128 v[44:47], v4 offset:3072
  s_waitcnt lgkmcnt(6)
  v_smfmac_f32_16x16x64_bf16 v[20:23], v[60:63], v[72:79], v1
  ds_read_b128 v[72:75], v2 offset:7168
  v_smfmac_f32_16x16x64_bf16 v[24:27], v[48:51], a[112:119], v1
  ds_read_b128 v[76:79], v2 offset:23552
  v_smfmac_f32_16x16x64_bf16 v[24:27], v[52:55], a[144:151], v1
  v_add_u32 v4, 4096, v4
  v_smfmac_f32_16x16x64_bf16 v[24:27], v[56:59], a[176:183], v1
  v_and_b32 v4, 0x23fff, v4
  s_waitcnt lgkmcnt(4)
  v_smfmac_f32_16x16x64_bf16 v[24:27], v[60:63], v[64:71], v1
  ds_read_b128 v[64:67], v2 offset:8192
  v_smfmac_f32_16x16x64_bf16 v[28:31], v[48:51], a[120:127], v1
  ds_read_b128 v[68:71], v2 offset:24576
  v_smfmac_f32_16x16x64_bf16 v[28:31], v[52:55], a[152:159], v1
  ds_read_b128 v[88:91], v8 offset:6144
  v_smfmac_f32_16x16x64_bf16 v[28:31], v[56:59], a[184:191], v1
  ds_read_b128 v[92:95], v8 offset:7168
  s_waitcnt lgkmcnt(4)
  v_smfmac_f32_16x16x64_bf16 v[28:31], v[60:63], v[72:79], v1
  ds_read_b128 v[72:75], v2 offset:9216
  v_smfmac_f32_16x16x64_bf16 v[16:19], v[32:35], a[192:199], v1
  ds_read_b128 v[76:79], v2 offset:25600
  v_smfmac_f32_16x16x64_bf16 v[16:19], v[36:39], a[224:231], v1
  ds_read_b128 v[48:51], v4 offset:0
  v_smfmac_f32_16x16x64_bf16 v[16:19], v[40:43], v[128:135], v1
  ds_read_b128 v[52:55], v4 offset:1024
  s_waitcnt lgkmcnt(6)
  v_smfmac_f32_16x16x64_bf16 v[16:19], v[44:47], v[64:71], v1
  ds_read_b128 v[64:67], v2 offset:10240
  v_smfmac_f32_16x16x64_bf16 v[20:23], v[32:35], a[200:207], v1
  ds_read_b128 v[68:71], v2 offset:26624
  v_smfmac_f32_16x16x64_bf16 v[20:23], v[36:39], a[232:239], v1
  ds_read_b128 v[56:59], v4 offset:2048
  v_smfmac_f32_16x16x64_bf16 v[20:23], v[40:43], v[136:143], v1
  ds_read_b128 v[60:63], v4 offset:3072
  s_waitcnt lgkmcnt(6)
  v_smfmac_f32_16x16x64_bf16 v[20:23], v[44:47], v[72:79], v1
  ds_read_b128 v[72:75], v2 offset:11264
  v_smfmac_f32_16x16x64_bf16 v[24:27], v[32:35], a[208:215], v1
  ds_read_b128 v[76:79], v2 offset:27648
  v_smfmac_f32_16x16x64_bf16 v[24:27], v[36:39], a[240:247], v1
  v_lshlrev_b32 v4, 22, v0
  v_smfmac_f32_16x16x64_bf16 v[24:27], v[40:43], v[144:151], v1
  v_ashrrev_i32 v4, 8, v4
  s_waitcnt lgkmcnt(4)
  v_smfmac_f32_16x16x64_bf16 v[24:27], v[44:47], v[64:71], v1
  ds_read_b128 v[64:67], v2 offset:12288
  v_smfmac_f32_16x16x64_bf16 v[28:31], v[32:35], a[216:223], v1
  ds_read_b128 v[68:71], v2 offset:28672
  v_smfmac_f32_16x16x64_bf16 v[28:31], v[36:39], a[248:255], v1
  v_xor_b32 v4, -1, v4
  v_smfmac_f32_16x16x64_bf16 v[28:31], v[40:43], v[152:159], v1
  v_and_b32 v4, 0xff800000, v4
  s_waitcnt lgkmcnt(2)
  v_smfmac_f32_16x16x64_bf16 v[28:31], v[44:47], v[72:79], v1
  ds_read_b128 v[72:75], v2 offset:13312
  s_barrier
  v_smfmac_f32_16x16x64_bf16 v[16:19], v[48:51], v[160:167], v1
  ds_read_b128 v[76:79], v2 offset:29696
  v_smfmac_f32_16x16x64_bf16 v[16:19], v[52:55], v[192:199], v1
  ds_read_b128 v[32:35], v8 offset:0
  v_smfmac_f32_16x16x64_bf16 v[16:19], v[56:59], v[224:231], v1
  ds_read_b128 v[36:39], v8 offset:1024
  s_waitcnt lgkmcnt(4)
  v_smfmac_f32_16x16x64_bf16 v[16:19], v[60:63], v[64:71], v1
  ds_read_b128 v[64:67], v2 offset:14336
  v_smfmac_f32_16x16x64_bf16 v[20:23], v[48:51], v[168:175], v1
  ds_read_b128 v[68:71], v2 offset:30720
  v_smfmac_f32_16x16x64_bf16 v[20:23], v[52:55], v[200:207], v1
  ds_read_b128 v[40:43], v8 offset:2048
  v_smfmac_f32_16x16x64_bf16 v[20:23], v[56:59], v[232:239], v1
  ds_read_b128 v[44:47], v8 offset:3072
  s_waitcnt lgkmcnt(6)
  v_smfmac_f32_16x16x64_bf16 v[20:23], v[60:63], v[72:79], v1
  ds_read_b128 v[72:75], v2 offset:15360
  v_smfmac_f32_16x16x64_bf16 v[24:27], v[48:51], v[176:183], v1
  ds_read_b128 v[76:79], v2 offset:31744
  v_smfmac_f32_16x16x64_bf16 v[24:27], v[52:55], v[208:215], v1
  v_smfmac_f32_16x16x64_bf16 v[24:27], v[56:59], v[240:247], v1
  s_nop 1
  s_waitcnt lgkmcnt(4)
  v_smfmac_f32_16x16x64_bf16 v[24:27], v[60:63], v[64:71], v1
  v_permlane32_swap_b32 v16, v20
  v_smfmac_f32_16x16x64_bf16 v[28:31], v[48:51], v[184:191], v1
  v_permlane32_swap_b32 v17, v21
  v_smfmac_f32_16x16x64_bf16 v[28:31], v[52:55], v[216:223], v1
  v_permlane32_swap_b32 v18, v22
  v_smfmac_f32_16x16x64_bf16 v[28:31], v[56:59], v[248:255], v1
  v_permlane32_swap_b32 v19, v23
  s_waitcnt lgkmcnt(0)
  v_smfmac_f32_16x16x64_bf16 v[28:31], v[60:63], v[72:79], v1
  v_pk_add_f32 v[16:17], v[16:17], v[20:21]
  v_pk_add_f32 v[18:19], v[18:19], v[22:23]
  v_cvt_pk_bf16_f32 v20, v16, v17
  v_cvt_pk_bf16_f32 v21, v18, v19
  ds_write_b64 v6, v[20:21] offset:0
  v_mov_b32 v16, v4
  v_mov_b32 v17, v4
  v_mov_b32 v18, v4
  v_mov_b32 v19, v4
  v_permlane32_swap_b32 v24, v28
  v_permlane32_swap_b32 v25, v29
  v_permlane32_swap_b32 v26, v30
  v_permlane32_swap_b32 v27, v31
  v_pk_add_f32 v[24:25], v[24:25], v[28:29]
  v_pk_add_f32 v[26:27], v[26:27], v[30:31]
  v_cvt_pk_bf16_f32 v22, v24, v25
  v_cvt_pk_bf16_f32 v23, v26, v27
  ds_write_b64 v6, v[22:23] offset:16
  s_waitcnt lgkmcnt(0)
  s_barrier
  ds_read_b64_tr_b16 v[48:49], v7 offset:0
  ds_read_b64_tr_b16 v[50:51], v7 offset:512
  ds_read_b64_tr_b16 v[52:53], v7 offset:1024
  ds_read_b64_tr_b16 v[54:55], v7 offset:1536
  ds_read_b64_tr_b16 v[56:57], v7 offset:2048
  ds_read_b64_tr_b16 v[58:59], v7 offset:2560
  ds_read_b64_tr_b16 v[60:61], v7 offset:3072
  ds_read_b64_tr_b16 v[62:63], v7 offset:3584
  s_waitcnt lgkmcnt(6)
  v_mfma_f32_16x16x32_bf16 v[24:27], v[32:35], v[48:51], 0
  v_mfma_f32_16x16x32_bf16 v[28:31], v[80:83], v[48:51], 0
  s_waitcnt lgkmcnt(4)
  v_mfma_f32_16x16x32_bf16 v[24:27], v[36:39], v[52:55], v[24:27]
  v_mfma_f32_16x16x32_bf16 v[28:31], v[84:87], v[52:55], v[28:31]
  s_waitcnt lgkmcnt(2)
  v_mfma_f32_16x16x32_bf16 v[24:27], v[40:43], v[56:59], v[24:27]
  buffer_load_dwordx4 v[96:99], v10, s[8:11], s44 offen offset:0 sc1
  v_mfma_f32_16x16x32_bf16 v[28:31], v[88:91], v[56:59], v[28:31]
  s_waitcnt lgkmcnt(0)
  v_mfma_f32_16x16x32_bf16 v[24:27], v[44:47], v[60:63], v[24:27]
  buffer_load_dwordx4 v[100:103], v13, s[8:11], s44 offen offset:0 sc1
  v_mfma_f32_16x16x32_bf16 v[28:31], v[92:95], v[60:63], v[28:31]
  v_mfma_f32_16x16x32_bf16 v[16:19], v[48:51], v[48:51], v[16:19]
  ds_read_b64_tr_b16 v[64:65], v9 offset:0
  ds_read_b64_tr_b16 v[66:67], v9 offset:4096
  v_mfma_f32_16x16x32_bf16 v[16:19], v[52:55], v[52:55], v[16:19]
  ds_read_b64_tr_b16 v[68:69], v9 offset:8
  ds_read_b64_tr_b16 v[70:71], v9 offset:4104
  v_mfma_f32_16x16x32_bf16 v[16:19], v[56:59], v[56:59], v[16:19]
  ds_read_b64_tr_b16 v[72:73], v3 offset:0
  ds_read_b64_tr_b16 v[74:75], v3 offset:4096
  v_mfma_f32_16x16x32_bf16 v[16:19], v[60:63], v[60:63], v[16:19]
  ds_read_b64_tr_b16 v[76:77], v3 offset:8
  ds_read_b64_tr_b16 v[78:79], v3 offset:4104
  v_mov_b32 v15, 0
  v_max3_f32 v20, v24, v25, v26
  v_max3_f32 v21, v27, v28, v29
  v_max3_f32 v20, v20, v30, v31
  s_cmp_eq_u32 s31, 63
  s_cbranch_scc1 CP1_last
  v_max3_f32 v21, v21, v16, v17
  v_max3_f32 v20, v20, v18, v19
  v_max_f32 v20, v20, v21
  v_mov_b32 v21, v20
  s_nop 1
  v_permlane32_swap_b32 v20, v21
  v_max_f32 v20, v20, v21
  v_mov_b32 v21, v20
  s_nop 1
  v_permlane16_swap_b32 v20, v21
  v_max_f32 v20, v20, v21
  v_pk_add_f32 v[24:25], v[24:25], v[20:21] op_sel_hi:[1,0] neg_lo:[0,1] neg_hi:[0,1]
  v_pk_add_f32 v[26:27], v[26:27], v[20:21] op_sel_hi:[1,0] neg_lo:[0,1] neg_hi:[0,1]
  v_pk_add_f32 v[28:29], v[28:29], v[20:21] op_sel_hi:[1,0] neg_lo:[0,1] neg_hi:[0,1]
  v_pk_add_f32 v[30:31], v[30:31], v[20:21] op_sel_hi:[1,0] neg_lo:[0,1] neg_hi:[0,1]
  v_pk_add_f32 v[16:17], v[16:17], v[20:21] op_sel_hi:[1,0] neg_lo:[0,1] neg_hi:[0,1]
  v_pk_add_f32 v[18:19], v[18:19], v[20:21] op_sel_hi:[1,0] neg_lo:[0,1] neg_hi:[0,1]
  v_pk_mul_f32 v[24:25], v[24:25], s[100:101]
  v_pk_mul_f32 v[26:27], v[26:27], s[100:101]
  v_pk_mul_f32 v[28:29], v[28:29], s[100:101]
  v_pk_mul_f32 v[30:31], v[30:31], s[100:101]
  v_pk_mul_f32 v[16:17], v[16:17], s[100:101]
  v_pk_mul_f32 v[18:19], v[18:19], s[100:101]
  v_exp_f32 v24, v24
  v_exp_f32 v25, v25
  v_exp_f32 v26, v26
  v_exp_f32 v27, v27
  v_exp_f32 v28, v28
  v_exp_f32 v29, v29
  v_exp_f32 v30, v30
  v_exp_f32 v31, v31
  v_exp_f32 v16, v16
  v_exp_f32 v17, v17
  v_exp_f32 v18, v18
  v_exp_f32 v19, v19
  s_waitcnt lgkmcnt(4)
  s_waitcnt vmcnt(0)
Pvm_33:
  v_max3_u32 v14, v96, v97, v98
  v_max3_u32 v15, v99, v100, v101
  v_max3_u32 v14, v14, v102, v103
  v_max_u32 v14, v14, v15
  v_cmp_eq_u32 vcc, 0xffbfffbf, v14
  s_cbranch_vccnz Pvm_33_re
  v_pk_add_f32 v[20:21], v[24:25], v[26:27]
  v_pk_add_f32 v[22:23], v[28:29], v[30:31]
  v_cvt_pk_bf16_f32 v24, v24, v25
  v_cvt_pk_bf16_f32 v25, v26, v27
  v_cvt_pk_bf16_f32 v26, v28, v29
  v_cvt_pk_bf16_f32 v27, v30, v31
  v_pk_add_f32 v[20:21], v[20:21], v[16:17]
  v_pk_add_f32 v[22:23], v[22:23], v[18:19]
  v_cvt_pk_bf16_f32 v16, v16, v17
  v_cvt_pk_bf16_f32 v17, v18, v19
  v_mfma_f32_16x16x32_bf16 v[104:107], v[64:67], v[24:27], 0
  s_mov_b64 exec, s[20:21]
  buffer_store_dword v1, off, s[8:11], s55
  s_mov_b64 exec, -1
  v_pk_add_f32 v[20:21], v[20:21], v[22:23]
  v_mfma_f32_16x16x32_bf16 v[108:111], v[68:71], v[24:27], 0
  v_add_f32 v20, v20, v21
  v_mfma_f32_16x16x16_bf16 v[104:107], v[96:97], v[16:17], v[104:107]
  v_mfma_f32_16x16x16_bf16 v[108:111], v[98:99], v[16:17], v[108:111]
  v_mov_b32 v21, v20
  s_nop 1
  v_permlane32_swap_b32 v20, v21
  v_add_f32 v20, v20, v21
  v_mov_b32 v21, v20
  s_nop 1
  v_permlane16_swap_b32 v20, v21
  v_add_f32 v20, v20, v21
  v_rcp_f32 v20, v20
  s_nop 0
  v_pk_mul_f32 v[104:105], v[104:105], v[20:21] op_sel_hi:[1,0]
  v_pk_mul_f32 v[106:107], v[106:107], v[20:21] op_sel_hi:[1,0]
  v_pk_mul_f32 v[108:109], v[108:109], v[20:21] op_sel_hi:[1,0]
  v_pk_mul_f32 v[110:111], v[110:111], v[20:21] op_sel_hi:[1,0]
  v_cvt_pk_bf16_f32 v104, v104, v105
  v_cvt_pk_bf16_f32 v105, v106, v107
  v_cvt_pk_bf16_f32 v106, v108, v109
  v_cvt_pk_bf16_f32 v107, v110, v111
  s_mov_b32 exec_lo, 0x00ff00ff
  s_mov_b32 exec_hi, 0x00ff00ff
  buffer_store_dwordx4 v[104:107], v11, s[8:11], s54 offen
  s_waitcnt lgkmcnt(0)
  s_barrier
  s_mov_b64 exec, -1
  buffer_load_dwordx4 v[112:115], v0, s[8:11], s24 offen offset:0 sc1
  buffer_load_dwordx4 v[116:119], v0, s[8:11], s24 offen offset:1024 sc1
  buffer_load_dwordx4 v[120:123], v0, s[8:11], s24 offen offset:2048 sc1
  buffer_load_dwordx4 v[124:127], v0, s[8:11], s24 offen offset:3072 sc1
  s_mov_b32 exec_lo, 0x00ff00ff
  s_mov_b32 exec_hi, 0x00ff00ff
  v_mov_b32 v108, 0xffbfffbf
  v_mov_b32 v109, 0xffbfffbf
  v_mov_b32 v110, 0xffbfffbf
  v_mov_b32 v111, 0xffbfffbf
  s_add_u32 s3, s25, s50
  s_add_u32 s3, s3, 98304
  s_add_u32 s4, s25, s53
  buffer_store_dwordx4 v[108:111], v11, s[8:11], s3 offen
  s_mov_b64 exec, s[20:21]
  buffer_store_dword v108, off, s[8:11], s4
  s_mov_b64 exec, -1
  s_cmp_lg_u32 s31, s23
  s_cbranch_scc1 CP1_ns
  s_add_u32 s23, s23, 4
  s_lshr_b32 s3, s31, 2
  v_mov_b32 v15, s3
  s_lshl_b32 s3, s30, 7
  s_add_u32 s3, s3, 99618816
  s_mov_b64 exec, 1
  buffer_store_dword v15, off, s[8:11], s3 sc1
  s_mov_b64 exec, -1
CP1_ns:
  v_readfirstlane_b32 s3, v12
  s_nop 0
  s_cmp_ge_u32 s3, 96
  s_cbranch_scc1 CP1_rdy
  s_add_u32 s7, s31, 1
  s_lshr_b32 s7, s7, 2
  s_lshl_b32 s7, s7, 7
  s_add_u32 s7, s7, 99614720
  s_mov_b32 s4, 0
Wkv_34:
  buffer_load_dword v18, off, s[8:11], s7 offset:0 sc1
  s_add_u32 s4, s4, 1
  s_cmp_gt_u32 s4, 65536
  s_cbranch_scc1 L_abort
  s_waitcnt vmcnt(0)
  v_readfirstlane_b32 s3, v18
  s_cmp_ge_u32 s3, 96
  s_cbranch_scc1 Wkv_34_ok
  s_sleep 8
  s_branch Wkv_34
Wkv_34_ok:
CP1_rdy:
  v_mov_b32 v16, v4
  v_mov_b32 v17, v4
  v_mov_b32 v18, v4
  v_mov_b32 v19, v4
  v_mov_b32 v22, 0xff800000
  v_cndmask_b32 v24, v22, 0, s[68:69]
  v_cndmask_b32 v25, v22, 0, s[70:71]
  v_cndmask_b32 v26, v22, 0, s[72:73]
  v_cndmask_b32 v27, v22, 0, s[74:75]
  v_cndmask_b32 v28, v22, 0, s[76:77]
  v_cndmask_b32 v29, v22, 0, s[78:79]
  v_cndmask_b32 v30, v22, 0, s[80:81]
  v_cndmask_b32 v31, v22, 0, s[82:83]
  s_waitcnt vmcnt(2)
  s_nop 0
  v_mfma_f32_16x16x32_bf16 v[24:27], v[32:35], v[112:115], v[24:27]
  s_mov_b32 m0, s46
  s_add_u32 s5, s35, s41
  s_add_u32 s5, s5, 32768
  s_lshl_b32 s4, s28, 7
  v_lshrrev_b32 v15, 1, v0
  v_and_b32 v15, s4, v15
  v_xor_b32 v15, v15, v0
  v_mfma_f32_16x16x32_bf16 v[28:31], v[80:83], v[112:115], v[28:31]
  buffer_load_dwordx4 v15, s[8:11], s5 offen offset:0 sc1 lds
  v_mfma_f32_16x16x32_bf16 v[24:27], v[36:39], v[116:119], v[24:27]
  buffer_load_dwordx4 v15, s[8:11], s5 offen offset:1024 sc1 lds
  v_mfma_f32_16x16x32_bf16 v[28:31], v[84:87], v[116:119], v[28:31]
  buffer_load_dwordx4 v15, s[8:11], s5 offen offset:2048 sc1 lds
  v_mfma_f32_16x16x32_bf16 v[24:27], v[40:43], v[120:123], v[24:27]
  buffer_load_dwordx4 v15, s[8:11], s5 offen offset:3072 sc1 lds
  v_mfma_f32_16x16x32_bf16 v[28:31], v[88:91], v[120:123], v[28:31]
  s_lshr_b32 s5, s41, 1
  s_add_u32 s5, s5, s35
  s_add_u32 s5, s5, 24576
  v_lshlrev_b32 v15, 3, v0
  v_mfma_f32_16x16x32_bf16 v[24:27], v[44:47], v[124:127], v[24:27]
  s_mov_b64 exec, 0xffff
  buffer_load_dword v14, v15, s[8:11], s5 offen sc1
  s_mov_b64 exec, -1
  v_mfma_f32_16x16x32_bf16 v[28:31], v[92:95], v[124:127], v[28:31]
  s_add_u32 s5, s31, 2
  s_lshr_b32 s5, s5, 2
  s_lshl_b32 s5, s5, 7
  s_add_u32 s5, s5, 99614720
  v_mfma_f32_16x16x32_bf16 v[16:19], v[48:51], v[112:115], v[16:19]
  buffer_load_dword v12, off, s[8:11], s5 sc1
  v_mfma_f32_16x16x32_bf16 v[16:19], v[52:55], v[116:119], v[16:19]
  v_mfma_f32_16x16x32_bf16 v[16:19], v[56:59], v[120:123], v[16:19]
  v_mfma_f32_16x16x32_bf16 v[16:19], v[60:63], v[124:127], v[16:19]
  s_branch CP1_x
CP1_last:
  s_waitcnt vmcnt(0)
Pvm_35:
  v_max3_u32 v14, v96, v97, v98
  v_max3_u32 v15, v99, v100, v101
  v_max3_u32 v14, v14, v102, v103
  v_max_u32 v14, v14, v15
  v_cmp_eq_u32 vcc, 0xffbfffbf, v14
  s_cbranch_vccnz Pvm_35_re
  s_barrier
  buffer_load_dwordx4 v[112:115], v0, s[8:11], s24 offen offset:0 sc1
  buffer_load_dwordx4 v[116:119], v0, s[8:11], s24 offen offset:1024 sc1
  buffer_load_dwordx4 v[120:123], v0, s[8:11], s24 offen offset:2048 sc1
  buffer_load_dwordx4 v[124:127], v0, s[8:11], s24 offen offset:3072 sc1
  s_waitcnt lgkmcnt(0)
  v_mov_b32 v16, v4
  v_mov_b32 v17, v4
  v_mov_b32 v18, v4
  v_mov_b32 v19, v4
  v_mov_b32 v22, 0xff800000
  v_cndmask_b32 v24, v22, 0, s[68:69]
  v_cndmask_b32 v25, v22, 0, s[70:71]
  v_cndmask_b32 v26, v22, 0, s[72:73]
  v_cndmask_b32 v27, v22, 0, s[74:75]
  v_cndmask_b32 v28, v22, 0, s[76:77]
  v_cndmask_b32 v29, v22, 0, s[78:79]
  v_cndmask_b32 v30, v22, 0, s[80:81]
  v_cndmask_b32 v31, v22, 0, s[82:83]
  s_waitcnt vmcnt(0)
  s_nop 0
  v_mfma_f32_16x16x32_bf16 v[24:27], v[32:35], v[112:115], v[24:27]
  v_mfma_f32_16x16x32_bf16 v[28:31], v[80:83], v[112:115], v[28:31]
  v_mfma_f32_16x16x32_bf16 v[24:27], v[36:39], v[116:119], v[24:27]
  v_mfma_f32_16x16x32_bf16 v[28:31], v[84:87], v[116:119], v[28:31]
  v_mfma_f32_16x16x32_bf16 v[24:27], v[40:43], v[120:123], v[24:27]
  v_mfma_f32_16x16x32_bf16 v[28:31], v[88:91], v[120:123], v[28:31]
  v_mfma_f32_16x16x32_bf16 v[24:27], v[44:47], v[124:127], v[24:27]
  v_mfma_f32_16x16x32_bf16 v[28:31], v[92:95], v[124:127], v[28:31]
  v_mfma_f32_16x16x32_bf16 v[16:19], v[48:51], v[112:115], v[16:19]
  v_mfma_f32_16x16x32_bf16 v[16:19], v[52:55], v[116:119], v[16:19]
  v_mfma_f32_16x16x32_bf16 v[16:19], v[56:59], v[120:123], v[16:19]
  v_mfma_f32_16x16x32_bf16 v[16:19], v[60:63], v[124:127], v[16:19]
CP1_x:
  v_mov_b32 v15, 0
  v_mov_b32 v15, 0
  v_mov_b32 v15, 0
  v_mov_b32 v15, 0
  v_mov_b32 v15, 0
  v_max3_f32 v20, v24, v25, v26
  v_max3_f32 v21, v27, v28, v29
  v_max3_f32 v20, v20, v30, v31
  v_max3_f32 v21, v21, v16, v17
  v_max3_f32 v20, v20, v18, v19
  v_max_f32 v20, v20, v21
  v_mov_b32 v21, v20
  s_nop 1
  v_permlane32_swap_b32 v20, v21
  v_max_f32 v20, v20, v21
  v_mov_b32 v21, v20
  s_nop 1
  v_permlane16_swap_b32 v20, v21
  v_max_f32 v20, v20, v21
  v_pk_add_f32 v[24:25], v[24:25], v[20:21] op_sel_hi:[1,0] neg_lo:[0,1] neg_hi:[0,1]
  v_pk_add_f32 v[26:27], v[26:27], v[20:21] op_sel_hi:[1,0] neg_lo:[0,1] neg_hi:[0,1]
  v_pk_add_f32 v[28:29], v[28:29], v[20:21] op_sel_hi:[1,0] neg_lo:[0,1] neg_hi:[0,1]
  v_pk_add_f32 v[30:31], v[30:31], v[20:21] op_sel_hi:[1,0] neg_lo:[0,1] neg_hi:[0,1]
  v_pk_add_f32 v[16:17], v[16:17], v[20:21] op_sel_hi:[1,0] neg_lo:[0,1] neg_hi:[0,1]
  v_pk_add_f32 v[18:19], v[18:19], v[20:21] op_sel_hi:[1,0] neg_lo:[0,1] neg_hi:[0,1]
  v_pk_mul_f32 v[24:25], v[24:25], s[100:101]
  v_pk_mul_f32 v[26:27], v[26:27], s[100:101]
  v_pk_mul_f32 v[28:29], v[28:29], s[100:101]
  v_pk_mul_f32 v[30:31], v[30:31], s[100:101]
  v_pk_mul_f32 v[16:17], v[16:17], s[100:101]
  v_pk_mul_f32 v[18:19], v[18:19], s[100:101]
  v_exp_f32 v24, v24
  v_exp_f32 v25, v25
  v_exp_f32 v26, v26
  v_exp_f32 v27, v27
  v_exp_f32 v28, v28
  v_exp_f32 v29, v29
  v_exp_f32 v30, v30
  v_exp_f32 v31, v31
  v_exp_f32 v16, v16
  v_exp_f32 v17, v17
  v_exp_f32 v18, v18
  v_exp_f32 v19, v19
  v_pk_add_f32 v[20:21], v[24:25], v[26:27]
  v_pk_add_f32 v[22:23], v[28:29], v[30:31]
  v_cvt_pk_bf16_f32 v24, v24, v25
  v_cvt_pk_bf16_f32 v25, v26, v27
  v_cvt_pk_bf16_f32 v26, v28, v29
  v_cvt_pk_bf16_f32 v27, v30, v31
  v_pk_add_f32 v[20:21], v[20:21], v[16:17]
  v_pk_add_f32 v[22:23], v[22:23], v[18:19]
  v_cvt_pk_bf16_f32 v16, v16, v17
  v_cvt_pk_bf16_f32 v17, v18, v19
  v_mfma_f32_16x16x32_bf16 v[32:35], v[64:67], v[24:27], 0
  v_pk_add_f32 v[20:21], v[20:21], v[22:23]
  v_mfma_f32_16x16x32_bf16 v[36:39], v[68:71], v[24:27], 0
  v_add_f32 v20, v20, v21
  v_mfma_f32_16x16x32_bf16 v[40:43], v[72:75], v[24:27], 0
  v_mfma_f32_16x16x32_bf16 v[44:47], v[76:79], v[24:27], 0
  v_mfma_f32_16x16x16_bf16 v[32:35], v[96:97], v[16:17], v[32:35]
  v_mfma_f32_16x16x16_bf16 v[36:39], v[98:99], v[16:17], v[36:39]
  v_mfma_f32_16x16x16_bf16 v[40:43], v[100:101], v[16:17], v[40:43]
  v_mfma_f32_16x16x16_bf16 v[44:47], v[102:103], v[16:17], v[44:47]
  v_mov_b32 v21, v20
  s_nop 1
  v_permlane32_swap_b32 v20, v21
  v_add_f32 v20, v20, v21
  v_mov_b32 v21, v20
  s_nop 1
  v_permlane16_swap_b32 v20, v21
  v_add_f32 v20, v20, v21
  v_rcp_f32 v20, v20
  s_nop 0
  v_pk_mul_f32 v[32:33], v[32:33], v[20:21] op_sel_hi:[1,0]
  v_pk_mul_f32 v[34:35], v[34:35], v[20:21] op_sel_hi:[1,0]
  v_pk_mul_f32 v[36:37], v[36:37], v[20:21] op_sel_hi:[1,0]
  v_pk_mul_f32 v[38:39], v[38:39], v[20:21] op_sel_hi:[1,0]
  v_pk_mul_f32 v[40:41], v[40:41], v[20:21] op_sel_hi:[1,0]
  v_pk_mul_f32 v[42:43], v[42:43], v[20:21] op_sel_hi:[1,0]
  v_pk_mul_f32 v[44:45], v[44:45], v[20:21] op_sel_hi:[1,0]
  v_pk_mul_f32 v[46:47], v[46:47], v[20:21] op_sel_hi:[1,0]
  v_cvt_pk_bf16_f32 v112, v32, v33
  v_cvt_pk_bf16_f32 v113, v34, v35
  v_cvt_pk_bf16_f32 v114, v36, v37
  v_cvt_pk_bf16_f32 v115, v38, v39
  v_cvt_pk_bf16_f32 v116, v40, v41
  v_cvt_pk_bf16_f32 v117, v42, v43
  v_cvt_pk_bf16_f32 v118, v44, v45
  v_cvt_pk_bf16_f32 v119, v46, v47
  s_add_u32 s38, s36, 69206016
  s_xor_b32 s39, s36, 131072
  s_add_u32 s39, s39, 69206016
  s_mov_b32 s18, s10
  s_add_u32 s36, s36, 2048
  s_add_u32 s31, s31, 1
  s_mov_b32 s25, s32
  s_mov_b32 s32, s26
  s_add_u32 s26, s26, 262144
  s_and_b32 s26, s26, 0xfffff
  s_or_b32 s26, s26, 85983232
  s_add_u32 s35, s35, 24576
  s_cmp_lt_u32 s31, 64
  s_cbranch_scc1 CP1_top
  buffer_store_dwordx4 v[112:115], v0, s[16:19], s38 offen sc1
  buffer_store_dwordx4 v[116:119], v0, s[16:19], s39 offen sc1
  s_waitcnt vmcnt(0)
  s_barrier
  s_cmp_lg_u32 s27, 0
  s_cbranch_scc1 L_exit
  s_lshl_b32 s3, s30, 7
  s_add_u32 s3, s3, 99618816
  v_mov_b32 v18, 16
  s_mov_b64 exec, 1
  buffer_store_dword v18, off, s[8:11], s3 sc1
  s_endpgm
Pa_32_re:
  s_add_u32 s40, s40, 1
  s_cmp_gt_u32 s40, 65536
  s_cbranch_scc1 L_abort
  s_mov_b64 exec, vcc
  buffer_load_dwordx4 v[96:99], v0, s[8:11], s42 offen offset:0 sc1
  buffer_load_dwordx4 v[100:103], v0, s[8:11], s42 offen offset:1024 sc1
  buffer_load_dwordx4 v[104:107], v0, s[8:11], s42 offen offset:2048 sc1
  buffer_load_dwordx4 v[108:111], v0, s[8:11], s42 offen offset:3072 sc1
  s_mov_b64 exec, -1
  s_waitcnt vmcnt(0)
  s_branch Pa_32
GA_31_re:
  s_add_u32 s40, s40, 1
  s_cmp_gt_u32 s40, 65536
  s_cbranch_scc1 L_abort
  s_mov_b64 exec, vcc
  buffer_load_dwordx4 v[48:51], v0, s[8:11], s43 offen offset:0 sc1
  buffer_load_dwordx4 v[52:55], v0, s[8:11], s43 offen offset:1024 sc1
  buffer_load_dwordx4 v[56:59], v0, s[8:11], s43 offen offset:2048 sc1
  buffer_load_dwordx4 v[60:63], v0, s[8:11], s43 offen offset:3072 sc1
  s_mov_b64 exec, -1
  s_branch GA_31_u
Pvm_33_re:
  s_add_u32 s40, s40, 1
  s_cmp_gt_u32 s40, 65536
  s_cbranch_scc1 L_abort
  s_mov_b64 exec, vcc
  buffer_load_dwordx4 v[96:99], v10, s[8:11], s44 offen offset:0 sc1
  buffer_load_dwordx4 v[100:103], v13, s[8:11], s44 offen offset:0 sc1
  s_mov_b64 exec, -1
  s_waitcnt vmcnt(0)
  s_branch Pvm_33
Pvm_35_re:
  s_add_u32 s40, s40, 1
  s_cmp_gt_u32 s40, 65536
  s_cbranch_scc1 L_abort
  s_mov_b64 exec, vcc
  buffer_load_dwordx4 v[96:99], v10, s[8:11], s44 offen offset:0 sc1
  buffer_load_dwordx4 v[100:103], v13, s[8:11], s44 offen offset:0 sc1
  s_mov_b64 exec, -1
  s_waitcnt vmcnt(0)
  s_branch Pvm_35
.p2align 6
CP0_top:
  s_mov_b32 s40, 0
  ds_read_b128 v[64:67], v2 offset:0
  ds_read_b128 v[68:71], v2 offset:16384
  ds_read_b128 v[72:75], v2 offset:1024
  ds_read_b128 v[76:79], v2 offset:17408
  v_mov_b64 v[16:17], 0
  v_mov_b64 v[18:19], 0
  v_mov_b64 v[20:21], 0
  v_mov_b64 v[22:23], 0
  v_mov_b64 v[24:25], 0
  v_mov_b64 v[26:27], 0
  v_mov_b64 v[28:29], 0
  v_mov_b64 v[30:31], 0
  v_add_u32 v4, 4096, v5
  v_and_b32 v4, 0x23fff, v4
  s_add_u32 s44, s32, s50
  s_add_u32 s54, s44, 98304
  s_add_u32 s44, s44, 163840
  s_add_u32 s55, s32, s53
  s_lshl_b32 s24, s29, 12
  s_add_u32 s24, s24, s35
  s_add_u32 s42, s32, s48
  s_add_u32 s43, s32, s49
  v_lshrrev_b32 v15, 2, v0
  s_add_u32 s3, s32, s22
  v_writelane_b32 v15, s45, 16
  s_cmp_lg_u32 s27, 3
  s_cbranch_scc1 Ql_36_w
  s_mov_b64 exec, 0x1ffff
  buffer_load_dword v14, v15, s[8:11], s3 offen sc1
  s_nop 15
  buffer_load_dword v32, v15, s[8:11], s3 offen sc1
  s_nop 15
  buffer_load_dword v33, v15, s[8:11], s3 offen sc1
  s_nop 15
Ql_36:
  buffer_load_dword v34, v15, s[8:11], s3 offen sc1
  s_waitcnt vmcnt(3)
  v_cmp_eq_u32 vcc, 0xffbfffbf, v14
  s_cbranch_vccz Ql_36_ok
  buffer_load_dword v14, v15, s[8:11], s3 offen sc1
  s_waitcnt vmcnt(3)
  v_cmp_eq_u32 vcc, 0xffbfffbf, v32
  s_cbranch_vccz Ql_36_ok
  buffer_load_dword v32, v15, s[8:11], s3 offen sc1
  s_waitcnt vmcnt(3)
  v_cmp_eq_u32 vcc, 0xffbfffbf, v33
  s_cbranch_vccz Ql_36_ok
  buffer_load_dword v33, v15, s[8:11], s3 offen sc1
  s_waitcnt vmcnt(3)
  v_cmp_eq_u32 vcc, 0xffbfffbf, v34
  s_cbranch_vccz Ql_36_ok
  s_add_u32 s40, s40, 1
  s_cmp_gt_u32 s40, 65536
  s_cbranch_scc1 L_abort
  s_branch Ql_36
Ql_36_ok:
  s_mov_b64 exec, -1
Ql_36_w:
  s_barrier
  s_nop 15
  buffer_load_dwordx4 v[96:99], v0, s[8:11], s42 offen offset:0 sc1
  buffer_load_dwordx4 v[100:103], v0, s[8:11], s42 offen offset:1024 sc1
  buffer_load_dwordx4 v[104:107], v0, s[8:11], s42 offen offset:2048 sc1
  buffer_load_dwordx4 v[108:111], v0, s[8:11], s42 offen offset:3072 sc1
  s_nop 15
  s_nop 15
  buffer_load_dwordx4 v[48:51], v0, s[8:11], s43 offen offset:0 sc1
  buffer_load_dwordx4 v[52:55], v0, s[8:11], s43 offen offset:1024 sc1
  buffer_load_dwordx4 v[56:59], v0, s[8:11], s43 offen offset:2048 sc1
  buffer_load_dwordx4 v[60:63], v0, s[8:11], s43 offen offset:3072 sc1
  s_waitcnt vmcnt(4)
Pa_38:
  v_max3_u32 v14, v96, v97, v98
  v_max3_u32 v15, v99, v100, v101
  v_max3_u32 v14, v14, v102, v103
  v_max3_u32 v15, v15, v104, v105
  v_max3_u32 v14, v14, v106, v107
  v_max3_u32 v15, v15, v108, v109
  v_max3_u32 v14, v14, v110, v111
  v_max_u32 v14, v14, v15
  v_cmp_eq_u32 vcc, 0xffbfffbf, v14
  s_cbranch_vccnz Pa_38_re
  v_lshlrev_b32 v80, 16, v96
  v_and_b32 v81, 0xffff0000, v96
  v_lshlrev_b32 v82, 16, v97
  v_and_b32 v83, 0xffff0000, v97
  v_lshlrev_b32 v84, 16, v98
  v_and_b32 v85, 0xffff0000, v98
  v_lshlrev_b32 v86, 16, v99
  v_and_b32 v87, 0xffff0000, v99
  v_lshlrev_b32 v88, 16, v100
  v_and_b32 v89, 0xffff0000, v100
  v_lshlrev_b32 v90, 16, v101
  v_and_b32 v91, 0xffff0000, v101
  v_lshlrev_b32 v92, 16, v102
  v_and_b32 v93, 0xffff0000, v102
  v_lshlrev_b32 v94, 16, v103
  v_and_b32 v95, 0xffff0000, v103
  v_lshlrev_b32 v96, 16, v104
  v_and_b32 v97, 0xffff0000, v104
  v_lshlrev_b32 v98, 16, v105
  v_and_b32 v99, 0xffff0000, v105
  v_lshlrev_b32 v100, 16, v106
  v_and_b32 v101, 0xffff0000, v106
  v_lshlrev_b32 v102, 16, v107
  v_and_b32 v103, 0xffff0000, v107
  v_lshlrev_b32 v104, 16, v108
  v_and_b32 v105, 0xffff0000, v108
  v_lshlrev_b32 v106, 16, v109
  v_and_b32 v107, 0xffff0000, v109
  v_lshlrev_b32 v108, 16, v110
  v_and_b32 v109, 0xffff0000, v110
  v_lshlrev_b32 v110, 16, v111
  v_and_b32 v111, 0xffff0000, v111
GA_37_u:
.p2align 3
  s_waitcnt vmcnt(3)
  s_nop 0
  v_dot2_f32_bf16 v120, v48, s51, v80
  v_dot2_f32_bf16 v121, v48, s52, v81
  v_dot2_f32_bf16 v122, v49, s51, v82
  v_dot2_f32_bf16 v123, v49, s52, v83
  v_dot2_f32_bf16 v124, v50, s51, v84
  v_dot2_f32_bf16 v125, v50, s52, v85
  v_dot2_f32_bf16 v126, v51, s51, v86
  v_dot2_f32_bf16 v127, v51, s52, v87
  v_max3_u32 v14, v48, v49, v49
  v_max3_u32 v14, v50, v51, v14
  v_cvt_pk_bf16_f32 v32, v120, v121
  v_cvt_pk_bf16_f32 v33, v122, v123
  v_cvt_pk_bf16_f32 v34, v124, v125
  v_cvt_pk_bf16_f32 v35, v126, v127
  ds_write_b128 v5, v[32:35] offset:0
  s_waitcnt vmcnt(2)
  s_nop 0
  v_dot2_f32_bf16 v120, v52, s51, v88
  v_dot2_f32_bf16 v121, v52, s52, v89
  v_dot2_f32_bf16 v122, v53, s51, v90
  v_dot2_f32_bf16 v123, v53, s52, v91
  v_dot2_f32_bf16 v124, v54, s51, v92
  v_dot2_f32_bf16 v125, v54, s52, v93
  v_dot2_f32_bf16 v126, v55, s51, v94
  v_dot2_f32_bf16 v127, v55, s52, v95
  v_max3_u32 v14, v52, v53, v14
  v_max3_u32 v14, v54, v55, v14
  v_cvt_pk_bf16_f32 v36, v120, v121
  v_cvt_pk_bf16_f32 v37, v122, v123
  v_cvt_pk_bf16_f32 v38, v124, v125
  v_cvt_pk_bf16_f32 v39, v126, v127
  ds_write_b128 v5, v[36:39] offset:1024
  s_waitcnt vmcnt(1)
  s_nop 0
  v_dot2_f32_bf16 v120, v56, s51, v96
  v_dot2_f32_bf16 v121, v56, s52, v97
  v_dot2_f32_bf16 v122, v57, s51, v98
  v_dot2_f32_bf16 v123, v57, s52, v99
  v_dot2_f32_bf16 v124, v58, s51, v100
  v_dot2_f32_bf16 v125, v58, s52, v101
  v_dot2_f32_bf16 v126, v59, s51, v102
  v_dot2_f32_bf16 v127, v59, s52, v103
  v_max3_u32 v14, v56, v57, v14
  v_max3_u32 v14, v58, v59, v14
  v_cvt_pk_bf16_f32 v40, v120, v121
  v_cvt_pk_bf16_f32 v41, v122, v123
  v_cvt_pk_bf16_f32 v42, v124, v125
  v_cvt_pk_bf16_f32 v43, v126, v127
  ds_write_b128 v5, v[40:43] offset:2048
  s_waitcnt vmcnt(0)
  s_nop 0
  v_dot2_f32_bf16 v120, v60, s51, v104
  v_dot2_f32_bf16 v121, v60, s52, v105
  v_dot2_f32_bf16 v122, v61, s51, v106
  v_dot2_f32_bf16 v123, v61, s52, v107
  v_dot2_f32_bf16 v124, v62, s51, v108
  v_dot2_f32_bf16 v125, v62, s52, v109
  v_dot2_f32_bf16 v126, v63, s51, v110
  v_dot2_f32_bf16 v127, v63, s52, v111
  v_max3_u32 v14, v60, v61, v14
  v_max3_u32 v14, v62, v63, v14
  v_cmp_eq_u32 vcc, 0xffbfffbf, v14
  v_cvt_pk_bf16_f32 v44, v120, v121
  v_cvt_pk_bf16_f32 v45, v122, v123
  v_cvt_pk_bf16_f32 v46, v124, v125
  v_cvt_pk_bf16_f32 v47, v126, v127
  ds_write_b128 v5, v[44:47] offset:3072
  s_cbranch_vccnz GA_37_re
  v_smfmac_f32_16x16x64_bf16 v[16:19], v[32:35], a[0:7], v1
  buffer_store_dwordx4 v[112:115], v0, s[16:19], s38 offen sc1
  v_smfmac_f32_16x16x64_bf16 v[16:19], v[36:39], a[32:39], v1
  buffer_store_dwordx4 v[116:119], v0, s[16:19], s39 offen sc1
  v_smfmac_f32_16x16x64_bf16 v[16:19], v[40:43], a[64:71], v1
  s_waitcnt lgkmcnt(0)
  s_barrier
  ds_read_b128 v[48:51], v4 offset:0
  ds_read_b128 v[52:55], v4 offset:1024
  v_smfmac_f32_16x16x64_bf16 v[16:19], v[44:47], v[64:71], v1
  ds_read_b128 v[64:67], v2 offset:2048
  v_smfmac_f32_16x16x64_bf16 v[20:23], v[32:35], a[8:15], v1
  ds_read_b128 v[68:71], v2 offset:18432
  v_smfmac_f32_16x16x64_bf16 v[20:23], v[36:39], a[40:47], v1
  ds_read_b128 v[56:59], v4 offset:2048
  v_smfmac_f32_16x16x64_bf16 v[20:23], v[40:43], a[72:79], v1
  ds_read_b128 v[60:63], v4 offset:3072
  v_smfmac_f32_16x16x64_bf16 v[20:23], v[44:47], v[72:79], v1
  ds_read_b128 v[72:75], v2 offset:3072
  v_smfmac_f32_16x16x64_bf16 v[24:27], v[32:35], a[16:23], v1
  ds_read_b128 v[76:79], v2 offset:19456
  v_smfmac_f32_16x16x64_bf16 v[24:27], v[36:39], a[48:55], v1
  v_add_u32 v4, 4096, v4
  v_smfmac_f32_16x16x64_bf16 v[24:27], v[40:43], a[80:87], v1
  v_and_b32 v4, 0x23fff, v4
  s_waitcnt lgkmcnt(4)
  v_smfmac_f32_16x16x64_bf16 v[24:27], v[44:47], v[64:71], v1
  ds_read_b128 v[64:67], v2 offset:4096
  v_smfmac_f32_16x16x64_bf16 v[28:31], v[32:35], a[24:31], v1
  ds_read_b128 v[68:71], v2 offset:20480
  v_smfmac_f32_16x16x64_bf16 v[28:31], v[36:39], a[56:63], v1
  ds_read_b128 v[80:83], v8 offset:4096
  v_smfmac_f32_16x16x64_bf16 v[28:31], v[40:43], a[88:95], v1
  ds_read_b128 v[84:87], v8 offset:5120
  s_waitcnt lgkmcnt(4)
  v_smfmac_f32_16x16x64_bf16 v[28:31], v[44:47], v[72:79], v1
  ds_read_b128 v[72:75], v2 offset:5120
  v_smfmac_f32_16x16x64_bf16 v[16:19], v[48:51], a[96:103], v1
  ds_read_b128 v[76:79], v2 offset:21504
  v_smfmac_f32_16x16x64_bf16 v[16:19], v[52:55], a[128:135], v1
  ds_read_b128 v[32:35], v4 offset:0
  v_smfmac_f32_16x16x64_bf16 v[16:19], v[56:59], a[160:167], v1
  ds_read_b128 v[36:39], v4 offset:1024
  s_waitcnt lgkmcnt(6)
  v_smfmac_f32_16x16x64_bf16 v[16:19], v[60:63], v[64:71], v1
  ds_read_b128 v[64:67], v2 offset:6144
  v_smfmac_f32_16x16x64_bf16 v[20:23], v[48:51], a[104:111], v1
  ds_read_b128 v[68:71], v2 offset:22528
  v_smfmac_f32_16x16x64_bf16 v[20:23], v[52:55], a[136:143], v1
  ds_read_b128 v[40:43], v4 offset:2048
  v_smfmac_f32_16x16x64_bf16 v[20:23], v[56:59], a[168:175], v1
  ds_read_b128 v[44:47], v4 offset:3072
  s_waitcnt lgkmcnt(6)
  v_smfmac_f32_16x16x64_bf16 v[20:23], v[60:63], v[72:79], v1
  ds_read_b128 v[72:75], v2 offset:7168
  v_smfmac_f32_16x16x64_bf16 v[24:27], v[48:51], a[112:119], v1
  ds_read_b128 v[76:79], v2 offset:23552
  v_smfmac_f32_16x16x64_bf16 v[24:27], v[52:55], a[144:151], v1
  v_add_u32 v4, 4096, v4
  v_smfmac_f32_16x16x64_bf16 v[24:27], v[56:59], a[176:183], v1
  v_and_b32 v4, 0x23fff, v4
  s_waitcnt lgkmcnt(4)
  v_smfmac_f32_16x16x64_bf16 v[24:27], v[60:63], v[64:71], v1
  ds_read_b128 v[64:67], v2 offset:8192
  v_smfmac_f32_16x16x64_bf16 v[28:31], v[48:51], a[120:127], v1
  ds_read_b128 v[68:71], v2 offset:24576
  v_smfmac_f32_16x16x64_bf16 v[28:31], v[52:55], a[152:159], v1
  ds_read_b128 v[88:91], v8 offset:6144
  v_smfmac_f32_16x16x64_bf16 v[28:31], v[56:59], a[184:191], v1
  ds_read_b128 v[92:95], v8 offset:7168
  s_waitcnt lgkmcnt(4)
  v_smfmac_f32_16x16x64_bf16 v[28:31], v[60:63], v[72:79], v1
  ds_read_b128 v[72:75], v2 offset:9216
  v_smfmac_f32_16x16x64_bf16 v[16:19], v[32:35], a[192:199], v1
  ds_read_b128 v[76:79], v2 offset:25600
  v_smfmac_f32_16x16x64_bf16 v[16:19], v[36:39], a[224:231], v1
  ds_read_b128 v[48:51], v4 offset:0
  v_smfmac_f32_16x16x64_bf16 v[16:19], v[40:43], v[128:135], v1
  ds_read_b128 v[52:55], v4 offset:1024
  s_waitcnt lgkmcnt(6)
  v_smfmac_f32_16x16x64_bf16 v[16:19], v[44:47], v[64:71], v1
  ds_read_b128 v[64:67], v2 offset:10240
  v_smfmac_f32_16x16x64_bf16 v[20:23], v[32:35], a[200:207], v1
  ds_read_b128 v[68:71], v2 offset:26624
  v_smfmac_f32_16x16x64_bf16 v[20:23], v[36:39], a[232:239], v1
  ds_read_b128 v[56:59], v4 offset:2048
  v_smfmac_f32_16x16x64_bf16 v[20:23], v[40:43], v[136:143], v1
  ds_read_b128 v[60:63], v4 offset:3072
  s_waitcnt lgkmcnt(6)
  v_smfmac_f32_16x16x64_bf16 v[20:23], v[44:47], v[72:79], v1
  ds_read_b128 v[72:75], v2 offset:11264
  v_smfmac_f32_16x16x64_bf16 v[24:27], v[32:35], a[208:215], v1
  ds_read_b128 v[76:79], v2 offset:27648
  v_smfmac_f32_16x16x64_bf16 v[24:27], v[36:39], a[240:247], v1
  v_lshlrev_b32 v4, 22, v0
  v_smfmac_f32_16x16x64_bf16 v[24:27], v[40:43], v[144:151], v1
  v_ashrrev_i32 v4, 8, v4
  s_waitcnt lgkmcnt(4)
  v_smfmac_f32_16x16x64_bf16 v[24:27], v[44:47], v[64:71], v1
  ds_read_b128 v[64:67], v2 offset:12288
  v_smfmac_f32_16x16x64_bf16 v[28:31], v[32:35], a[216:223], v1
  ds_read_b128 v[68:71], v2 offset:28672
  v_smfmac_f32_16x16x64_bf16 v[28:31], v[36:39], a[248:255], v1
  v_xor_b32 v4, -1, v4
  v_smfmac_f32_16x16x64_bf16 v[28:31], v[40:43], v[152:159], v1
  v_and_b32 v4, 0xff800000, v4
  s_waitcnt lgkmcnt(2)
  v_smfmac_f32_16x16x64_bf16 v[28:31], v[44:47], v[72:79], v1
  ds_read_b128 v[72:75], v2 offset:13312
  s_barrier
  v_smfmac_f32_16x16x64_bf16 v[16:19], v[48:51], v[160:167], v1
  ds_read_b128 v[76:79], v2 offset:29696
  v_smfmac_f32_16x16x64_bf16 v[16:19], v[52:55], v[192:199], v1
  ds_read_b128 v[32:35], v8 offset:0
  v_smfmac_f32_16x16x64_bf16 v[16:19], v[56:59], v[224:231], v1
  ds_read_b128 v[36:39], v8 offset:1024
  s_waitcnt lgkmcnt(4)
  v_smfmac_f32_16x16x64_bf16 v[16:19], v[60:63], v[64:71], v1
  ds_read_b128 v[64:67], v2 offset:14336
  v_smfmac_f32_16x16x64_bf16 v[20:23], v[48:51], v[168:175], v1
  ds_read_b128 v[68:71], v2 offset:30720
  v_smfmac_f32_16x16x64_bf16 v[20:23], v[52:55], v[200:207], v1
  ds_read_b128 v[40:43], v8 offset:2048
  v_smfmac_f32_16x16x64_bf16 v[20:23], v[56:59], v[232:239], v1
  ds_read_b128 v[44:47], v8 offset:3072
  s_waitcnt lgkmcnt(6)
  v_smfmac_f32_16x16x64_bf16 v[20:23], v[60:63], v[72:79], v1
  ds_read_b128 v[72:75], v2 offset:15360
  v_smfmac_f32_16x16x64_bf16 v[24:27], v[48:51], v[176:183], v1
  ds_read_b128 v[76:79], v2 offset:31744
  v_smfmac_f32_16x16x64_bf16 v[24:27], v[52:55], v[208:215], v1
  v_smfmac_f32_16x16x64_bf16 v[24:27], v[56:59], v[240:247], v1
  s_nop 1
  s_waitcnt lgkmcnt(4)
  v_smfmac_f32_16x16x64_bf16 v[24:27], v[60:63], v[64:71], v1
  v_permlane32_swap_b32 v16, v20
  v_smfmac_f32_16x16x64_bf16 v[28:31], v[48:51], v[184:191], v1
  v_permlane32_swap_b32 v17, v21
  v_smfmac_f32_16x16x64_bf16 v[28:31], v[52:55], v[216:223], v1
  v_permlane32_swap_b32 v18, v22
  v_smfmac_f32_16x16x64_bf16 v[28:31], v[56:59], v[248:255], v1
  v_permlane32_swap_b32 v19, v23
  s_waitcnt lgkmcnt(0)
  v_smfmac_f32_16x16x64_bf16 v[28:31], v[60:63], v[72:79], v1
  v_pk_add_f32 v[16:17], v[16:17], v[20:21]
  v_pk_add_f32 v[18:19], v[18:19], v[22:23]
  v_cvt_pk_bf16_f32 v20, v16, v17
  v_cvt_pk_bf16_f32 v21, v18, v19
  ds_write_b64 v6, v[20:21] offset:0
  v_mov_b32 v16, v4
  v_mov_b32 v17, v4
  v_mov_b32 v18, v4
  v_mov_b32 v19, v4
  v_permlane32_swap_b32 v24, v28
  v_permlane32_swap_b32 v25, v29
  v_permlane32_swap_b32 v26, v30
  v_permlane32_swap_b32 v27, v31
  v_pk_add_f32 v[24:25], v[24:25], v[28:29]
  v_pk_add_f32 v[26:27], v[26:27], v[30:31]
  v_cvt_pk_bf16_f32 v22, v24, v25
  v_cvt_pk_bf16_f32 v23, v26, v27
  ds_write_b64 v6, v[22:23] offset:16
  s_waitcnt lgkmcnt(0)
  s_barrier
  ds_read_b64_tr_b16 v[48:49], v7 offset:0
  ds_read_b64_tr_b16 v[50:51], v7 offset:512
  ds_read_b64_tr_b16 v[52:53], v7 offset:1024
  ds_read_b64_tr_b16 v[54:55], v7 offset:1536
  ds_read_b64_tr_b16 v[56:57], v7 offset:2048
  ds_read_b64_tr_b16 v[58:59], v7 offset:2560
  ds_read_b64_tr_b16 v[60:61], v7 offset:3072
  ds_read_b64_tr_b16 v[62:63], v7 offset:3584
  s_waitcnt lgkmcnt(6)
  v_mfma_f32_16x16x32_bf16 v[24:27], v[32:35], v[48:51], 0
  v_mfma_f32_16x16x32_bf16 v[28:31], v[80:83], v[48:51], 0
  s_waitcnt lgkmcnt(4)
  v_mfma_f32_16x16x32_bf16 v[24:27], v[36:39], v[52:55], v[24:27]
  v_mfma_f32_16x16x32_bf16 v[28:31], v[84:87], v[52:55], v[28:31]
  s_waitcnt lgkmcnt(2)
  v_mfma_f32_16x16x32_bf16 v[24:27], v[40:43], v[56:59], v[24:27]
  buffer_load_dwordx4 v[96:99], v10, s[8:11], s44 offen offset:0 sc1
  v_mfma_f32_16x16x32_bf16 v[28:31], v[88:91], v[56:59], v[28:31]
  s_waitcnt lgkmcnt(0)
  v_mfma_f32_16x16x32_bf16 v[24:27], v[44:47], v[60:63], v[24:27]
  buffer_load_dwordx4 v[100:103], v13, s[8:11], s44 offen offset:0 sc1
  v_mfma_f32_16x16x32_bf16 v[28:31], v[92:95], v[60:63], v[28:31]
  v_mfma_f32_16x16x32_bf16 v[16:19], v[48:51], v[48:51], v[16:19]
  ds_read_b64_tr_b16 v[64:65], v9 offset:0
  ds_read_b64_tr_b16 v[66:67], v9 offset:4096
  v_mfma_f32_16x16x32_bf16 v[16:19], v[52:55], v[52:55], v[16:19]
  ds_read_b64_tr_b16 v[68:69], v9 offset:8
  ds_read_b64_tr_b16 v[70:71], v9 offset:4104
  v_mfma_f32_16x16x32_bf16 v[16:19], v[56:59], v[56:59], v[16:19]
  ds_read_b64_tr_b16 v[72:73], v3 offset:0
  ds_read_b64_tr_b16 v[74:75], v3 offset:4096
  v_mfma_f32_16x16x32_bf16 v[16:19], v[60:63], v[60:63], v[16:19]
  ds_read_b64_tr_b16 v[76:77], v3 offset:8
  ds_read_b64_tr_b16 v[78:79], v3 offset:4104
  v_mov_b32 v15, 0
  v_max3_f32 v20, v24, v25, v26
  v_max3_f32 v21, v27, v28, v29
  v_max3_f32 v20, v20, v30, v31
  s_cmp_eq_u32 s31, 63
  s_cbranch_scc1 CP0_last
  v_max3_f32 v21, v21, v16, v17
  v_max3_f32 v20, v20, v18, v19
  v_max_f32 v20, v20, v21
  v_mov_b32 v21, v20
  s_nop 1
  v_permlane32_swap_b32 v20, v21
  v_max_f32 v20, v20, v21
  v_mov_b32 v21, v20
  s_nop 1
  v_permlane16_swap_b32 v20, v21
  v_max_f32 v20, v20, v21
  v_pk_add_f32 v[24:25], v[24:25], v[20:21] op_sel_hi:[1,0] neg_lo:[0,1] neg_hi:[0,1]
  v_pk_add_f32 v[26:27], v[26:27], v[20:21] op_sel_hi:[1,0] neg_lo:[0,1] neg_hi:[0,1]
  v_pk_add_f32 v[28:29], v[28:29], v[20:21] op_sel_hi:[1,0] neg_lo:[0,1] neg_hi:[0,1]
  v_pk_add_f32 v[30:31], v[30:31], v[20:21] op_sel_hi:[1,0] neg_lo:[0,1] neg_hi:[0,1]
  v_pk_add_f32 v[16:17], v[16:17], v[20:21] op_sel_hi:[1,0] neg_lo:[0,1] neg_hi:[0,1]
  v_pk_add_f32 v[18:19], v[18:19], v[20:21] op_sel_hi:[1,0] neg_lo:[0,1] neg_hi:[0,1]
  v_pk_mul_f32 v[24:25], v[24:25], s[100:101]
  v_pk_mul_f32 v[26:27], v[26:27], s[100:101]
  v_pk_mul_f32 v[28:29], v[28:29], s[100:101]
  v_pk_mul_f32 v[30:31], v[30:31], s[100:101]
  v_pk_mul_f32 v[16:17], v[16:17], s[100:101]
  v_pk_mul_f32 v[18:19], v[18:19], s[100:101]
  v_exp_f32 v24, v24
  v_exp_f32 v25, v25
  v_exp_f32 v26, v26
  v_exp_f32 v27, v27
  v_exp_f32 v28, v28
  v_exp_f32 v29, v29
  v_exp_f32 v30, v30
  v_exp_f32 v31, v31
  v_exp_f32 v16, v16
  v_exp_f32 v17, v17
  v_exp_f32 v18, v18
  v_exp_f32 v19, v19
  s_waitcnt lgkmcnt(4)
  s_waitcnt vmcnt(0)
Pvm_39:
  v_max3_u32 v14, v96, v97, v98
  v_max3_u32 v15, v99, v100, v101
  v_max3_u32 v14, v14, v102, v103
  v_max_u32 v14, v14, v15
  v_cmp_eq_u32 vcc, 0xffbfffbf, v14
  s_cbranch_vccnz Pvm_39_re
  v_pk_add_f32 v[20:21], v[24:25], v[26:27]
  v_pk_add_f32 v[22:23], v[28:29], v[30:31]
  v_cvt_pk_bf16_f32 v24, v24, v25
  v_cvt_pk_bf16_f32 v25, v26, v27
  v_cvt_pk_bf16_f32 v26, v28, v29
  v_cvt_pk_bf16_f32 v27, v30, v31
  v_pk_add_f32 v[20:21], v[20:21], v[16:17]
  v_pk_add_f32 v[22:23], v[22:23], v[18:19]
  v_cvt_pk_bf16_f32 v16, v16, v17
  v_cvt_pk_bf16_f32 v17, v18, v19
  v_mfma_f32_16x16x32_bf16 v[104:107], v[64:67], v[24:27], 0
  s_mov_b64 exec, s[20:21]
  buffer_store_dword v1, off, s[8:11], s55 sc1
  s_mov_b64 exec, -1
  v_pk_add_f32 v[20:21], v[20:21], v[22:23]
  v_mfma_f32_16x16x32_bf16 v[108:111], v[68:71], v[24:27], 0
  v_add_f32 v20, v20, v21
  v_mfma_f32_16x16x16_bf16 v[104:107], v[96:97], v[16:17], v[104:107]
  v_mfma_f32_16x16x16_bf16 v[108:111], v[98:99], v[16:17], v[108:111]
  v_mov_b32 v21, v20
  s_nop 1
  v_permlane32_swap_b32 v20, v21
  v_add_f32 v20, v20, v21
  v_mov_b32 v21, v20
  s_nop 1
  v_permlane16_swap_b32 v20, v21
  v_add_f32 v20, v20, v21
  v_rcp_f32 v20, v20
  s_nop 0
  v_pk_mul_f32 v[104:105], v[104:105], v[20:21] op_sel_hi:[1,0]
  v_pk_mul_f32 v[106:107], v[106:107], v[20:21] op_sel_hi:[1,0]
  v_pk_mul_f32 v[108:109], v[108:109], v[20:21] op_sel_hi:[1,0]
  v_pk_mul_f32 v[110:111], v[110:111], v[20:21] op_sel_hi:[1,0]
  v_cvt_pk_bf16_f32 v104, v104, v105
  v_cvt_pk_bf16_f32 v105, v106, v107
  v_cvt_pk_bf16_f32 v106, v108, v109
  v_cvt_pk_bf16_f32 v107, v110, v111
  s_mov_b32 exec_lo, 0x00ff00ff
  s_mov_b32 exec_hi, 0x00ff00ff
  buffer_store_dwordx4 v[104:107], v11, s[8:11], s54 offen sc1
  s_waitcnt lgkmcnt(0)
  s_barrier
  s_mov_b64 exec, -1
  buffer_load_dwordx4 v[112:115], v0, s[8:11], s24 offen offset:0 sc1
  buffer_load_dwordx4 v[116:119], v0, s[8:11], s24 offen offset:1024 sc1
  buffer_load_dwordx4 v[120:123], v0, s[8:11], s24 offen offset:2048 sc1
  buffer_load_dwordx4 v[124:127], v0, s[8:11], s24 offen offset:3072 sc1
  s_mov_b32 exec_lo, 0x00ff00ff
  s_mov_b32 exec_hi, 0x00ff00ff
  v_mov_b32 v108, 0xffbfffbf
  v_mov_b32 v109, 0xffbfffbf
  v_mov_b32 v110, 0xffbfffbf
  v_mov_b32 v111, 0xffbfffbf
  s_add_u32 s3, s25, s50
  s_add_u32 s3, s3, 98304
  s_add_u32 s4, s25, s53
  buffer_store_dwordx4 v[108:111], v11, s[8:11], s3 offen sc1
  s_mov_b64 exec, s[20:21]
  buffer_store_dword v108, off, s[8:11], s4 sc1
  s_mov_b64 exec, -1
  s_cmp_lg_u32 s31, s23
  s_cbranch_scc1 CP0_ns
  s_add_u32 s23, s23, 4
  s_lshr_b32 s3, s31, 2
  v_mov_b32 v15, s3
  s_lshl_b32 s3, s30, 7
  s_add_u32 s3, s3, 99618816
  s_mov_b64 exec, 1
  buffer_store_dword v15, off, s[8:11], s3 sc1
  s_mov_b64 exec, -1
CP0_ns:
  v_readfirstlane_b32 s3, v12
  s_nop 0
  s_cmp_ge_u32 s3, 96
  s_cbranch_scc1 CP0_rdy
  s_add_u32 s7, s31, 1
  s_lshr_b32 s7, s7, 2
  s_lshl_b32 s7, s7, 7
  s_add_u32 s7, s7, 99614720
  s_mov_b32 s4, 0
Wkv_40:
  buffer_load_dword v18, off, s[8:11], s7 offset:0 sc1
  s_add_u32 s4, s4, 1
  s_cmp_gt_u32 s4, 65536
  s_cbranch_scc1 L_abort
  s_waitcnt vmcnt(0)
  v_readfirstlane_b32 s3, v18
  s_cmp_ge_u32 s3, 96
  s_cbranch_scc1 Wkv_40_ok
  s_sleep 8
  s_branch Wkv_40
Wkv_40_ok:
CP0_rdy:
  v_mov_b32 v16, v4
  v_mov_b32 v17, v4
  v_mov_b32 v18, v4
  v_mov_b32 v19, v4
  v_mov_b32 v22, 0xff800000
  v_cndmask_b32 v24, v22, 0, s[68:69]
  v_cndmask_b32 v25, v22, 0, s[70:71]
  v_cndmask_b32 v26, v22, 0, s[72:73]
  v_cndmask_b32 v27, v22, 0, s[74:75]
  v_cndmask_b32 v28, v22, 0, s[76:77]
  v_cndmask_b32 v29, v22, 0, s[78:79]
  v_cndmask_b32 v30, v22, 0, s[80:81]
  v_cndmask_b32 v31, v22, 0, s[82:83]
  s_waitcnt vmcnt(2)
  s_nop 0
  v_mfma_f32_16x16x32_bf16 v[24:27], v[32:35], v[112:115], v[24:27]
  s_mov_b32 m0, s46
  s_add_u32 s5, s35, s41
  s_add_u32 s5, s5, 32768
  s_lshl_b32 s4, s28, 7
  v_lshrrev_b32 v15, 1, v0
  v_and_b32 v15, s4, v15
  v_xor_b32 v15, v15, v0
  v_mfma_f32_16x16x32_bf16 v[28:31], v[80:83], v[112:115], v[28:31]
  buffer_load_dwordx4 v15, s[8:11], s5 offen offset:0 sc1 lds
  v_mfma_f32_16x16x32_bf16 v[24:27], v[36:39], v[116:119], v[24:27]
  buffer_load_dwordx4 v15, s[8:11], s5 offen offset:1024 sc1 lds
  v_mfma_f32_16x16x32_bf16 v[28:31], v[84:87], v[116:119], v[28:31]
  buffer_load_dwordx4 v15, s[8:11], s5 offen offset:2048 sc1 lds
  v_mfma_f32_16x16x32_bf16 v[24:27], v[40:43], v[120:123], v[24:27]
  buffer_load_dwordx4 v15, s[8:11], s5 offen offset:3072 sc1 lds
  v_mfma_f32_16x16x32_bf16 v[28:31], v[88:91], v[120:123], v[28:31]
  s_lshr_b32 s5, s41, 1
  s_add_u32 s5, s5, s35
  s_add_u32 s5, s5, 24576
  v_lshlrev_b32 v15, 3, v0
  v_mfma_f32_16x16x32_bf16 v[24:27], v[44:47], v[124:127], v[24:27]
  s_mov_b64 exec, 0xffff
  buffer_load_dword v14, v15, s[8:11], s5 offen sc1
  s_mov_b64 exec, -1
  v_mfma_f32_16x16x32_bf16 v[28:31], v[92:95], v[124:127], v[28:31]
  s_add_u32 s5, s31, 2
  s_lshr_b32 s5, s5, 2
  s_lshl_b32 s5, s5, 7
  s_add_u32 s5, s5, 99614720
  v_mfma_f32_16x16x32_bf16 v[16:19], v[48:51], v[112:115], v[16:19]
  buffer_load_dword v12, off, s[8:11], s5 sc1
  v_mfma_f32_16x16x32_bf16 v[16:19], v[52:55], v[116:119], v[16:19]
  v_mfma_f32_16x16x32_bf16 v[16:19], v[56:59], v[120:123], v[16:19]
  v_mfma_f32_16x16x32_bf16 v[16:19], v[60:63], v[124:127], v[16:19]
  s_branch CP0_x
CP0_last:
  s_waitcnt vmcnt(0)
Pvm_41:
  v_max3_u32 v14, v96, v97, v98
  v_max3_u32 v15, v99, v100, v101
  v_max3_u32 v14, v14, v102, v103
  v_max_u32 v14, v14, v15
  v_cmp_eq_u32 vcc, 0xffbfffbf, v14
  s_cbranch_vccnz Pvm_41_re
  s_barrier
  buffer_load_dwordx4 v[112:115], v0, s[8:11], s24 offen offset:0 sc1
  buffer_load_dwordx4 v[116:119], v0, s[8:11], s24 offen offset:1024 sc1
  buffer_load_dwordx4 v[120:123], v0, s[8:11], s24 offen offset:2048 sc1
  buffer_load_dwordx4 v[124:127], v0, s[8:11], s24 offen offset:3072 sc1
  s_waitcnt lgkmcnt(0)
  v_mov_b32 v16, v4
  v_mov_b32 v17, v4
  v_mov_b32 v18, v4
  v_mov_b32 v19, v4
  v_mov_b32 v22, 0xff800000
  v_cndmask_b32 v24, v22, 0, s[68:69]
  v_cndmask_b32 v25, v22, 0, s[70:71]
  v_cndmask_b32 v26, v22, 0, s[72:73]
  v_cndmask_b32 v27, v22, 0, s[74:75]
  v_cndmask_b32 v28, v22, 0, s[76:77]
  v_cndmask_b32 v29, v22, 0, s[78:79]
  v_cndmask_b32 v30, v22, 0, s[80:81]
  v_cndmask_b32 v31, v22, 0, s[82:83]
  s_waitcnt vmcnt(0)
  s_nop 0
  v_mfma_f32_16x16x32_bf16 v[24:27], v[32:35], v[112:115], v[24:27]
  v_mfma_f32_16x16x32_bf16 v[28:31], v[80:83], v[112:115], v[28:31]
  v_mfma_f32_16x16x32_bf16 v[24:27], v[36:39], v[116:119], v[24:27]
  v_mfma_f32_16x16x32_bf16 v[28:31], v[84:87], v[116:119], v[28:31]
  v_mfma_f32_16x16x32_bf16 v[24:27], v[40:43], v[120:123], v[24:27]
  v_mfma_f32_16x16x32_bf16 v[28:31], v[88:91], v[120:123], v[28:31]
  v_mfma_f32_16x16x32_bf16 v[24:27], v[44:47], v[124:127], v[24:27]
  v_mfma_f32_16x16x32_bf16 v[28:31], v[92:95], v[124:127], v[28:31]
  v_mfma_f32_16x16x32_bf16 v[16:19], v[48:51], v[112:115], v[16:19]
  v_mfma_f32_16x16x32_bf16 v[16:19], v[52:55], v[116:119], v[16:19]
  v_mfma_f32_16x16x32_bf16 v[16:19], v[56:59], v[120:123], v[16:19]
  v_mfma_f32_16x16x32_bf16 v[16:19], v[60:63], v[124:127], v[16:19]
CP0_x:
  v_mov_b32 v15, 0
  v_mov_b32 v15, 0
  v_mov_b32 v15, 0
  v_mov_b32 v15, 0
  v_mov_b32 v15, 0
  v_max3_f32 v20, v24, v25, v26
  v_max3_f32 v21, v27, v28, v29
  v_max3_f32 v20, v20, v30, v31
  v_max3_f32 v21, v21, v16, v17
  v_max3_f32 v20, v20, v18, v19
  v_max_f32 v20, v20, v21
  v_mov_b32 v21, v20
  s_nop 1
  v_permlane32_swap_b32 v20, v21
  v_max_f32 v20, v20, v21
  v_mov_b32 v21, v20
  s_nop 1
  v_permlane16_swap_b32 v20, v21
  v_max_f32 v20, v20, v21
  v_pk_add_f32 v[24:25], v[24:25], v[20:21] op_sel_hi:[1,0] neg_lo:[0,1] neg_hi:[0,1]
  v_pk_add_f32 v[26:27], v[26:27], v[20:21] op_sel_hi:[1,0] neg_lo:[0,1] neg_hi:[0,1]
  v_pk_add_f32 v[28:29], v[28:29], v[20:21] op_sel_hi:[1,0] neg_lo:[0,1] neg_hi:[0,1]
  v_pk_add_f32 v[30:31], v[30:31], v[20:21] op_sel_hi:[1,0] neg_lo:[0,1] neg_hi:[0,1]
  v_pk_add_f32 v[16:17], v[16:17], v[20:21] op_sel_hi:[1,0] neg_lo:[0,1] neg_hi:[0,1]
  v_pk_add_f32 v[18:19], v[18:19], v[20:21] op_sel_hi:[1,0] neg_lo:[0,1] neg_hi:[0,1]
  v_pk_mul_f32 v[24:25], v[24:25], s[100:101]
  v_pk_mul_f32 v[26:27], v[26:27], s[100:101]
  v_pk_mul_f32 v[28:29], v[28:29], s[100:101]
  v_pk_mul_f32 v[30:31], v[30:31], s[100:101]
  v_pk_mul_f32 v[16:17], v[16:17], s[100:101]
  v_pk_mul_f32 v[18:19], v[18:19], s[100:101]
  v_exp_f32 v24, v24
  v_exp_f32 v25, v25
  v_exp_f32 v26, v26
  v_exp_f32 v27, v27
  v_exp_f32 v28, v28
  v_exp_f32 v29, v29
  v_exp_f32 v30, v30
  v_exp_f32 v31, v31
  v_exp_f32 v16, v16
  v_exp_f32 v17, v17
  v_exp_f32 v18, v18
  v_exp_f32 v19, v19
  v_pk_add_f32 v[20:21], v[24:25], v[26:27]
  v_pk_add_f32 v[22:23], v[28:29], v[30:31]
  v_cvt_pk_bf16_f32 v24, v24, v25
  v_cvt_pk_bf16_f32 v25, v26, v27
  v_cvt_pk_bf16_f32 v26, v28, v29
  v_cvt_pk_bf16_f32 v27, v30, v31
  v_pk_add_f32 v[20:21], v[20:21], v[16:17]
  v_pk_add_f32 v[22:23], v[22:23], v[18:19]
  v_cvt_pk_bf16_f32 v16, v16, v17
  v_cvt_pk_bf16_f32 v17, v18, v19
  v_mfma_f32_16x16x32_bf16 v[32:35], v[64:67], v[24:27], 0
  v_pk_add_f32 v[20:21], v[20:21], v[22:23]
  v_mfma_f32_16x16x32_bf16 v[36:39], v[68:71], v[24:27], 0
  v_add_f32 v20, v20, v21
  v_mfma_f32_16x16x32_bf16 v[40:43], v[72:75], v[24:27], 0
  v_mfma_f32_16x16x32_bf16 v[44:47], v[76:79], v[24:27], 0
  v_mfma_f32_16x16x16_bf16 v[32:35], v[96:97], v[16:17], v[32:35]
  v_mfma_f32_16x16x16_bf16 v[36:39], v[98:99], v[16:17], v[36:39]
  v_mfma_f32_16x16x16_bf16 v[40:43], v[100:101], v[16:17], v[40:43]
  v_mfma_f32_16x16x16_bf16 v[44:47], v[102:103], v[16:17], v[44:47]
  v_mov_b32 v21, v20
  s_nop 1
  v_permlane32_swap_b32 v20, v21
  v_add_f32 v20, v20, v21
  v_mov_b32 v21, v20
  s_nop 1
  v_permlane16_swap_b32 v20, v21
  v_add_f32 v20, v20, v21
  v_rcp_f32 v20, v20
  s_nop 0
  v_pk_mul_f32 v[32:33], v[32:33], v[20:21] op_sel_hi:[1,0]
  v_pk_mul_f32 v[34:35], v[34:35], v[20:21] op_sel_hi:[1,0]
  v_pk_mul_f32 v[36:37], v[36:37], v[20:21] op_sel_hi:[1,0]
  v_pk_mul_f32 v[38:39], v[38:39], v[20:21] op_sel_hi:[1,0]
  v_pk_mul_f32 v[40:41], v[40:41], v[20:21] op_sel_hi:[1,0]
  v_pk_mul_f32 v[42:43], v[42:43], v[20:21] op_sel_hi:[1,0]
  v_pk_mul_f32 v[44:45], v[44:45], v[20:21] op_sel_hi:[1,0]
  v_pk_mul_f32 v[46:47], v[46:47], v[20:21] op_sel_hi:[1,0]
  v_cvt_pk_bf16_f32 v112, v32, v33
  v_cvt_pk_bf16_f32 v113, v34, v35
  v_cvt_pk_bf16_f32 v114, v36, v37
  v_cvt_pk_bf16_f32 v115, v38, v39
  v_cvt_pk_bf16_f32 v116, v40, v41
  v_cvt_pk_bf16_f32 v117, v42, v43
  v_cvt_pk_bf16_f32 v118, v44, v45
  v_cvt_pk_bf16_f32 v119, v46, v47
  s_add_u32 s38, s36, 69206016
  s_xor_b32 s39, s36, 131072
  s_add_u32 s39, s39, 69206016
  s_mov_b32 s18, s10
  s_add_u32 s36, s36, 2048
  s_add_u32 s31, s31, 1
  s_mov_b32 s25, s32
  s_mov_b32 s32, s26
  s_add_u32 s26, s26, 262144
  s_and_b32 s26, s26, 0xfffff
  s_or_b32 s26, s26, 85983232
  s_add_u32 s35, s35, 24576
  s_cmp_lt_u32 s31, 64
  s_cbranch_scc1 CP0_top
  buffer_store_dwordx4 v[112:115], v0, s[16:19], s38 offen sc1
  buffer_store_dwordx4 v[116:119], v0, s[16:19], s39 offen sc1
  s_waitcnt vmcnt(0)
  s_barrier
  s_cmp_lg_u32 s27, 0
  s_cbranch_scc1 L_exit
  s_lshl_b32 s3, s30, 7
  s_add_u32 s3, s3, 99618816
  v_mov_b32 v18, 16
  s_mov_b64 exec, 1
  buffer_store_dword v18, off, s[8:11], s3 sc1
  s_endpgm
Pa_38_re:
  s_add_u32 s40, s40, 1
  s_cmp_gt_u32 s40, 65536
  s_cbranch_scc1 L_abort
  s_mov_b64 exec, vcc
  buffer_load_dwordx4 v[96:99], v0, s[8:11], s42 offen offset:0 sc1
  buffer_load_dwordx4 v[100:103], v0, s[8:11], s42 offen offset:1024 sc1
  buffer_load_dwordx4 v[104:107], v0, s[8:11], s42 offen offset:2048 sc1
  buffer_load_dwordx4 v[108:111], v0, s[8:11], s42 offen offset:3072 sc1
  s_mov_b64 exec, -1
  s_waitcnt vmcnt(0)
  s_branch Pa_38
GA_37_re:
  s_add_u32 s40, s40, 1
  s_cmp_gt_u32 s40, 65536
  s_cbranch_scc1 L_abort
  s_mov_b64 exec, vcc
  buffer_load_dwordx4 v[48:51], v0, s[8:11], s43 offen offset:0 sc1
  buffer_load_dwordx4 v[52:55], v0, s[8:11], s43 offen offset:1024 sc1
  buffer_load_dwordx4 v[56:59], v0, s[8:11], s43 offen offset:2048 sc1
  buffer_load_dwordx4 v[60:63], v0, s[8:11], s43 offen offset:3072 sc1
  s_mov_b64 exec, -1
  s_branch GA_37_u
Pvm_39_re:
  s_add_u32 s40, s40, 1
  s_cmp_gt_u32 s40, 65536
  s_cbranch_scc1 L_abort
  s_mov_b64 exec, vcc
  buffer_load_dwordx4 v[96:99], v10, s[8:11], s44 offen offset:0 sc1
  buffer_load_dwordx4 v[100:103], v13, s[8:11], s44 offen offset:0 sc1
  s_mov_b64 exec, -1
  s_waitcnt vmcnt(0)
  s_branch Pvm_39
Pvm_41_re:
  s_add_u32 s40, s40, 1
  s_cmp_gt_u32 s40, 65536
  s_cbranch_scc1 L_abort
  s_mov_b64 exec, vcc
  buffer_load_dwordx4 v[96:99], v10, s[8:11], s44 offen offset:0 sc1
  buffer_load_dwordx4 v[100:103], v13, s[8:11], s44 offen offset:0 sc1
  s_mov_b64 exec, -1
  s_waitcnt vmcnt(0)
  s_branch Pvm_41
L_chainV:
  s_and_b32 s30, s34, 15
  s_lshl_b32 s3, s33, 4
  s_add_u32 s30, s30, s3
  v_and_b32 v30, 63, v0
  v_lshlrev_b32 v0, 4, v30
  v_lshrrev_b32 v19, 4, v30
  s_lshl_b32 s3, s29, 4
  v_add_u32 v16, s3, v19
  v_bfe_u32 v20, v30, 1, 3
  v_xor_b32 v20, v20, v19
  v_and_b32 v21, 1, v30
  v_lshlrev_b32 v21, 4, v21
  v_lshl_add_u32 v17, v20, 5, v21
  s_mov_b32 s15, 0x20000
  s_mov_b32 s14, 8388608
  v_lshrrev_b32 v29, 2, v30
  v_and_b32 v28, 7, v29
  v_lshlrev_b32 v29, 8, v29
  v_and_b32 v21, 3, v30
  v_lshl_add_u32 v29, v21, 3, v29
  s_lshl_b32 s41, s27, 12
  v_mul_u32_u24 v18, 8192, v16
  v_xor_b32 v20, 0x80, v17
  v_add_u32 v12, v18, v17
  v_add_u32 v13, v18, v20
  v_add_u32 v13, 31744, v13
  v_add_u32 v14, 63488, v12
  v_add_u32 v15, 63488, v13
  s_mov_b32 s12, s64
  s_mov_b32 s13, s65
  s_mov_b32 s16, s66
  s_mov_b32 s17, s67
  s_mov_b32 s18, 8388608
  s_mov_b32 s19, 0x20000
  s_lshl_b32 s21, s30, 8
  s_lshl_b32 s3, s28, 18
  s_add_u32 s21, s21, s3
  s_lshl_b32 s22, s33, 22
  s_lshl_b32 s3, s27, 20
  s_add_u32 s22, s22, s3
  s_and_b32 s3, s34, 15
  s_lshl_b32 s3, s3, 7
  s_add_u32 s22, s22, s3
  s_lshl_b32 s3, s27, 1
  v_xor_b32 v18, s3, v28
  s_lshl_b32 s3, s27, 14
  v_add_u32 v19, s3, v29
  v_lshl_add_u32 v2, v18, 5, v19
  v_xor_b32 v3, 32, v2
  v_lshrrev_b32 v18, 5, v30
  v_lshlrev_b32 v22, 15, v18
  v_bfe_u32 v18, v30, 4, 1
  v_lshl_add_u32 v22, v18, 13, v22
  v_bfe_u32 v18, v30, 3, 1
  v_lshl_add_u32 v22, v18, 11, v22
  v_bfe_u32 v18, v30, 1, 2
  v_lshrrev_b32 v19, 4, v30
  v_xor_b32 v18, v18, v19
  v_lshl_add_u32 v22, v18, 5, v22
  v_and_b32 v18, 1, v30
  v_lshl_add_u32 v22, v18, 4, v22
  v_lshrrev_b32 v18, 2, v30
  v_lshlrev_b32 v8, 7, v18
  v_bfe_u32 v18, v30, 3, 2
  v_lshl_add_u32 v8, v18, 5, v8
  v_and_b32 v18, 3, v30
  v_lshl_add_u32 v8, v18, 3, v8
  s_lshl_b32 s23, s27, 14
  s_add_u32 s23, s23, 65536
  v_add_u32 v8, s23, v8
  s_add_u32 m0, s41, 0
  s_add_u32 s20, s21, 0
  buffer_load_dwordx4 v12, s[12:15], s20 offen offset:0 lds
  buffer_load_dwordx4 v13, s[12:15], s20 offen offset:1024 lds
  buffer_load_dwordx4 v14, s[12:15], s20 offen offset:2048 lds
  buffer_load_dwordx4 v15, s[12:15], s20 offen offset:3072 lds
  s_add_u32 m0, s41, 16384
  s_add_u32 s20, s21, 2097152
  buffer_load_dwordx4 v12, s[12:15], s20 offen offset:0 lds
  buffer_load_dwordx4 v13, s[12:15], s20 offen offset:1024 lds
  buffer_load_dwordx4 v14, s[12:15], s20 offen offset:2048 lds
  buffer_load_dwordx4 v15, s[12:15], s20 offen offset:3072 lds
  s_add_u32 m0, s41, 32768
  s_add_u32 s20, s21, 4194304
  buffer_load_dwordx4 v12, s[12:15], s20 offen offset:0 lds
  buffer_load_dwordx4 v13, s[12:15], s20 offen offset:1024 lds
  buffer_load_dwordx4 v14, s[12:15], s20 offen offset:2048 lds
  buffer_load_dwordx4 v15, s[12:15], s20 offen offset:3072 lds
  s_add_u32 m0, s41, 49152
  s_add_u32 s20, s21, 6291456
  buffer_load_dwordx4 v12, s[12:15], s20 offen offset:0 lds
  buffer_load_dwordx4 v13, s[12:15], s20 offen offset:1024 lds
  buffer_load_dwordx4 v14, s[12:15], s20 offen offset:2048 lds
  buffer_load_dwordx4 v15, s[12:15], s20 offen offset:3072 lds
  s_add_u32 m0, s23, 0
  s_add_u32 s20, s22, 0
  buffer_load_dwordx4 v22, s[16:19], s20 offen lds
  s_add_u32 m0, s23, 1024
  s_add_u32 s20, s22, 16384
  buffer_load_dwordx4 v22, s[16:19], s20 offen lds
  s_add_u32 m0, s23, 2048
  s_add_u32 s20, s22, 4096
  buffer_load_dwordx4 v22, s[16:19], s20 offen lds
  s_add_u32 m0, s23, 3072
  s_add_u32 s20, s22, 20480
  buffer_load_dwordx4 v22, s[16:19], s20 offen lds
  s_add_u32 m0, s23, 4096
  s_add_u32 s20, s22, 65536
  buffer_load_dwordx4 v22, s[16:19], s20 offen lds
  s_add_u32 m0, s23, 5120
  s_add_u32 s20, s22, 81920
  buffer_load_dwordx4 v22, s[16:19], s20 offen lds
  s_add_u32 m0, s23, 6144
  s_add_u32 s20, s22, 69632
  buffer_load_dwordx4 v22, s[16:19], s20 offen lds
  s_add_u32 m0, s23, 7168
  s_add_u32 s20, s22, 86016
  buffer_load_dwordx4 v22, s[16:19], s20 offen lds
  s_add_u32 m0, s23, 8192
  s_add_u32 s20, s22, 131072
  buffer_load_dwordx4 v22, s[16:19], s20 offen lds
  s_add_u32 m0, s23, 9216
  s_add_u32 s20, s22, 147456
  buffer_load_dwordx4 v22, s[16:19], s20 offen lds
  s_add_u32 m0, s23, 10240
  s_add_u32 s20, s22, 135168
  buffer_load_dwordx4 v22, s[16:19], s20 offen lds
  s_add_u32 m0, s23, 11264
  s_add_u32 s20, s22, 151552
  buffer_load_dwordx4 v22, s[16:19], s20 offen lds
  s_add_u32 m0, s23, 12288
  s_add_u32 s20, s22, 196608
  buffer_load_dwordx4 v22, s[16:19], s20 offen lds
  s_add_u32 m0, s23, 13312
  s_add_u32 s20, s22, 212992
  buffer_load_dwordx4 v22, s[16:19], s20 offen lds
  s_add_u32 m0, s23, 14336
  s_add_u32 s20, s22, 200704
  buffer_load_dwordx4 v22, s[16:19], s20 offen lds
  s_add_u32 m0, s23, 15360
  s_add_u32 s20, s22, 217088
  buffer_load_dwordx4 v22, s[16:19], s20 offen lds
  s_waitcnt vmcnt(16)
  s_barrier
  ds_read_b64_tr_b16 a[0:1], v2 offset:0
  ds_read_b64_tr_b16 a[2:3], v2 offset:4096
  ds_read_b64_tr_b16 a[4:5], v2 offset:8192
  ds_read_b64_tr_b16 a[6:7], v2 offset:12288
  ds_read_b64_tr_b16 a[8:9], v3 offset:0
  ds_read_b64_tr_b16 a[10:11], v3 offset:4096
  ds_read_b64_tr_b16 a[12:13], v3 offset:8192
  ds_read_b64_tr_b16 a[14:15], v3 offset:12288
  v_add_u32 v2, 0x4000, v2
  v_and_b32 v2, 0xffff, v2
  v_add_u32 v3, 0x4000, v3
  v_and_b32 v3, 0xffff, v3
  ds_read_b64_tr_b16 a[48:49], v2 offset:0
  ds_read_b64_tr_b16 a[50:51], v2 offset:4096
  ds_read_b64_tr_b16 a[52:53], v2 offset:8192
  ds_read_b64_tr_b16 a[54:55], v2 offset:12288
  ds_read_b64_tr_b16 a[56:57], v3 offset:0
  ds_read_b64_tr_b16 a[58:59], v3 offset:4096
  ds_read_b64_tr_b16 a[60:61], v3 offset:8192
  ds_read_b64_tr_b16 a[62:63], v3 offset:12288
  v_add_u32 v2, 0x4000, v2
  v_and_b32 v2, 0xffff, v2
  v_add_u32 v3, 0x4000, v3
  v_and_b32 v3, 0xffff, v3
  ds_read_b64_tr_b16 a[96:97], v2 offset:0
  ds_read_b64_tr_b16 a[98:99], v2 offset:4096
  ds_read_b64_tr_b16 a[100:101], v2 offset:8192
  ds_read_b64_tr_b16 a[102:103], v2 offset:12288
  ds_read_b64_tr_b16 a[104:105], v3 offset:0
  ds_read_b64_tr_b16 a[106:107], v3 offset:4096
  ds_read_b64_tr_b16 a[108:109], v3 offset:8192
  ds_read_b64_tr_b16 a[110:111], v3 offset:12288
  v_add_u32 v2, 0x4000, v2
  v_and_b32 v2, 0xffff, v2
  v_add_u32 v3, 0x4000, v3
  v_and_b32 v3, 0xffff, v3
  ds_read_b64_tr_b16 a[144:145], v2 offset:0
  ds_read_b64_tr_b16 a[146:147], v2 offset:4096
  ds_read_b64_tr_b16 a[148:149], v2 offset:8192
  ds_read_b64_tr_b16 a[150:151], v2 offset:12288
  ds_read_b64_tr_b16 a[152:153], v3 offset:0
  ds_read_b64_tr_b16 a[154:155], v3 offset:4096
  ds_read_b64_tr_b16 a[156:157], v3 offset:8192
  ds_read_b64_tr_b16 a[158:159], v3 offset:12288
  v_add_u32 v2, 0x4000, v2
  v_and_b32 v2, 0xffff, v2
  v_add_u32 v3, 0x4000, v3
  v_and_b32 v3, 0xffff, v3
  s_waitcnt lgkmcnt(0)
  s_barrier
  buffer_load_dword v31, off, s[68:71], 0 offset:136 sc1
  s_add_u32 m0, s41, 0
  s_add_u32 s20, s21, 524288
  buffer_load_dwordx4 v12, s[12:15], s20 offen offset:0 lds
  buffer_load_dwordx4 v13, s[12:15], s20 offen offset:1024 lds
  buffer_load_dwordx4 v14, s[12:15], s20 offen offset:2048 lds
  buffer_load_dwordx4 v15, s[12:15], s20 offen offset:3072 lds
  s_add_u32 m0, s41, 16384
  s_add_u32 s20, s21, 2621440
  buffer_load_dwordx4 v12, s[12:15], s20 offen offset:0 lds
  buffer_load_dwordx4 v13, s[12:15], s20 offen offset:1024 lds
  buffer_load_dwordx4 v14, s[12:15], s20 offen offset:2048 lds
  buffer_load_dwordx4 v15, s[12:15], s20 offen offset:3072 lds
  s_add_u32 m0, s41, 32768
  s_add_u32 s20, s21, 4718592
  buffer_load_dwordx4 v12, s[12:15], s20 offen offset:0 lds
  buffer_load_dwordx4 v13, s[12:15], s20 offen offset:1024 lds
  buffer_load_dwordx4 v14, s[12:15], s20 offen offset:2048 lds
  buffer_load_dwordx4 v15, s[12:15], s20 offen offset:3072 lds
  s_add_u32 m0, s41, 49152
  s_add_u32 s20, s21, 6815744
  buffer_load_dwordx4 v12, s[12:15], s20 offen offset:0 lds
  buffer_load_dwordx4 v13, s[12:15], s20 offen offset:1024 lds
  buffer_load_dwordx4 v14, s[12:15], s20 offen offset:2048 lds
  buffer_load_dwordx4 v15, s[12:15], s20 offen offset:3072 lds
  s_waitcnt vmcnt(16)
  s_mov_b32 s4, 0
  v_mov_b32 v18, v31
  s_branch VR_42_c
VR_42:
  s_sleep 4
  buffer_load_dword v18, off, s[68:71], 0 offset:136 sc1
  s_add_u32 s4, s4, 1
  s_cmp_gt_u32 s4, 0x10000
  s_cbranch_scc1 L_abort
  s_waitcnt vmcnt(0)
VR_42_c:
  v_readfirstlane_b32 s3, v18
  s_cmp_eq_u32 s3, 0
  s_cbranch_scc1 VR_42
  s_sub_u32 s3, s3, 1
  s_and_b32 s3, s3, 7
  s_cmp_lg_u32 s3, s89
  s_cbranch_scc1 L_redo
  s_getreg_b32 s47, hwreg(HW_REG_XCC_ID, 0, 3)
  s_lshl_b32 s47, s47, 3
  s_lshl_b64 s[4:5], 1, s47
  v_mov_b32 v18, s4
  v_mov_b32 v19, s5
  s_lshl_b32 s3, s33, 3
  s_cmp_eq_u32 s27, 0
  s_cselect_b32 s4, 1, 0
  s_mov_b32 s5, 0
  s_mov_b64 exec, s[4:5]
  buffer_atomic_add_x2 v[18:19], off, s[68:71], s3 offset:8 sc1
  s_mov_b64 exec, -1
  v_xor_b32 v18, 0, v8
  ds_read_b64_tr_b16 a[192:193], v18 offset:0
  ds_read_b64_tr_b16 a[194:195], v18 offset:2048
  ds_read_b64_tr_b16 a[196:197], v18 offset:4096
  ds_read_b64_tr_b16 a[198:199], v18 offset:6144
  v_xor_b32 v18, 32, v8
  ds_read_b64_tr_b16 a[200:201], v18 offset:0
  ds_read_b64_tr_b16 a[202:203], v18 offset:2048
  ds_read_b64_tr_b16 a[204:205], v18 offset:4096
  ds_read_b64_tr_b16 a[206:207], v18 offset:6144
  v_xor_b32 v18, 64, v8
  ds_read_b64_tr_b16 a[208:209], v18 offset:0
  ds_read_b64_tr_b16 a[210:211], v18 offset:2048
  ds_read_b64_tr_b16 a[212:213], v18 offset:4096
  ds_read_b64_tr_b16 a[214:215], v18 offset:6144
  v_xor_b32 v18, 96, v8
  ds_read_b64_tr_b16 a[216:217], v18 offset:0
  ds_read_b64_tr_b16 a[218:219], v18 offset:2048
  ds_read_b64_tr_b16 a[220:221], v18 offset:4096
  ds_read_b64_tr_b16 a[222:223], v18 offset:6144
  v_xor_b32 v18, 0, v8
  ds_read_b64_tr_b16 a[224:225], v18 offset:8192
  ds_read_b64_tr_b16 a[226:227], v18 offset:10240
  ds_read_b64_tr_b16 a[228:229], v18 offset:12288
  ds_read_b64_tr_b16 a[230:231], v18 offset:14336
  v_xor_b32 v18, 32, v8
  ds_read_b64_tr_b16 a[232:233], v18 offset:8192
  ds_read_b64_tr_b16 a[234:235], v18 offset:10240
  ds_read_b64_tr_b16 a[236:237], v18 offset:12288
  ds_read_b64_tr_b16 a[238:239], v18 offset:14336
  v_xor_b32 v18, 64, v8
  ds_read_b64_tr_b16 a[240:241], v18 offset:8192
  ds_read_b64_tr_b16 a[242:243], v18 offset:10240
  ds_read_b64_tr_b16 a[244:245], v18 offset:12288
  ds_read_b64_tr_b16 a[246:247], v18 offset:14336
  v_xor_b32 v18, 96, v8
  ds_read_b64_tr_b16 a[248:249], v18 offset:8192
  ds_read_b64_tr_b16 a[250:251], v18 offset:10240
  ds_read_b64_tr_b16 a[252:253], v18 offset:12288
  ds_read_b64_tr_b16 a[254:255], v18 offset:14336
  s_waitcnt lgkmcnt(0)
  s_add_u32 m0, s23, 0
  s_add_u32 s20, s22, 262144
  buffer_load_dwordx4 v22, s[16:19], s20 offen lds
  s_add_u32 m0, s23, 1024
  s_add_u32 s20, s22, 278528
  buffer_load_dwordx4 v22, s[16:19], s20 offen lds
  s_add_u32 m0, s23, 2048
  s_add_u32 s20, s22, 266240
  buffer_load_dwordx4 v22, s[16:19], s20 offen lds
  s_add_u32 m0, s23, 3072
  s_add_u32 s20, s22, 282624
  buffer_load_dwordx4 v22, s[16:19], s20 offen lds
  s_add_u32 m0, s23, 4096
  s_add_u32 s20, s22, 327680
  buffer_load_dwordx4 v22, s[16:19], s20 offen lds
  s_add_u32 m0, s23, 5120
  s_add_u32 s20, s22, 344064
  buffer_load_dwordx4 v22, s[16:19], s20 offen lds
  s_add_u32 m0, s23, 6144
  s_add_u32 s20, s22, 331776
  buffer_load_dwordx4 v22, s[16:19], s20 offen lds
  s_add_u32 m0, s23, 7168
  s_add_u32 s20, s22, 348160
  buffer_load_dwordx4 v22, s[16:19], s20 offen lds
  s_add_u32 m0, s23, 8192
  s_add_u32 s20, s22, 524288
  buffer_load_dwordx4 v22, s[16:19], s20 offen lds
  s_add_u32 m0, s23, 9216
  s_add_u32 s20, s22, 540672
  buffer_load_dwordx4 v22, s[16:19], s20 offen lds
  s_add_u32 m0, s23, 10240
  s_add_u32 s20, s22, 528384
  buffer_load_dwordx4 v22, s[16:19], s20 offen lds
  s_add_u32 m0, s23, 11264
  s_add_u32 s20, s22, 544768
  buffer_load_dwordx4 v22, s[16:19], s20 offen lds
  s_add_u32 m0, s23, 12288
  s_add_u32 s20, s22, 589824
  buffer_load_dwordx4 v22, s[16:19], s20 offen lds
  s_add_u32 m0, s23, 13312
  s_add_u32 s20, s22, 606208
  buffer_load_dwordx4 v22, s[16:19], s20 offen lds
  s_add_u32 m0, s23, 14336
  s_add_u32 s20, s22, 593920
  buffer_load_dwordx4 v22, s[16:19], s20 offen lds
  s_add_u32 m0, s23, 15360
  s_add_u32 s20, s22, 610304
  buffer_load_dwordx4 v22, s[16:19], s20 offen lds
  s_waitcnt vmcnt(16)
  s_barrier
  ds_read_b64_tr_b16 a[16:17], v2 offset:0
  ds_read_b64_tr_b16 a[18:19], v2 offset:4096
  ds_read_b64_tr_b16 a[20:21], v2 offset:8192
  ds_read_b64_tr_b16 a[22:23], v2 offset:12288
  ds_read_b64_tr_b16 a[24:25], v3 offset:0
  ds_read_b64_tr_b16 a[26:27], v3 offset:4096
  ds_read_b64_tr_b16 a[28:29], v3 offset:8192
  ds_read_b64_tr_b16 a[30:31], v3 offset:12288
  v_add_u32 v2, 0x4000, v2
  v_and_b32 v2, 0xffff, v2
  v_add_u32 v3, 0x4000, v3
  v_and_b32 v3, 0xffff, v3
  ds_read_b64_tr_b16 a[64:65], v2 offset:0
  ds_read_b64_tr_b16 a[66:67], v2 offset:4096
  ds_read_b64_tr_b16 a[68:69], v2 offset:8192
  ds_read_b64_tr_b16 a[70:71], v2 offset:12288
  ds_read_b64_tr_b16 a[72:73], v3 offset:0
  ds_read_b64_tr_b16 a[74:75], v3 offset:4096
  ds_read_b64_tr_b16 a[76:77], v3 offset:8192
  ds_read_b64_tr_b16 a[78:79], v3 offset:12288
  v_add_u32 v2, 0x4000, v2
  v_and_b32 v2, 0xffff, v2
  v_add_u32 v3, 0x4000, v3
  v_and_b32 v3, 0xffff, v3
  ds_read_b64_tr_b16 a[112:113], v2 offset:0
  ds_read_b64_tr_b16 a[114:115], v2 offset:4096
  ds_read_b64_tr_b16 a[116:117], v2 offset:8192
  ds_read_b64_tr_b16 a[118:119], v2 offset:12288
  ds_read_b64_tr_b16 a[120:121], v3 offset:0
  ds_read_b64_tr_b16 a[122:123], v3 offset:4096
  ds_read_b64_tr_b16 a[124:125], v3 offset:8192
  ds_read_b64_tr_b16 a[126:127], v3 offset:12288
  v_add_u32 v2, 0x4000, v2
  v_and_b32 v2, 0xffff, v2
  v_add_u32 v3, 0x4000, v3
  v_and_b32 v3, 0xffff, v3
  ds_read_b64_tr_b16 a[160:161], v2 offset:0
  ds_read_b64_tr_b16 a[162:163], v2 offset:4096
  ds_read_b64_tr_b16 a[164:165], v2 offset:8192
  ds_read_b64_tr_b16 a[166:167], v2 offset:12288
  ds_read_b64_tr_b16 a[168:169], v3 offset:0
  ds_read_b64_tr_b16 a[170:171], v3 offset:4096
  ds_read_b64_tr_b16 a[172:173], v3 offset:8192
  ds_read_b64_tr_b16 a[174:175], v3 offset:12288
  v_add_u32 v2, 0x4000, v2
  v_and_b32 v2, 0xffff, v2
  v_add_u32 v3, 0x4000, v3
  v_and_b32 v3, 0xffff, v3
  s_waitcnt lgkmcnt(0)
  s_barrier
  s_add_u32 m0, s41, 0
  s_add_u32 s20, s21, 1048576
  buffer_load_dwordx4 v12, s[12:15], s20 offen offset:0 lds
  buffer_load_dwordx4 v13, s[12:15], s20 offen offset:1024 lds
  buffer_load_dwordx4 v14, s[12:15], s20 offen offset:2048 lds
  buffer_load_dwordx4 v15, s[12:15], s20 offen offset:3072 lds
  s_add_u32 m0, s41, 16384
  s_add_u32 s20, s21, 3145728
  buffer_load_dwordx4 v12, s[12:15], s20 offen offset:0 lds
  buffer_load_dwordx4 v13, s[12:15], s20 offen offset:1024 lds
  buffer_load_dwordx4 v14, s[12:15], s20 offen offset:2048 lds
  buffer_load_dwordx4 v15, s[12:15], s20 offen offset:3072 lds
  s_add_u32 m0, s41, 32768
  s_add_u32 s20, s21, 5242880
  buffer_load_dwordx4 v12, s[12:15], s20 offen offset:0 lds
  buffer_load_dwordx4 v13, s[12:15], s20 offen offset:1024 lds
  buffer_load_dwordx4 v14, s[12:15], s20 offen offset:2048 lds
  buffer_load_dwordx4 v15, s[12:15], s20 offen offset:3072 lds
  s_add_u32 m0, s41, 49152
  s_add_u32 s20, s21, 7340032
  buffer_load_dwordx4 v12, s[12:15], s20 offen offset:0 lds
  buffer_load_dwordx4 v13, s[12:15], s20 offen offset:1024 lds
  buffer_load_dwordx4 v14, s[12:15], s20 offen offset:2048 lds
  buffer_load_dwordx4 v15, s[12:15], s20 offen offset:3072 lds
  s_waitcnt vmcnt(16)
  v_xor_b32 v18, 0, v8
  ds_read_b64_tr_b16 v[128:129], v18 offset:0
  ds_read_b64_tr_b16 v[130:131], v18 offset:2048
  ds_read_b64_tr_b16 v[132:133], v18 offset:4096
  ds_read_b64_tr_b16 v[134:135], v18 offset:6144
  v_xor_b32 v18, 32, v8
  ds_read_b64_tr_b16 v[136:137], v18 offset:0
  ds_read_b64_tr_b16 v[138:139], v18 offset:2048
  ds_read_b64_tr_b16 v[140:141], v18 offset:4096
  ds_read_b64_tr_b16 v[142:143], v18 offset:6144
  v_xor_b32 v18, 64, v8
  ds_read_b64_tr_b16 v[144:145], v18 offset:0
  ds_read_b64_tr_b16 v[146:147], v18 offset:2048
  ds_read_b64_tr_b16 v[148:149], v18 offset:4096
  ds_read_b64_tr_b16 v[150:151], v18 offset:6144
  v_xor_b32 v18, 96, v8
  ds_read_b64_tr_b16 v[152:153], v18 offset:0
  ds_read_b64_tr_b16 v[154:155], v18 offset:2048
  ds_read_b64_tr_b16 v[156:157], v18 offset:4096
  ds_read_b64_tr_b16 v[158:159], v18 offset:6144
  v_xor_b32 v18, 0, v8
  ds_read_b64_tr_b16 v[160:161], v18 offset:8192
  ds_read_b64_tr_b16 v[162:163], v18 offset:10240
  ds_read_b64_tr_b16 v[164:165], v18 offset:12288
  ds_read_b64_tr_b16 v[166:167], v18 offset:14336
  v_xor_b32 v18, 32, v8
  ds_read_b64_tr_b16 v[168:169], v18 offset:8192
  ds_read_b64_tr_b16 v[170:171], v18 offset:10240
  ds_read_b64_tr_b16 v[172:173], v18 offset:12288
  ds_read_b64_tr_b16 v[174:175], v18 offset:14336
  v_xor_b32 v18, 64, v8
  ds_read_b64_tr_b16 v[176:177], v18 offset:8192
  ds_read_b64_tr_b16 v[178:179], v18 offset:10240
  ds_read_b64_tr_b16 v[180:181], v18 offset:12288
  ds_read_b64_tr_b16 v[182:183], v18 offset:14336
  v_xor_b32 v18, 96, v8
  ds_read_b64_tr_b16 v[184:185], v18 offset:8192
  ds_read_b64_tr_b16 v[186:187], v18 offset:10240
  ds_read_b64_tr_b16 v[188:189], v18 offset:12288
  ds_read_b64_tr_b16 v[190:191], v18 offset:14336
  s_waitcnt lgkmcnt(0)
  s_add_u32 m0, s23, 0
  s_add_u32 s20, s22, 655360
  buffer_load_dwordx4 v22, s[16:19], s20 offen lds
  s_add_u32 m0, s23, 1024
  s_add_u32 s20, s22, 671744
  buffer_load_dwordx4 v22, s[16:19], s20 offen lds
  s_add_u32 m0, s23, 2048
  s_add_u32 s20, s22, 659456
  buffer_load_dwordx4 v22, s[16:19], s20 offen lds
  s_add_u32 m0, s23, 3072
  s_add_u32 s20, s22, 675840
  buffer_load_dwordx4 v22, s[16:19], s20 offen lds
  s_add_u32 m0, s23, 4096
  s_add_u32 s20, s22, 720896
  buffer_load_dwordx4 v22, s[16:19], s20 offen lds
  s_add_u32 m0, s23, 5120
  s_add_u32 s20, s22, 737280
  buffer_load_dwordx4 v22, s[16:19], s20 offen lds
  s_add_u32 m0, s23, 6144
  s_add_u32 s20, s22, 724992
  buffer_load_dwordx4 v22, s[16:19], s20 offen lds
  s_add_u32 m0, s23, 7168
  s_add_u32 s20, s22, 741376
  buffer_load_dwordx4 v22, s[16:19], s20 offen lds
  s_add_u32 m0, s23, 8192
  s_add_u32 s20, s22, 786432
  buffer_load_dwordx4 v22, s[16:19], s20 offen lds
  s_add_u32 m0, s23, 9216
  s_add_u32 s20, s22, 802816
  buffer_load_dwordx4 v22, s[16:19], s20 offen lds
  s_add_u32 m0, s23, 10240
  s_add_u32 s20, s22, 790528
  buffer_load_dwordx4 v22, s[16:19], s20 offen lds
  s_add_u32 m0, s23, 11264
  s_add_u32 s20, s22, 806912
  buffer_load_dwordx4 v22, s[16:19], s20 offen lds
  s_add_u32 m0, s23, 12288
  s_add_u32 s20, s22, 851968
  buffer_load_dwordx4 v22, s[16:19], s20 offen lds
  s_add_u32 m0, s23, 13312
  s_add_u32 s20, s22, 868352
  buffer_load_dwordx4 v22, s[16:19], s20 offen lds
  s_add_u32 m0, s23, 14336
  s_add_u32 s20, s22, 856064
  buffer_load_dwordx4 v22, s[16:19], s20 offen lds
  s_add_u32 m0, s23, 15360
  s_add_u32 s20, s22, 872448
  buffer_load_dwordx4 v22, s[16:19], s20 offen lds
  s_waitcnt vmcnt(16)
  s_barrier
  ds_read_b64_tr_b16 a[32:33], v2 offset:0
  ds_read_b64_tr_b16 a[34:35], v2 offset:4096
  ds_read_b64_tr_b16 a[36:37], v2 offset:8192
  ds_read_b64_tr_b16 a[38:39], v2 offset:12288
  ds_read_b64_tr_b16 a[40:41], v3 offset:0
  ds_read_b64_tr_b16 a[42:43], v3 offset:4096
  ds_read_b64_tr_b16 a[44:45], v3 offset:8192
  ds_read_b64_tr_b16 a[46:47], v3 offset:12288
  v_add_u32 v2, 0x4000, v2
  v_and_b32 v2, 0xffff, v2
  v_add_u32 v3, 0x4000, v3
  v_and_b32 v3, 0xffff, v3
  ds_read_b64_tr_b16 a[80:81], v2 offset:0
  ds_read_b64_tr_b16 a[82:83], v2 offset:4096
  ds_read_b64_tr_b16 a[84:85], v2 offset:8192
  ds_read_b64_tr_b16 a[86:87], v2 offset:12288
  ds_read_b64_tr_b16 a[88:89], v3 offset:0
  ds_read_b64_tr_b16 a[90:91], v3 offset:4096
  ds_read_b64_tr_b16 a[92:93], v3 offset:8192
  ds_read_b64_tr_b16 a[94:95], v3 offset:12288
  v_add_u32 v2, 0x4000, v2
  v_and_b32 v2, 0xffff, v2
  v_add_u32 v3, 0x4000, v3
  v_and_b32 v3, 0xffff, v3
  ds_read_b64_tr_b16 a[128:129], v2 offset:0
  ds_read_b64_tr_b16 a[130:131], v2 offset:4096
  ds_read_b64_tr_b16 a[132:133], v2 offset:8192
  ds_read_b64_tr_b16 a[134:135], v2 offset:12288
  ds_read_b64_tr_b16 a[136:137], v3 offset:0
  ds_read_b64_tr_b16 a[138:139], v3 offset:4096
  ds_read_b64_tr_b16 a[140:141], v3 offset:8192
  ds_read_b64_tr_b16 a[142:143], v3 offset:12288
  v_add_u32 v2, 0x4000, v2
  v_and_b32 v2, 0xffff, v2
  v_add_u32 v3, 0x4000, v3
  v_and_b32 v3, 0xffff, v3
  ds_read_b64_tr_b16 a[176:177], v2 offset:0
  ds_read_b64_tr_b16 a[178:179], v2 offset:4096
  ds_read_b64_tr_b16 a[180:181], v2 offset:8192
  ds_read_b64_tr_b16 a[182:183], v2 offset:12288
  ds_read_b64_tr_b16 a[184:185], v3 offset:0
  ds_read_b64_tr_b16 a[186:187], v3 offset:4096
  ds_read_b64_tr_b16 a[188:189], v3 offset:8192
  ds_read_b64_tr_b16 a[190:191], v3 offset:12288
  v_add_u32 v2, 0x4000, v2
  v_and_b32 v2, 0xffff, v2
  v_add_u32 v3, 0x4000, v3
  v_and_b32 v3, 0xffff, v3
  s_waitcnt lgkmcnt(0)
  s_barrier
  s_add_u32 m0, s41, 0
  s_add_u32 s20, s21, 1572864
  buffer_load_dwordx4 v12, s[12:15], s20 offen offset:0 lds
  buffer_load_dwordx4 v13, s[12:15], s20 offen offset:1024 lds
  buffer_load_dwordx4 v14, s[12:15], s20 offen offset:2048 lds
  buffer_load_dwordx4 v15, s[12:15], s20 offen offset:3072 lds
  s_add_u32 m0, s41, 16384
  s_add_u32 s20, s21, 3670016
  buffer_load_dwordx4 v12, s[12:15], s20 offen offset:0 lds
  buffer_load_dwordx4 v13, s[12:15], s20 offen offset:1024 lds
  buffer_load_dwordx4 v14, s[12:15], s20 offen offset:2048 lds
  buffer_load_dwordx4 v15, s[12:15], s20 offen offset:3072 lds
  s_add_u32 m0, s41, 32768
  s_add_u32 s20, s21, 5767168
  buffer_load_dwordx4 v12, s[12:15], s20 offen offset:0 lds
  buffer_load_dwordx4 v13, s[12:15], s20 offen offset:1024 lds
  buffer_load_dwordx4 v14, s[12:15], s20 offen offset:2048 lds
  buffer_load_dwordx4 v15, s[12:15], s20 offen offset:3072 lds
  s_add_u32 m0, s41, 49152
  s_add_u32 s20, s21, 7864320
  buffer_load_dwordx4 v12, s[12:15], s20 offen offset:0 lds
  buffer_load_dwordx4 v13, s[12:15], s20 offen offset:1024 lds
  buffer_load_dwordx4 v14, s[12:15], s20 offen offset:2048 lds
  buffer_load_dwordx4 v15, s[12:15], s20 offen offset:3072 lds
  s_waitcnt vmcnt(16)
  v_xor_b32 v18, 0, v8
  ds_read_b64_tr_b16 v[192:193], v18 offset:0
  ds_read_b64_tr_b16 v[194:195], v18 offset:2048
  ds_read_b64_tr_b16 v[196:197], v18 offset:4096
  ds_read_b64_tr_b16 v[198:199], v18 offset:6144
  v_xor_b32 v18, 32, v8
  ds_read_b64_tr_b16 v[200:201], v18 offset:0
  ds_read_b64_tr_b16 v[202:203], v18 offset:2048
  ds_read_b64_tr_b16 v[204:205], v18 offset:4096
  ds_read_b64_tr_b16 v[206:207], v18 offset:6144
  v_xor_b32 v18, 64, v8
  ds_read_b64_tr_b16 v[208:209], v18 offset:0
  ds_read_b64_tr_b16 v[210:211], v18 offset:2048
  ds_read_b64_tr_b16 v[212:213], v18 offset:4096
  ds_read_b64_tr_b16 v[214:215], v18 offset:6144
  v_xor_b32 v18, 96, v8
  ds_read_b64_tr_b16 v[216:217], v18 offset:0
  ds_read_b64_tr_b16 v[218:219], v18 offset:2048
  ds_read_b64_tr_b16 v[220:221], v18 offset:4096
  ds_read_b64_tr_b16 v[222:223], v18 offset:6144
  v_xor_b32 v18, 0, v8
  ds_read_b64_tr_b16 v[224:225], v18 offset:8192
  ds_read_b64_tr_b16 v[226:227], v18 offset:10240
  ds_read_b64_tr_b16 v[228:229], v18 offset:12288
  ds_read_b64_tr_b16 v[230:231], v18 offset:14336
  v_xor_b32 v18, 32, v8
  ds_read_b64_tr_b16 v[232:233], v18 offset:8192
  ds_read_b64_tr_b16 v[234:235], v18 offset:10240
  ds_read_b64_tr_b16 v[236:237], v18 offset:12288
  ds_read_b64_tr_b16 v[238:239], v18 offset:14336
  v_xor_b32 v18, 64, v8
  ds_read_b64_tr_b16 v[240:241], v18 offset:8192
  ds_read_b64_tr_b16 v[242:243], v18 offset:10240
  ds_read_b64_tr_b16 v[244:245], v18 offset:12288
  ds_read_b64_tr_b16 v[246:247], v18 offset:14336
  v_xor_b32 v18, 96, v8
  ds_read_b64_tr_b16 v[248:249], v18 offset:8192
  ds_read_b64_tr_b16 v[250:251], v18 offset:10240
  ds_read_b64_tr_b16 v[252:253], v18 offset:12288
  ds_read_b64_tr_b16 v[254:255], v18 offset:14336
  s_waitcnt lgkmcnt(0)
  s_add_u32 m0, s23, 0
  s_add_u32 s20, s22, 393216
  buffer_load_dwordx4 v22, s[16:19], s20 offen lds
  s_add_u32 m0, s23, 1024
  s_add_u32 s20, s22, 409600
  buffer_load_dwordx4 v22, s[16:19], s20 offen lds
  s_add_u32 m0, s23, 2048
  s_add_u32 s20, s22, 397312
  buffer_load_dwordx4 v22, s[16:19], s20 offen lds
  s_add_u32 m0, s23, 3072
  s_add_u32 s20, s22, 413696
  buffer_load_dwordx4 v22, s[16:19], s20 offen lds
  s_add_u32 m0, s23, 4096
  s_add_u32 s20, s22, 458752
  buffer_load_dwordx4 v22, s[16:19], s20 offen lds
  s_add_u32 m0, s23, 5120
  s_add_u32 s20, s22, 475136
  buffer_load_dwordx4 v22, s[16:19], s20 offen lds
  s_add_u32 m0, s23, 6144
  s_add_u32 s20, s22, 462848
  buffer_load_dwordx4 v22, s[16:19], s20 offen lds
  s_add_u32 m0, s23, 7168
  s_add_u32 s20, s22, 479232
  buffer_load_dwordx4 v22, s[16:19], s20 offen lds
  s_add_u32 m0, s23, 8192
  s_add_u32 s20, s22, 917504
  buffer_load_dwordx4 v22, s[16:19], s20 offen lds
  s_add_u32 m0, s23, 9216
  s_add_u32 s20, s22, 933888
  buffer_load_dwordx4 v22, s[16:19], s20 offen lds
  s_add_u32 m0, s23, 10240
  s_add_u32 s20, s22, 921600
  buffer_load_dwordx4 v22, s[16:19], s20 offen lds
  s_add_u32 m0, s23, 11264
  s_add_u32 s20, s22, 937984
  buffer_load_dwordx4 v22, s[16:19], s20 offen lds
  s_add_u32 m0, s23, 12288
  s_add_u32 s20, s22, 983040
  buffer_load_dwordx4 v22, s[16:19], s20 offen lds
  s_add_u32 m0, s23, 13312
  s_add_u32 s20, s22, 999424
  buffer_load_dwordx4 v22, s[16:19], s20 offen lds
  s_add_u32 m0, s23, 14336
  s_add_u32 s20, s22, 987136
  buffer_load_dwordx4 v22, s[16:19], s20 offen lds
  s_add_u32 m0, s23, 15360
  s_add_u32 s20, s22, 1003520
  buffer_load_dwordx4 v22, s[16:19], s20 offen lds
  s_waitcnt vmcnt(0)
  s_barrier
  ds_read_b64_tr_b16 v[64:65], v2 offset:0
  ds_read_b64_tr_b16 v[66:67], v2 offset:4096
  ds_read_b64_tr_b16 v[68:69], v2 offset:8192
  ds_read_b64_tr_b16 v[70:71], v2 offset:12288
  ds_read_b64_tr_b16 v[72:73], v3 offset:0
  ds_read_b64_tr_b16 v[74:75], v3 offset:4096
  ds_read_b64_tr_b16 v[76:77], v3 offset:8192
  ds_read_b64_tr_b16 v[78:79], v3 offset:12288
  v_add_u32 v2, 0x4000, v2
  v_and_b32 v2, 0xffff, v2
  v_add_u32 v3, 0x4000, v3
  v_and_b32 v3, 0xffff, v3
  ds_read_b64_tr_b16 v[80:81], v2 offset:0
  ds_read_b64_tr_b16 v[82:83], v2 offset:4096
  ds_read_b64_tr_b16 v[84:85], v2 offset:8192
  ds_read_b64_tr_b16 v[86:87], v2 offset:12288
  ds_read_b64_tr_b16 v[88:89], v3 offset:0
  ds_read_b64_tr_b16 v[90:91], v3 offset:4096
  ds_read_b64_tr_b16 v[92:93], v3 offset:8192
  ds_read_b64_tr_b16 v[94:95], v3 offset:12288
  v_add_u32 v2, 0x4000, v2
  v_and_b32 v2, 0xffff, v2
  v_add_u32 v3, 0x4000, v3
  v_and_b32 v3, 0xffff, v3
  ds_read_b64_tr_b16 v[96:97], v2 offset:0
  ds_read_b64_tr_b16 v[98:99], v2 offset:4096
  ds_read_b64_tr_b16 v[100:101], v2 offset:8192
  ds_read_b64_tr_b16 v[102:103], v2 offset:12288
  ds_read_b64_tr_b16 v[104:105], v3 offset:0
  ds_read_b64_tr_b16 v[106:107], v3 offset:4096
  ds_read_b64_tr_b16 v[108:109], v3 offset:8192
  ds_read_b64_tr_b16 v[110:111], v3 offset:12288
  v_add_u32 v2, 0x4000, v2
  v_and_b32 v2, 0xffff, v2
  v_add_u32 v3, 0x4000, v3
  v_and_b32 v3, 0xffff, v3
  ds_read_b64_tr_b16 v[112:113], v2 offset:0
  ds_read_b64_tr_b16 v[114:115], v2 offset:4096
  ds_read_b64_tr_b16 v[116:117], v2 offset:8192
  ds_read_b64_tr_b16 v[118:119], v2 offset:12288
  ds_read_b64_tr_b16 v[120:121], v3 offset:0
  ds_read_b64_tr_b16 v[122:123], v3 offset:4096
  ds_read_b64_tr_b16 v[124:125], v3 offset:8192
  ds_read_b64_tr_b16 v[126:127], v3 offset:12288
  v_add_u32 v2, 0x4000, v2
  v_and_b32 v2, 0xffff, v2
  v_add_u32 v3, 0x4000, v3
  v_and_b32 v3, 0xffff, v3
  s_waitcnt lgkmcnt(0)
  s_barrier
  s_lshl_b32 s3, s27, 14
  v_add_u32 v2, s3, v0
  ds_write_b128 v2, v[64:67] offset:0
  ds_write_b128 v2, v[68:71] offset:1024
  ds_write_b128 v2, v[72:75] offset:2048
  ds_write_b128 v2, v[76:79] offset:3072
  ds_write_b128 v2, v[80:83] offset:4096
  ds_write_b128 v2, v[84:87] offset:5120
  ds_write_b128 v2, v[88:91] offset:6144
  ds_write_b128 v2, v[92:95] offset:7168
  ds_write_b128 v2, v[96:99] offset:8192
  ds_write_b128 v2, v[100:103] offset:9216
  ds_write_b128 v2, v[104:107] offset:10240
  ds_write_b128 v2, v[108:111] offset:11264
  ds_write_b128 v2, v[112:115] offset:12288
  ds_write_b128 v2, v[116:119] offset:13312
  ds_write_b128 v2, v[120:123] offset:14336
  ds_write_b128 v2, v[124:127] offset:15360
  s_waitcnt lgkmcnt(0)
  v_xor_b32 v18, 0, v8
  ds_read_b64_tr_b16 v[64:65], v18 offset:0
  ds_read_b64_tr_b16 v[66:67], v18 offset:2048
  ds_read_b64_tr_b16 v[68:69], v18 offset:4096
  ds_read_b64_tr_b16 v[70:71], v18 offset:6144
  v_xor_b32 v18, 32, v8
  ds_read_b64_tr_b16 v[72:73], v18 offset:0
  ds_read_b64_tr_b16 v[74:75], v18 offset:2048
  ds_read_b64_tr_b16 v[76:77], v18 offset:4096
  ds_read_b64_tr_b16 v[78:79], v18 offset:6144
  v_xor_b32 v18, 64, v8
  ds_read_b64_tr_b16 v[80:81], v18 offset:0
  ds_read_b64_tr_b16 v[82:83], v18 offset:2048
  ds_read_b64_tr_b16 v[84:85], v18 offset:4096
  ds_read_b64_tr_b16 v[86:87], v18 offset:6144
  v_xor_b32 v18, 96, v8
  ds_read_b64_tr_b16 v[88:89], v18 offset:0
  ds_read_b64_tr_b16 v[90:91], v18 offset:2048
  ds_read_b64_tr_b16 v[92:93], v18 offset:4096
  ds_read_b64_tr_b16 v[94:95], v18 offset:6144
  v_xor_b32 v18, 0, v8
  ds_read_b64_tr_b16 v[96:97], v18 offset:8192
  ds_read_b64_tr_b16 v[98:99], v18 offset:10240
  ds_read_b64_tr_b16 v[100:101], v18 offset:12288
  ds_read_b64_tr_b16 v[102:103], v18 offset:14336
  v_xor_b32 v18, 32, v8
  ds_read_b64_tr_b16 v[104:105], v18 offset:8192
  ds_read_b64_tr_b16 v[106:107], v18 offset:10240
  ds_read_b64_tr_b16 v[108:109], v18 offset:12288
  ds_read_b64_tr_b16 v[110:111], v18 offset:14336
  v_xor_b32 v18, 64, v8
  ds_read_b64_tr_b16 v[112:113], v18 offset:8192
  ds_read_b64_tr_b16 v[114:115], v18 offset:10240
  ds_read_b64_tr_b16 v[116:117], v18 offset:12288
  ds_read_b64_tr_b16 v[118:119], v18 offset:14336
  v_xor_b32 v18, 96, v8
  ds_read_b64_tr_b16 v[120:121], v18 offset:8192
  ds_read_b64_tr_b16 v[122:123], v18 offset:10240
  ds_read_b64_tr_b16 v[124:125], v18 offset:12288
  ds_read_b64_tr_b16 v[126:127], v18 offset:14336
  s_waitcnt lgkmcnt(0)
  v_add_u32 v8, s23, v0
  ds_write_b128 v8, v[64:67] offset:0
  ds_write_b128 v8, v[68:71] offset:1024
  ds_write_b128 v8, v[72:75] offset:2048
  ds_write_b128 v8, v[76:79] offset:3072
  ds_write_b128 v8, v[80:83] offset:4096
  ds_write_b128 v8, v[84:87] offset:5120
  ds_write_b128 v8, v[88:91] offset:6144
  ds_write_b128 v8, v[92:95] offset:7168
  ds_write_b128 v8, v[96:99] offset:8192
  ds_write_b128 v8, v[100:103] offset:9216
  ds_write_b128 v8, v[104:107] offset:10240
  ds_write_b128 v8, v[108:111] offset:11264
  ds_write_b128 v8, v[112:115] offset:12288
  ds_write_b128 v8, v[116:119] offset:13312
  ds_write_b128 v8, v[120:123] offset:14336
  ds_write_b128 v8, v[124:127] offset:15360
  s_waitcnt lgkmcnt(0)
  v_and_b32 v18, 8, v30
  v_cmp_eq_u32 vcc, 0, v18
  v_mov_b32 v1, 0xeeee
  v_mov_b32 v18, 0x4444
  v_cndmask_b32 v1, v1, v18, vcc
  s_add_u32 s3, s41, 131072
  v_add_u32 v5, s3, v0
  s_mov_b32 s51, 0x3f80
  s_mov_b32 s52, 0x3f800000
  s_lshl_b32 s53, s33, 11
  s_add_u32 s53, s53, 229376
  s_cmp_eq_u32 s27, 3
  s_cselect_b32 s20, 1, 0
  s_mov_b32 s21, 0
  s_mov_b32 s31, 0
  s_mov_b32 s32, 85983232
  s_mov_b32 s25, 86769664
  s_mov_b32 s26, 86245376
  s_lshl_b32 s3, s33, 14
  s_add_u32 s48, s3, s41
  s_xor_b32 s49, s48, 16384
  s_and_b32 s3, s49, 0x6000
  s_add_u32 s49, s49, s3
  s_add_u32 s48, s48, 65536
  s_lshl_b32 s50, s30, 11
  s_lshl_b32 s22, s33, 11
  s_add_u32 s22, s22, 233472
  s_barrier
  v_and_b32 v18, 31, v30
  v_lshlrev_b32 v6, 4, v18
  v_lshrrev_b32 v18, 5, v30
  v_lshl_add_u32 v6, v18, 3, v6
  s_lshl_b32 s3, s27, 9
  v_add_u32 v6, s3, v6
  v_bfe_u32 v18, v30, 3, 1
  v_lshlrev_b32 v11, 6, v18
  v_bfe_u32 v18, v30, 1, 1
  v_lshl_add_u32 v11, v18, 5, v11
  v_bfe_u32 v18, v30, 2, 1
  v_lshl_add_u32 v11, v18, 4, v11
  v_bfe_u32 v18, v30, 5, 1
  v_lshl_add_u32 v11, v18, 3, v11
  v_bfe_u32 v18, v30, 0, 1
  v_lshl_add_u32 v11, v18, 2, v11
  v_bfe_u32 v18, v30, 4, 1
  v_mul_u32_u24 v18, 640, v18
  v_add_u32 v11, v11, v18
  s_mul_i32 s3, s27, 1280
  s_add_u32 s3, s3, 147456
  v_add_u32 v11, s3, v11
  v_add_u32 v10, 5120, v11
  v_bfe_u32 v18, v30, 2, 3
  v_mul_u32_u24 v7, 160, v18
  v_lshrrev_b32 v18, 5, v30
  v_lshl_add_u32 v7, v18, 5, v7
  v_and_b32 v18, 3, v30
  v_lshl_add_u32 v7, v18, 3, v7
  s_mul_i32 s3, s28, 5120
  s_lshl_b32 s4, s29, 6
  s_add_u32 s3, s3, s4
  s_add_u32 s3, s3, 147456
  v_add_u32 v7, s3, v7
  s_lshl_b32 s35, s30, 10
  s_lshl_b32 s3, s27, 8
  v_lshlrev_b32 v13, 2, v30
  v_add_u32 v13, s3, v13
  s_and_b32 s3, s35, 0x6000
  s_add_u32 s46, s35, s3
  s_add_u32 s35, s35, 65536
  v_lshlrev_b32 v9, 2, v30
  v_lshlrev_b32 v12, 7, v30
  s_lshl_b32 s36, s33, 15
  s_lshl_b32 s3, s27, 13
  s_add_u32 s36, s36, s3
  s_add_u32 s36, s36, 98304
  s_and_b32 s3, s34, 15
  s_lshl_b32 s3, s3, 2
  s_add_u32 s24, s22, s3
  v_mov_b32 v24, 0xffbfffbf
  v_mov_b32 v25, 0xffbfffbf
  s_getpc_b64 s[4:5]
HS_43_pc:
  s_add_u32 s4, s4, CV1_top-HS_43_pc
  s_addc_u32 s5, s5, 0
  v_lshlrev_b32 v18, 2, v0
  v_add_u32 v18, s41, v18
  v_min_u32 v18, CV0_top-CV1_top-4, v18
  global_load_dword v19, v18, s[4:5]
  s_mov_b32 s40, 0
  s_lshl_b32 s7, s33, 3
HS_43:
  buffer_load_dwordx2 v[20:21], off, s[68:71], s7 offset:8 sc1
  buffer_load_dwordx2 v[22:23], off, s[68:71], 0 offset:128 sc1
  s_add_u32 s40, s40, 1
  s_cmp_gt_u32 s40, 65536
  s_cbranch_scc1 L_abort
  s_waitcnt vmcnt(0)
  v_readfirstlane_b32 s4, v20
  v_readfirstlane_b32 s5, v21
  v_readfirstlane_b32 s6, v22
  v_readfirstlane_b32 s3, v23
  s_cmp_eq_u32 s3, 0
  s_cbranch_scc1 HS_43_s
  s_cmp_eq_u32 s6, 0
  s_cbranch_scc1 HS_43_s
  s_add_u32 s3, s4, s5
  s_mul_i32 s3, s3, 0x01010101
  s_lshr_b32 s3, s3, 24
  s_cmp_eq_u32 s3, 32
  s_cbranch_scc1 HS_43_ok
HS_43_s:
  s_sleep 4
  s_branch HS_43
HS_43_ok:
  s_lshr_b64 s[4:5], s[4:5], s47
  s_and_b32 s4, s4, 0xff
  s_cmp_eq_u32 s4, 32
  s_cselect_b32 s37, 1, 0
  s_and_b32 s6, s6, 1
  s_lshl_b32 s6, s6, 13
  s_add_u32 s49, s49, s6
  s_xor_b32 s45, s33, 1
  s_lshl_b32 s45, s45, 7
  s_add_u32 s45, s45, s6
  s_add_u32 s45, s45, 246784
  s_sub_u32 s45, s45, s22
  v_mov_b32 v3, 0
  s_mul_i32 s54, s30, 1572864
  s_mul_i32 s3, s27, 6144
  s_add_u32 s54, s54, s3
  s_add_u32 s54, s54, 4194304
  s_add_u32 s46, s46, s6
  s_lshl_b32 s47, s33, 7
  s_add_u32 s47, s47, s6
  s_add_u32 s47, s47, 246784
  s_cmp_eq_u32 s34, 16
  s_cselect_b32 s38, s20, 0
  s_mov_b32 s39, 0
  s_mov_b32 s16, s8
  s_mov_b32 s17, s9
  s_cmp_lg_u32 s38, 0
  s_cselect_b32 s18, s10, 0
  s_add_u32 s3, s47, 85983232
  s_mov_b64 exec, s[38:39]
  buffer_store_dword v1, off, s[8:11], s3 sc1
  s_mov_b64 exec, -1
  s_add_u32 s3, s24, 85983232
  s_mov_b64 exec, s[20:21]
  buffer_store_dword v1, off, s[8:11], s3 sc1
  s_mov_b64 exec, -1
  s_cmp_eq_u32 s37, 0
  s_cbranch_scc1 CV0_top
  s_add_u32 s3, s50, 86147072
  buffer_load_dword v18, v6, s[8:11], s3 offen sc1
  s_add_u32 s3, s35, 85983232
  buffer_load_dword v18, v13, s[8:11], s3 offen sc1
  s_add_u32 s3, s24, 85983232
  buffer_load_dword v18, off, s[8:11], s3 sc1
  s_add_u32 s3, s50, 86409216
  buffer_load_dword v18, v6, s[8:11], s3 offen sc1
  s_add_u32 s3, s35, 86245376
  buffer_load_dword v18, v13, s[8:11], s3 offen sc1
  s_add_u32 s3, s24, 86245376
  buffer_load_dword v18, off, s[8:11], s3 sc1
  s_add_u32 s3, s50, 86671360
  buffer_load_dword v18, v6, s[8:11], s3 offen sc1
  s_add_u32 s3, s35, 86507520
  buffer_load_dword v18, v13, s[8:11], s3 offen sc1
  s_add_u32 s3, s24, 86507520
  buffer_load_dword v18, off, s[8:11], s3 sc1
  s_add_u32 s3, s50, 86933504
  buffer_load_dword v18, v6, s[8:11], s3 offen sc1
  s_add_u32 s3, s35, 86769664
  buffer_load_dword v18, v13, s[8:11], s3 offen sc1
  s_add_u32 s3, s24, 86769664
  buffer_load_dword v18, off, s[8:11], s3 sc1
  s_waitcnt vmcnt(0)
  s_add_u32 s3, s50, 86147072
  buffer_store_dwordx2 v[24:25], v6, s[8:11], s3 offen
  s_add_u32 s3, s50, 86409216
  buffer_store_dwordx2 v[24:25], v6, s[8:11], s3 offen
  s_add_u32 s3, s35, 86245376
  buffer_store_dword v24, v13, s[8:11], s3 offen
  s_add_u32 s3, s24, 86245376
  s_mov_b64 exec, s[20:21]
  buffer_store_dword v24, off, s[8:11], s3
  s_mov_b64 exec, -1
  s_add_u32 s3, s50, 86671360
  buffer_store_dwordx2 v[24:25], v6, s[8:11], s3 offen
  s_add_u32 s3, s35, 86507520
  buffer_store_dword v24, v13, s[8:11], s3 offen
  s_add_u32 s3, s24, 86507520
  s_mov_b64 exec, s[20:21]
  buffer_store_dword v24, off, s[8:11], s3
  s_mov_b64 exec, -1
  s_add_u32 s3, s50, 86933504
  buffer_store_dwordx2 v[24:25], v6, s[8:11], s3 offen
  s_add_u32 s3, s35, 86769664
  buffer_store_dword v24, v13, s[8:11], s3 offen
  s_add_u32 s3, s24, 86769664
  s_mov_b64 exec, s[20:21]
  buffer_store_dword v24, off, s[8:11], s3
  s_mov_b64 exec, -1
.p2align 6
CV1_top:
  s_mov_b32 s40, 0
  ds_read_b128 v[64:67], v2 offset:0
  ds_read_b128 v[68:71], v2 offset:1024
  ds_read_b128 v[72:75], v2 offset:2048
  ds_read_b128 v[76:79], v2 offset:3072
  v_mov_b64 v[16:17], 0
  v_mov_b64 v[18:19], 0
  v_mov_b64 v[20:21], 0
  v_mov_b64 v[22:23], 0
  v_add_u32 v4, 4096, v5
  v_and_b32 v4, 0x23fff, v4
  s_add_u32 s42, s32, s48
  s_add_u32 s43, s32, s49
  v_lshrrev_b32 v15, 2, v0
  s_add_u32 s3, s32, s22
  v_writelane_b32 v15, s45, 16
  s_nop 15
  s_nop 12
  buffer_load_dwordx4 v[96:99], v0, s[8:11], s43 offen offset:0 sc1
  buffer_load_dwordx4 v[100:103], v0, s[8:11], s43 offen offset:1024 sc1
  buffer_load_dwordx4 v[104:107], v0, s[8:11], s43 offen offset:2048 sc1
  buffer_load_dwordx4 v[108:111], v0, s[8:11], s43 offen offset:3072 sc1
  s_nop 8
  buffer_load_dwordx4 v[48:51], v0, s[8:11], s42 offen offset:0 sc1
  buffer_load_dwordx4 v[52:55], v0, s[8:11], s42 offen offset:1024 sc1
  buffer_load_dwordx4 v[56:59], v0, s[8:11], s42 offen offset:2048 sc1
  buffer_load_dwordx4 v[60:63], v0, s[8:11], s42 offen offset:3072 sc1
  s_waitcnt vmcnt(4)
Pa_45:
  v_max3_u32 v14, v96, v97, v98
  v_max3_u32 v15, v99, v100, v101
  v_max3_u32 v14, v14, v102, v103
  v_max3_u32 v15, v15, v104, v105
  v_max3_u32 v14, v14, v106, v107
  v_max3_u32 v15, v15, v108, v109
  v_max3_u32 v14, v14, v110, v111
  v_max_u32 v14, v14, v15
  v_cmp_eq_u32 vcc, 0xffbfffbf, v14
  s_cbranch_vccnz Pa_45_re
  v_lshlrev_b32 v80, 16, v96
  v_and_b32 v81, 0xffff0000, v96
  v_lshlrev_b32 v82, 16, v97
  v_and_b32 v83, 0xffff0000, v97
  v_lshlrev_b32 v84, 16, v98
  v_and_b32 v85, 0xffff0000, v98
  v_lshlrev_b32 v86, 16, v99
  v_and_b32 v87, 0xffff0000, v99
  v_lshlrev_b32 v88, 16, v100
  v_and_b32 v89, 0xffff0000, v100
  v_lshlrev_b32 v90, 16, v101
  v_and_b32 v91, 0xffff0000, v101
  v_lshlrev_b32 v92, 16, v102
  v_and_b32 v93, 0xffff0000, v102
  v_lshlrev_b32 v94, 16, v103
  v_and_b32 v95, 0xffff0000, v103
  v_lshlrev_b32 v96, 16, v104
  v_and_b32 v97, 0xffff0000, v104
  v_lshlrev_b32 v98, 16, v105
  v_and_b32 v99, 0xffff0000, v105
  v_lshlrev_b32 v100, 16, v106
  v_and_b32 v101, 0xffff0000, v106
  v_lshlrev_b32 v102, 16, v107
  v_and_b32 v103, 0xffff0000, v107
  v_lshlrev_b32 v104, 16, v108
  v_and_b32 v105, 0xffff0000, v108
  v_lshlrev_b32 v106, 16, v109
  v_and_b32 v107, 0xffff0000, v109
  v_lshlrev_b32 v108, 16, v110
  v_and_b32 v109, 0xffff0000, v110
  v_lshlrev_b32 v110, 16, v111
  v_and_b32 v111, 0xffff0000, v111
GA_44_u:
.p2align 3
  s_waitcnt vmcnt(3)
  s_nop 0
  v_dot2_f32_bf16 v120, v48, s51, v80
  v_dot2_f32_bf16 v121, v48, s52, v81
  v_dot2_f32_bf16 v122, v49, s51, v82
  v_dot2_f32_bf16 v123, v49, s52, v83
  v_dot2_f32_bf16 v124, v50, s51, v84
  v_dot2_f32_bf16 v125, v50, s52, v85
  v_dot2_f32_bf16 v126, v51, s51, v86
  v_dot2_f32_bf16 v127, v51, s52, v87
  v_max3_u32 v14, v48, v49, v49
  v_max3_u32 v14, v50, v51, v14
  v_cvt_pk_bf16_f32 v32, v120, v121
  v_cvt_pk_bf16_f32 v33, v122, v123
  v_cvt_pk_bf16_f32 v34, v124, v125
  v_cvt_pk_bf16_f32 v35, v126, v127
  ds_write_b128 v5, v[32:35] offset:0
  s_waitcnt vmcnt(2)
  s_nop 0
  v_dot2_f32_bf16 v120, v52, s51, v88
  v_dot2_f32_bf16 v121, v52, s52, v89
  v_dot2_f32_bf16 v122, v53, s51, v90
  v_dot2_f32_bf16 v123, v53, s52, v91
  v_dot2_f32_bf16 v124, v54, s51, v92
  v_dot2_f32_bf16 v125, v54, s52, v93
  v_dot2_f32_bf16 v126, v55, s51, v94
  v_dot2_f32_bf16 v127, v55, s52, v95
  v_max3_u32 v14, v52, v53, v14
  v_max3_u32 v14, v54, v55, v14
  v_cvt_pk_bf16_f32 v36, v120, v121
  v_cvt_pk_bf16_f32 v37, v122, v123
  v_cvt_pk_bf16_f32 v38, v124, v125
  v_cvt_pk_bf16_f32 v39, v126, v127
  ds_write_b128 v5, v[36:39] offset:1024
  s_waitcnt vmcnt(1)
  s_nop 0
  v_dot2_f32_bf16 v120, v56, s51, v96
  v_dot2_f32_bf16 v121, v56, s52, v97
  v_dot2_f32_bf16 v122, v57, s51, v98
  v_dot2_f32_bf16 v123, v57, s52, v99
  v_dot2_f32_bf16 v124, v58, s51, v100
  v_dot2_f32_bf16 v125, v58, s52, v101
  v_dot2_f32_bf16 v126, v59, s51, v102
  v_dot2_f32_bf16 v127, v59, s52, v103
  v_max3_u32 v14, v56, v57, v14
  v_max3_u32 v14, v58, v59, v14
  v_cvt_pk_bf16_f32 v40, v120, v121
  v_cvt_pk_bf16_f32 v41, v122, v123
  v_cvt_pk_bf16_f32 v42, v124, v125
  v_cvt_pk_bf16_f32 v43, v126, v127
  ds_write_b128 v5, v[40:43] offset:2048
  s_waitcnt vmcnt(0)
  s_nop 0
  v_dot2_f32_bf16 v120, v60, s51, v104
  v_dot2_f32_bf16 v121, v60, s52, v105
  v_dot2_f32_bf16 v122, v61, s51, v106
  v_dot2_f32_bf16 v123, v61, s52, v107
  v_dot2_f32_bf16 v124, v62, s51, v108
  v_dot2_f32_bf16 v125, v62, s52, v109
  v_dot2_f32_bf16 v126, v63, s51, v110
  v_dot2_f32_bf16 v127, v63, s52, v111
  v_max3_u32 v14, v60, v61, v14
  v_max3_u32 v14, v62, v63, v14
  v_cmp_eq_u32 vcc, 0xffbfffbf, v14
  v_cvt_pk_bf16_f32 v44, v120, v121
  v_cvt_pk_bf16_f32 v45, v122, v123
  v_cvt_pk_bf16_f32 v46, v124, v125
  v_cvt_pk_bf16_f32 v47, v126, v127
  ds_write_b128 v5, v[44:47] offset:3072
  s_cbranch_vccnz GA_44_re
  v_smfmac_f32_16x16x64_bf16 v[16:19], v[32:35], a[0:7], v1
  v_smfmac_f32_16x16x64_bf16 v[16:19], v[36:39], a[16:23], v1
  s_waitcnt lgkmcnt(0)
  s_barrier
  ds_read_b128 v[48:51], v4 offset:0
  ds_read_b128 v[52:55], v4 offset:1024
  v_smfmac_f32_16x16x64_bf16 v[16:19], v[40:43], a[32:39], v1
  ds_read_b128 v[56:59], v4 offset:2048
  ds_read_b128 v[60:63], v4 offset:3072
  v_smfmac_f32_16x16x64_bf16 v[16:19], v[44:47], v[64:71], v1
  ds_read_b128 v[64:67], v2 offset:4096
  v_add_u32 v4, 4096, v4
  v_and_b32 v4, 0x23fff, v4
  v_smfmac_f32_16x16x64_bf16 v[20:23], v[32:35], a[8:15], v1
  ds_read_b128 v[68:71], v2 offset:5120
  v_smfmac_f32_16x16x64_bf16 v[20:23], v[36:39], a[24:31], v1
  v_smfmac_f32_16x16x64_bf16 v[20:23], v[40:43], a[40:47], v1
  v_smfmac_f32_16x16x64_bf16 v[20:23], v[44:47], v[72:79], v1
  ds_read_b128 v[72:75], v2 offset:6144
  s_waitcnt lgkmcnt(3)
  v_smfmac_f32_16x16x64_bf16 v[16:19], v[48:51], a[48:55], v1
  ds_read_b128 v[76:79], v2 offset:7168
  ds_read_b128 v[32:35], v4 offset:0
  ds_read_b128 v[36:39], v4 offset:1024
  v_smfmac_f32_16x16x64_bf16 v[16:19], v[52:55], a[64:71], v1
  ds_read_b128 v[40:43], v4 offset:2048
  ds_read_b128 v[44:47], v4 offset:3072
  v_smfmac_f32_16x16x64_bf16 v[16:19], v[56:59], a[80:87], v1
  v_add_u32 v4, 4096, v4
  v_and_b32 v4, 0x23fff, v4
  s_waitcnt lgkmcnt(6)
  v_smfmac_f32_16x16x64_bf16 v[16:19], v[60:63], v[64:71], v1
  ds_read_b128 v[64:67], v2 offset:8192
  v_smfmac_f32_16x16x64_bf16 v[20:23], v[48:51], a[56:63], v1
  ds_read_b128 v[68:71], v2 offset:9216
  v_smfmac_f32_16x16x64_bf16 v[20:23], v[52:55], a[72:79], v1
  v_smfmac_f32_16x16x64_bf16 v[20:23], v[56:59], a[88:95], v1
  s_waitcnt lgkmcnt(6)
  v_smfmac_f32_16x16x64_bf16 v[20:23], v[60:63], v[72:79], v1
  ds_read_b128 v[72:75], v2 offset:10240
  s_waitcnt lgkmcnt(3)
  v_smfmac_f32_16x16x64_bf16 v[16:19], v[32:35], a[96:103], v1
  ds_read_b128 v[76:79], v2 offset:11264
  ds_read_b128 v[48:51], v4 offset:0
  ds_read_b128 v[52:55], v4 offset:1024
  v_smfmac_f32_16x16x64_bf16 v[16:19], v[36:39], a[112:119], v1
  ds_read_b128 v[56:59], v4 offset:2048
  ds_read_b128 v[60:63], v4 offset:3072
  v_smfmac_f32_16x16x64_bf16 v[16:19], v[40:43], a[128:135], v1
  s_waitcnt lgkmcnt(6)
  v_smfmac_f32_16x16x64_bf16 v[16:19], v[44:47], v[64:71], v1
  ds_read_b128 v[64:67], v2 offset:12288
  v_smfmac_f32_16x16x64_bf16 v[20:23], v[32:35], a[104:111], v1
  ds_read_b128 v[68:71], v2 offset:13312
  v_smfmac_f32_16x16x64_bf16 v[20:23], v[36:39], a[120:127], v1
  v_smfmac_f32_16x16x64_bf16 v[20:23], v[40:43], a[136:143], v1
  s_waitcnt lgkmcnt(6)
  v_smfmac_f32_16x16x64_bf16 v[20:23], v[44:47], v[72:79], v1
  ds_read_b128 v[72:75], v2 offset:14336
  s_waitcnt lgkmcnt(3)
  v_smfmac_f32_16x16x64_bf16 v[16:19], v[48:51], a[144:151], v1
  ds_read_b128 v[76:79], v2 offset:15360
  v_smfmac_f32_16x16x64_bf16 v[16:19], v[52:55], a[160:167], v1
  v_smfmac_f32_16x16x64_bf16 v[16:19], v[56:59], a[176:183], v1
  s_waitcnt lgkmcnt(2)
  v_smfmac_f32_16x16x64_bf16 v[16:19], v[60:63], v[64:71], v1
  v_smfmac_f32_16x16x64_bf16 v[20:23], v[48:51], a[152:159], v1
  v_smfmac_f32_16x16x64_bf16 v[20:23], v[52:55], a[168:175], v1
  v_smfmac_f32_16x16x64_bf16 v[20:23], v[56:59], a[184:191], v1
  s_waitcnt lgkmcnt(0)
  v_smfmac_f32_16x16x64_bf16 v[20:23], v[60:63], v[72:79], v1
  s_add_u32 s42, s32, s50
  s_add_u32 s42, s42, 163840
  v_mov_b64 v[24:25], 0
  v_mov_b64 v[26:27], 0
  v_mov_b64 v[28:29], 0
  v_mov_b64 v[30:31], 0
  s_nop 1
  v_permlane32_swap_b32 v16, v20
  v_permlane32_swap_b32 v17, v21
  v_permlane32_swap_b32 v18, v22
  v_permlane32_swap_b32 v19, v23
  v_pk_add_f32 v[16:17], v[16:17], v[20:21]
  v_pk_add_f32 v[18:19], v[18:19], v[22:23]
  v_cvt_pk_bf16_f32 v20, v16, v17
  v_cvt_pk_bf16_f32 v21, v18, v19
  buffer_store_dwordx2 v[20:21], v6, s[8:11], s42 offen
  s_cmp_eq_u32 s31, 63
  s_cbranch_scc1 CV1_end
  v_mov_b32 v22, 0xffbfffbf
  v_mov_b32 v23, 0xffbfffbf
  s_add_u32 s42, s25, s50
  s_add_u32 s42, s42, 163840
  s_add_u32 s43, s25, s35
  s_add_u32 s44, s25, s46
  s_add_u32 s3, s25, s24
  buffer_store_dword v22, v13, s[8:11], s44 offen sc1
  s_add_u32 s44, s25, s47
  s_mov_b64 exec, s[38:39]
  buffer_store_dword v22, off, s[8:11], s44 sc1
  s_mov_b64 exec, -1
  buffer_store_dwordx2 v[22:23], v6, s[8:11], s42 offen
  buffer_store_dword v22, v13, s[8:11], s43 offen
  s_mov_b64 exec, s[20:21]
  buffer_store_dword v22, off, s[8:11], s3
  s_mov_b64 exec, -1
  ds_read_b128 v[64:67], v8 offset:0
  ds_read_b128 v[68:71], v8 offset:1024
  ds_read_b128 v[72:75], v8 offset:2048
  ds_read_b128 v[76:79], v8 offset:3072
  ds_read_b128 v[80:83], v8 offset:4096
  ds_read_b128 v[84:87], v8 offset:5120
  ds_read_b128 v[88:91], v8 offset:6144
  ds_read_b128 v[92:95], v8 offset:7168
  ds_read_b128 v[96:99], v8 offset:8192
  ds_read_b128 v[100:103], v8 offset:9216
  ds_read_b128 v[104:107], v8 offset:10240
  ds_read_b128 v[108:111], v8 offset:11264
  ds_read_b128 v[112:115], v8 offset:12288
  ds_read_b128 v[116:119], v8 offset:13312
  ds_read_b128 v[120:123], v8 offset:14336
  ds_read_b128 v[124:127], v8 offset:15360
  v_mov_b64 v[16:17], 0
  v_mov_b64 v[18:19], 0
  v_mov_b64 v[20:21], 0
  v_mov_b64 v[22:23], 0
  v_mov_b64 v[24:25], 0
  v_mov_b64 v[26:27], 0
  v_mov_b64 v[28:29], 0
  v_mov_b64 v[30:31], 0
  s_add_u32 s42, s32, s36
  s_add_u32 s43, s42, 4096
  s_add_u32 s44, s32, s53
  s_waitcnt lgkmcnt(0)
  s_cmp_lg_u32 s27, 3
  s_cbranch_scc1 Qf_46_w
  buffer_load_dword v14, v9, s[8:11], s44 offen sc1
  s_nop 15
  buffer_load_dword v32, v9, s[8:11], s44 offen sc1
  s_nop 15
  buffer_load_dword v33, v9, s[8:11], s44 offen sc1
  s_nop 15
Qf_46:
  buffer_load_dword v34, v9, s[8:11], s44 offen sc1
  s_waitcnt vmcnt(3)
  v_cmp_eq_u32 vcc, 0xffbfffbf, v14
  s_cbranch_vccz Qf_46_ok
  buffer_load_dword v14, v9, s[8:11], s44 offen sc1
  s_waitcnt vmcnt(3)
  v_cmp_eq_u32 vcc, 0xffbfffbf, v32
  s_cbranch_vccz Qf_46_ok
  buffer_load_dword v32, v9, s[8:11], s44 offen sc1
  s_waitcnt vmcnt(3)
  v_cmp_eq_u32 vcc, 0xffbfffbf, v33
  s_cbranch_vccz Qf_46_ok
  buffer_load_dword v33, v9, s[8:11], s44 offen sc1
  s_waitcnt vmcnt(3)
  v_cmp_eq_u32 vcc, 0xffbfffbf, v34
  s_cbranch_vccz Qf_46_ok
  s_add_u32 s40, s40, 1
  s_cmp_gt_u32 s40, 65536
  s_cbranch_scc1 L_abort
  s_branch Qf_46
Qf_46_ok:
Qf_46_w:
  s_barrier
  buffer_load_dwordx4 v[32:35], v0, s[8:11], s42 offen offset:0 sc1
  s_nop 8
  buffer_load_dwordx4 v[36:39], v0, s[8:11], s42 offen offset:1024 sc1
  s_nop 8
  buffer_load_dwordx4 v[40:43], v0, s[8:11], s42 offen offset:2048 sc1
  s_nop 8
  buffer_load_dwordx4 v[44:47], v0, s[8:11], s42 offen offset:3072 sc1
  s_nop 8
  buffer_load_dwordx4 v[48:51], v0, s[8:11], s43 offen offset:0 sc1
  s_waitcnt vmcnt(4)
  v_max3_u32 v14, v32, v33, v34
  v_max_u32 v14, v14, v35
  v_cmp_eq_u32 vcc, 0xffbfffbf, v14
  s_cbranch_vccnz CV1_f0
CV1_b0:
  s_add_u32 s44, s26, s24
  s_add_u32 s3, s26, s47
  v_smfmac_f32_16x16x64_bf16 v[16:19], v[32:35], a[192:199], v1
  buffer_load_dwordx4 v[52:55], v0, s[8:11], s43 offen offset:1024 sc1
  v_smfmac_f32_16x16x64_bf16 v[20:23], v[32:35], a[200:207], v1
  s_waitcnt vmcnt(4)
  v_max3_u32 v14, v36, v37, v38
  v_smfmac_f32_16x16x64_bf16 v[24:27], v[32:35], a[208:215], v1
  v_max_u32 v14, v14, v39
  v_cmp_eq_u32 vcc, 0xffbfffbf, v14
  v_smfmac_f32_16x16x64_bf16 v[28:31], v[32:35], a[216:223], v1
  s_cbranch_vccnz CV1_f1
CV1_b1:
  v_smfmac_f32_16x16x64_bf16 v[16:19], v[36:39], a[224:231], v1
  buffer_load_dwordx4 v[56:59], v0, s[8:11], s43 offen offset:2048 sc1
  v_smfmac_f32_16x16x64_bf16 v[20:23], v[36:39], a[232:239], v1
  s_waitcnt vmcnt(4)
  v_max3_u32 v14, v40, v41, v42
  v_smfmac_f32_16x16x64_bf16 v[24:27], v[36:39], a[240:247], v1
  v_max_u32 v14, v14, v43
  v_cmp_eq_u32 vcc, 0xffbfffbf, v14
  v_smfmac_f32_16x16x64_bf16 v[28:31], v[36:39], a[248:255], v1
  s_cbranch_vccnz CV1_f2
CV1_b2:
  v_smfmac_f32_16x16x64_bf16 v[16:19], v[40:43], v[128:135], v1
  buffer_load_dwordx4 v[60:63], v0, s[8:11], s43 offen offset:3072 sc1
  v_smfmac_f32_16x16x64_bf16 v[20:23], v[40:43], v[136:143], v1
  s_waitcnt vmcnt(4)
  v_max3_u32 v14, v44, v45, v46
  v_smfmac_f32_16x16x64_bf16 v[24:27], v[40:43], v[144:151], v1
  v_max_u32 v14, v14, v47
  v_cmp_eq_u32 vcc, 0xffbfffbf, v14
  v_smfmac_f32_16x16x64_bf16 v[28:31], v[40:43], v[152:159], v1
  s_cbranch_vccnz CV1_f3
CV1_b3:
  v_smfmac_f32_16x16x64_bf16 v[16:19], v[44:47], v[64:71], v1
  v_smfmac_f32_16x16x64_bf16 v[20:23], v[44:47], v[72:79], v1
  s_waitcnt vmcnt(3)
  v_max3_u32 v14, v48, v49, v50
  v_smfmac_f32_16x16x64_bf16 v[24:27], v[44:47], v[80:87], v1
  v_max_u32 v14, v14, v51
  v_cmp_eq_u32 vcc, 0xffbfffbf, v14
  v_smfmac_f32_16x16x64_bf16 v[28:31], v[44:47], v[88:95], v1
  s_cbranch_vccnz CV1_f4
CV1_b4:
  v_smfmac_f32_16x16x64_bf16 v[16:19], v[48:51], v[160:167], v1
  v_smfmac_f32_16x16x64_bf16 v[20:23], v[48:51], v[168:175], v1
  s_waitcnt vmcnt(2)
  v_max3_u32 v14, v52, v53, v54
  v_smfmac_f32_16x16x64_bf16 v[24:27], v[48:51], v[176:183], v1
  v_max_u32 v14, v14, v55
  v_cmp_eq_u32 vcc, 0xffbfffbf, v14
  v_smfmac_f32_16x16x64_bf16 v[28:31], v[48:51], v[184:191], v1
  s_cbranch_vccnz CV1_f5
CV1_b5:
  v_smfmac_f32_16x16x64_bf16 v[16:19], v[52:55], v[192:199], v1
  s_mov_b64 exec, 1
  buffer_store_dword v1, off, s[16:19], s3 sc1
  s_mov_b64 exec, -1
  v_smfmac_f32_16x16x64_bf16 v[20:23], v[52:55], v[200:207], v1
  s_waitcnt vmcnt(2)
  v_max3_u32 v14, v56, v57, v58
  v_smfmac_f32_16x16x64_bf16 v[24:27], v[52:55], v[208:215], v1
  v_max_u32 v14, v14, v59
  v_cmp_eq_u32 vcc, 0xffbfffbf, v14
  v_smfmac_f32_16x16x64_bf16 v[28:31], v[52:55], v[216:223], v1
  s_cbranch_vccnz CV1_f6
CV1_b6:
  v_smfmac_f32_16x16x64_bf16 v[16:19], v[56:59], v[224:231], v1
  s_waitcnt vmcnt(1)
  v_max3_u32 v14, v60, v61, v62
  v_smfmac_f32_16x16x64_bf16 v[20:23], v[56:59], v[232:239], v1
  v_max_u32 v14, v14, v63
  v_cmp_eq_u32 vcc, 0xffbfffbf, v14
  v_smfmac_f32_16x16x64_bf16 v[24:27], v[56:59], v[240:247], v1
  s_cbranch_vccnz CV1_f7
CV1_b7:
  v_smfmac_f32_16x16x64_bf16 v[16:19], v[60:63], v[96:103], v1
  v_smfmac_f32_16x16x64_bf16 v[20:23], v[60:63], v[104:111], v1
  s_add_u32 s31, s31, 1
  s_add_u32 s42, s26, s46
  v_smfmac_f32_16x16x64_bf16 v[28:31], v[56:59], v[248:255], v1
  s_add_u32 s43, s26, s35
  v_mov_b32 v15, 0
  v_smfmac_f32_16x16x64_bf16 v[24:27], v[60:63], v[112:119], v1
  v_mov_b32 v15, 0
  v_smfmac_f32_16x16x64_bf16 v[28:31], v[60:63], v[120:127], v1
  v_permlane32_swap_b32 v16, v20
  v_permlane32_swap_b32 v17, v21
  v_permlane32_swap_b32 v18, v22
  v_permlane32_swap_b32 v19, v23
  v_pk_add_f32 v[16:17], v[16:17], v[20:21]
  v_pk_add_f32 v[18:19], v[18:19], v[22:23]
  ds_write2_b32 v11, v16, v17 offset0:0 offset1:40
  ds_write2_b32 v11, v18, v19 offset0:80 offset1:120
  v_permlane32_swap_b32 v24, v28
  v_permlane32_swap_b32 v25, v29
  v_permlane32_swap_b32 v26, v30
  v_permlane32_swap_b32 v27, v31
  v_pk_add_f32 v[24:25], v[24:25], v[28:29]
  v_pk_add_f32 v[26:27], v[26:27], v[30:31]
  ds_write2_b32 v10, v24, v25 offset0:0 offset1:40
  ds_write2_b32 v10, v26, v27 offset0:80 offset1:120
  s_mov_b64 exec, s[20:21]
  buffer_store_dword v1, off, s[8:11], s44
  s_mov_b64 exec, -1
  s_waitcnt lgkmcnt(0)
  s_barrier
  ds_read_b64 v[36:37], v7 offset:0
  ds_read_b64 v[38:39], v7 offset:1280
  ds_read_b64 v[40:41], v7 offset:2560
  ds_read_b64 v[42:43], v7 offset:3840
  s_waitcnt lgkmcnt(2)
  v_pk_add_f32 v[36:37], v[36:37], v[38:39]
  s_waitcnt lgkmcnt(0)
  v_pk_add_f32 v[40:41], v[40:41], v[42:43]
  v_pk_add_f32 v[36:37], v[36:37], v[40:41]
  v_cvt_pk_bf16_f32 v24, v36, v37
  buffer_store_dword v24, v13, s[8:11], s43 offen
  s_nop 8
  buffer_store_dword v24, v13, s[8:11], s42 offen sc1
  s_mov_b32 s25, s32
  s_mov_b32 s32, s26
  s_add_u32 s26, s26, 262144
  s_and_b32 s26, s26, 0xfffff
  s_or_b32 s26, s26, 85983232
  s_branch CV1_top
CV1_f0:
  s_waitcnt vmcnt(0)
Po_47:
  v_max3_u32 v14, v32, v33, v34
  v_max3_u32 v15, v35, v36, v37
  v_max3_u32 v14, v14, v38, v39
  v_max3_u32 v15, v15, v40, v41
  v_max3_u32 v14, v14, v42, v43
  v_max3_u32 v15, v15, v44, v45
  v_max3_u32 v14, v14, v46, v47
  v_max3_u32 v15, v15, v48, v49
  v_max3_u32 v14, v14, v50, v51
  v_max_u32 v14, v14, v15
  v_cmp_eq_u32 vcc, 0xffbfffbf, v14
  s_cbranch_vccnz Po_47_re
  s_branch CV1_b0
CV1_f1:
  s_waitcnt vmcnt(0)
Po_48:
  v_max3_u32 v14, v36, v37, v38
  v_max3_u32 v15, v39, v40, v41
  v_max3_u32 v14, v14, v42, v43
  v_max3_u32 v15, v15, v44, v45
  v_max3_u32 v14, v14, v46, v47
  v_max3_u32 v15, v15, v48, v49
  v_max3_u32 v14, v14, v50, v51
  v_max3_u32 v15, v15, v52, v53
  v_max3_u32 v14, v14, v54, v55
  v_max_u32 v14, v14, v15
  v_cmp_eq_u32 vcc, 0xffbfffbf, v14
  s_cbranch_vccnz Po_48_re
  s_branch CV1_b1
CV1_f2:
  s_waitcnt vmcnt(0)
Po_49:
  v_max3_u32 v14, v40, v41, v42
  v_max3_u32 v15, v43, v44, v45
  v_max3_u32 v14, v14, v46, v47
  v_max3_u32 v15, v15, v48, v49
  v_max3_u32 v14, v14, v50, v51
  v_max3_u32 v15, v15, v52, v53
  v_max3_u32 v14, v14, v54, v55
  v_max3_u32 v15, v15, v56, v57
  v_max3_u32 v14, v14, v58, v59
  v_max_u32 v14, v14, v15
  v_cmp_eq_u32 vcc, 0xffbfffbf, v14
  s_cbranch_vccnz Po_49_re
  s_branch CV1_b2
CV1_f3:
  s_waitcnt vmcnt(0)
Po_50:
  v_max3_u32 v14, v44, v45, v46
  v_max3_u32 v15, v47, v48, v49
  v_max3_u32 v14, v14, v50, v51
  v_max3_u32 v15, v15, v52, v53
  v_max3_u32 v14, v14, v54, v55
  v_max3_u32 v15, v15, v56, v57
  v_max3_u32 v14, v14, v58, v59
  v_max3_u32 v15, v15, v60, v61
  v_max3_u32 v14, v14, v62, v63
  v_max_u32 v14, v14, v15
  v_cmp_eq_u32 vcc, 0xffbfffbf, v14
  s_cbranch_vccnz Po_50_re
  s_branch CV1_b3
CV1_f4:
  s_waitcnt vmcnt(0)
Po_51:
  v_max3_u32 v14, v48, v49, v50
  v_max3_u32 v15, v51, v52, v53
  v_max3_u32 v14, v14, v54, v55
  v_max3_u32 v15, v15, v56, v57
  v_max3_u32 v14, v14, v58, v59
  v_max3_u32 v15, v15, v60, v61
  v_max3_u32 v14, v14, v62, v63
  v_max_u32 v14, v14, v15
  v_cmp_eq_u32 vcc, 0xffbfffbf, v14
  s_cbranch_vccnz Po_51_re
  s_branch CV1_b4
CV1_f5:
  s_waitcnt vmcnt(0)
Po_52:
  v_max3_u32 v14, v52, v53, v54
  v_max3_u32 v15, v55, v56, v57
  v_max3_u32 v14, v14, v58, v59
  v_max3_u32 v15, v15, v60, v61
  v_max3_u32 v14, v14, v62, v63
  v_max_u32 v14, v14, v15
  v_cmp_eq_u32 vcc, 0xffbfffbf, v14
  s_cbranch_vccnz Po_52_re
  s_branch CV1_b5
CV1_f6:
  s_waitcnt vmcnt(0)
Po_53:
  v_max3_u32 v14, v56, v57, v58
  v_max3_u32 v15, v59, v60, v61
  v_max3_u32 v14, v14, v62, v63
  v_max_u32 v14, v14, v15
  v_cmp_eq_u32 vcc, 0xffbfffbf, v14
  s_cbranch_vccnz Po_53_re
  s_branch CV1_b6
CV1_f7:
  s_waitcnt vmcnt(0)
Po_54:
  v_max3_u32 v14, v60, v61, v62
  v_max_u32 v14, v14, v63
  v_cmp_eq_u32 vcc, 0xffbfffbf, v14
  s_cbranch_vccnz Po_54_re
  s_branch CV1_b7
Pa_45_re:
  s_add_u32 s40, s40, 1
  s_cmp_gt_u32 s40, 65536
  s_cbranch_scc1 L_abort
  s_mov_b64 exec, vcc
  buffer_load_dwordx4 v[96:99], v0, s[8:11], s43 offen offset:0 sc1
  buffer_load_dwordx4 v[100:103], v0, s[8:11], s43 offen offset:1024 sc1
  buffer_load_dwordx4 v[104:107], v0, s[8:11], s43 offen offset:2048 sc1
  buffer_load_dwordx4 v[108:111], v0, s[8:11], s43 offen offset:3072 sc1
  s_mov_b64 exec, -1
  s_waitcnt vmcnt(0)
  s_branch Pa_45
GA_44_re:
  s_add_u32 s40, s40, 1
  s_cmp_gt_u32 s40, 65536
  s_cbranch_scc1 L_abort
  s_mov_b64 exec, vcc
  buffer_load_dwordx4 v[48:51], v0, s[8:11], s42 offen offset:0 sc1
  buffer_load_dwordx4 v[52:55], v0, s[8:11], s42 offen offset:1024 sc1
  buffer_load_dwordx4 v[56:59], v0, s[8:11], s42 offen offset:2048 sc1
  buffer_load_dwordx4 v[60:63], v0, s[8:11], s42 offen offset:3072 sc1
  s_mov_b64 exec, -1
  s_branch GA_44_u
CV1_end:
  s_endpgm
Po_47_re:
  s_add_u32 s40, s40, 1
  s_cmp_gt_u32 s40, 65536
  s_cbranch_scc1 L_abort
  s_mov_b64 exec, vcc
  buffer_load_dwordx4 v[32:35], v0, s[8:11], s42 offen offset:0 sc1
  buffer_load_dwordx4 v[36:39], v0, s[8:11], s42 offen offset:1024 sc1
  buffer_load_dwordx4 v[40:43], v0, s[8:11], s42 offen offset:2048 sc1
  buffer_load_dwordx4 v[44:47], v0, s[8:11], s42 offen offset:3072 sc1
  buffer_load_dwordx4 v[48:51], v0, s[8:11], s43 offen offset:0 sc1
  s_mov_b64 exec, -1
  s_waitcnt vmcnt(0)
  s_branch Po_47
Po_48_re:
  s_add_u32 s40, s40, 1
  s_cmp_gt_u32 s40, 65536
  s_cbranch_scc1 L_abort
  s_mov_b64 exec, vcc
  buffer_load_dwordx4 v[36:39], v0, s[8:11], s42 offen offset:1024 sc1
  buffer_load_dwordx4 v[40:43], v0, s[8:11], s42 offen offset:2048 sc1
  buffer_load_dwordx4 v[44:47], v0, s[8:11], s42 offen offset:3072 sc1
  buffer_load_dwordx4 v[48:51], v0, s[8:11], s43 offen offset:0 sc1
  buffer_load_dwordx4 v[52:55], v0, s[8:11], s43 offen offset:1024 sc1
  s_mov_b64 exec, -1
  s_waitcnt vmcnt(0)
  s_branch Po_48
Po_49_re:
  s_add_u32 s40, s40, 1
  s_cmp_gt_u32 s40, 65536
  s_cbranch_scc1 L_abort
  s_mov_b64 exec, vcc
  buffer_load_dwordx4 v[40:43], v0, s[8:11], s42 offen offset:2048 sc1
  buffer_load_dwordx4 v[44:47], v0, s[8:11], s42 offen offset:3072 sc1
  buffer_load_dwordx4 v[48:51], v0, s[8:11], s43 offen offset:0 sc1
  buffer_load_dwordx4 v[52:55], v0, s[8:11], s43 offen offset:1024 sc1
  buffer_load_dwordx4 v[56:59], v0, s[8:11], s43 offen offset:2048 sc1
  s_mov_b64 exec, -1
  s_waitcnt vmcnt(0)
  s_branch Po_49
Po_50_re:
  s_add_u32 s40, s40, 1
  s_cmp_gt_u32 s40, 65536
  s_cbranch_scc1 L_abort
  s_mov_b64 exec, vcc
  buffer_load_dwordx4 v[44:47], v0, s[8:11], s42 offen offset:3072 sc1
  buffer_load_dwordx4 v[48:51], v0, s[8:11], s43 offen offset:0 sc1
  buffer_load_dwordx4 v[52:55], v0, s[8:11], s43 offen offset:1024 sc1
  buffer_load_dwordx4 v[56:59], v0, s[8:11], s43 offen offset:2048 sc1
  buffer_load_dwordx4 v[60:63], v0, s[8:11], s43 offen offset:3072 sc1
  s_mov_b64 exec, -1
  s_waitcnt vmcnt(0)
  s_branch Po_50
Po_51_re:
  s_add_u32 s40, s40, 1
  s_cmp_gt_u32 s40, 65536
  s_cbranch_scc1 L_abort
  s_mov_b64 exec, vcc
  buffer_load_dwordx4 v[48:51], v0, s[8:11], s43 offen offset:0 sc1
  buffer_load_dwordx4 v[52:55], v0, s[8:11], s43 offen offset:1024 sc1
  buffer_load_dwordx4 v[56:59], v0, s[8:11], s43 offen offset:2048 sc1
  buffer_load_dwordx4 v[60:63], v0, s[8:11], s43 offen offset:3072 sc1
  s_mov_b64 exec, -1
  s_waitcnt vmcnt(0)
  s_branch Po_51
Po_52_re:
  s_add_u32 s40, s40, 1
  s_cmp_gt_u32 s40, 65536
  s_cbranch_scc1 L_abort
  s_mov_b64 exec, vcc
  buffer_load_dwordx4 v[52:55], v0, s[8:11], s43 offen offset:1024 sc1
  buffer_load_dwordx4 v[56:59], v0, s[8:11], s43 offen offset:2048 sc1
  buffer_load_dwordx4 v[60:63], v0, s[8:11], s43 offen offset:3072 sc1
  s_mov_b64 exec, -1
  s_waitcnt vmcnt(0)
  s_branch Po_52
Po_53_re:
  s_add_u32 s40, s40, 1
  s_cmp_gt_u32 s40, 65536
  s_cbranch_scc1 L_abort
  s_mov_b64 exec, vcc
  buffer_load_dwordx4 v[56:59], v0, s[8:11], s43 offen offset:2048 sc1
  buffer_load_dwordx4 v[60:63], v0, s[8:11], s43 offen offset:3072 sc1
  s_mov_b64 exec, -1
  s_waitcnt vmcnt(0)
  s_branch Po_53
Po_54_re:
  s_add_u32 s40, s40, 1
  s_cmp_gt_u32 s40, 65536
  s_cbranch_scc1 L_abort
  s_mov_b64 exec, vcc
  buffer_load_dwordx4 v[60:63], v0, s[8:11], s43 offen offset:3072 sc1
  s_mov_b64 exec, -1
  s_waitcnt vmcnt(0)
  s_branch Po_54
.p2align 6
CV0_top:
  s_mov_b32 s40, 0
  ds_read_b128 v[64:67], v2 offset:0
  ds_read_b128 v[68:71], v2 offset:1024
  ds_read_b128 v[72:75], v2 offset:2048
  ds_read_b128 v[76:79], v2 offset:3072
  v_mov_b64 v[16:17], 0
  v_mov_b64 v[18:19], 0
  v_mov_b64 v[20:21], 0
  v_mov_b64 v[22:23], 0
  v_add_u32 v4, 4096, v5
  v_and_b32 v4, 0x23fff, v4
  s_add_u32 s42, s32, s48
  s_add_u32 s43, s32, s49
  v_lshrrev_b32 v15, 2, v0
  s_add_u32 s3, s32, s22
  v_writelane_b32 v15, s45, 16
  s_nop 15
  s_nop 12
  buffer_load_dwordx4 v[96:99], v0, s[8:11], s43 offen offset:0 sc1
  buffer_load_dwordx4 v[100:103], v0, s[8:11], s43 offen offset:1024 sc1
  buffer_load_dwordx4 v[104:107], v0, s[8:11], s43 offen offset:2048 sc1
  buffer_load_dwordx4 v[108:111], v0, s[8:11], s43 offen offset:3072 sc1
  s_nop 8
  buffer_load_dwordx4 v[48:51], v0, s[8:11], s42 offen offset:0 sc1
  buffer_load_dwordx4 v[52:55], v0, s[8:11], s42 offen offset:1024 sc1
  buffer_load_dwordx4 v[56:59], v0, s[8:11], s42 offen offset:2048 sc1
  buffer_load_dwordx4 v[60:63], v0, s[8:11], s42 offen offset:3072 sc1
  s_waitcnt vmcnt(4)
Pa_56:
  v_max3_u32 v14, v96, v97, v98
  v_max3_u32 v15, v99, v100, v101
  v_max3_u32 v14, v14, v102, v103
  v_max3_u32 v15, v15, v104, v105
  v_max3_u32 v14, v14, v106, v107
  v_max3_u32 v15, v15, v108, v109
  v_max3_u32 v14, v14, v110, v111
  v_max_u32 v14, v14, v15
  v_cmp_eq_u32 vcc, 0xffbfffbf, v14
  s_cbranch_vccnz Pa_56_re
  v_lshlrev_b32 v80, 16, v96
  v_and_b32 v81, 0xffff0000, v96
  v_lshlrev_b32 v82, 16, v97
  v_and_b32 v83, 0xffff0000, v97
  v_lshlrev_b32 v84, 16, v98
  v_and_b32 v85, 0xffff0000, v98
  v_lshlrev_b32 v86, 16, v99
  v_and_b32 v87, 0xffff0000, v99
  v_lshlrev_b32 v88, 16, v100
  v_and_b32 v89, 0xffff0000, v100
  v_lshlrev_b32 v90, 16, v101
  v_and_b32 v91, 0xffff0000, v101
  v_lshlrev_b32 v92, 16, v102
  v_and_b32 v93, 0xffff0000, v102
  v_lshlrev_b32 v94, 16, v103
  v_and_b32 v95, 0xffff0000, v103
  v_lshlrev_b32 v96, 16, v104
  v_and_b32 v97, 0xffff0000, v104
  v_lshlrev_b32 v98, 16, v105
  v_and_b32 v99, 0xffff0000, v105
  v_lshlrev_b32 v100, 16, v106
  v_and_b32 v101, 0xffff0000, v106
  v_lshlrev_b32 v102, 16, v107
  v_and_b32 v103, 0xffff0000, v107
  v_lshlrev_b32 v104, 16, v108
  v_and_b32 v105, 0xffff0000, v108
  v_lshlrev_b32 v106, 16, v109
  v_and_b32 v107, 0xffff0000, v109
  v_lshlrev_b32 v108, 16, v110
  v_and_b32 v109, 0xffff0000, v110
  v_lshlrev_b32 v110, 16, v111
  v_and_b32 v111, 0xffff0000, v111
GA_55_u:
.p2align 3
  s_waitcnt vmcnt(3)
  s_nop 0
  v_dot2_f32_bf16 v120, v48, s51, v80
  v_dot2_f32_bf16 v121, v48, s52, v81
  v_dot2_f32_bf16 v122, v49, s51, v82
  v_dot2_f32_bf16 v123, v49, s52, v83
  v_dot2_f32_bf16 v124, v50, s51, v84
  v_dot2_f32_bf16 v125, v50, s52, v85
  v_dot2_f32_bf16 v126, v51, s51, v86
  v_dot2_f32_bf16 v127, v51, s52, v87
  v_max3_u32 v14, v48, v49, v49
  v_max3_u32 v14, v50, v51, v14
  v_cvt_pk_bf16_f32 v32, v120, v121
  v_cvt_pk_bf16_f32 v33, v122, v123
  v_cvt_pk_bf16_f32 v34, v124, v125
  v_cvt_pk_bf16_f32 v35, v126, v127
  ds_write_b128 v5, v[32:35] offset:0
  s_waitcnt vmcnt(2)
  s_nop 0
  v_dot2_f32_bf16 v120, v52, s51, v88
  v_dot2_f32_bf16 v121, v52, s52, v89
  v_dot2_f32_bf16 v122, v53, s51, v90
  v_dot2_f32_bf16 v123, v53, s52, v91
  v_dot2_f32_bf16 v124, v54, s51, v92
  v_dot2_f32_bf16 v125, v54, s52, v93
  v_dot2_f32_bf16 v126, v55, s51, v94
  v_dot2_f32_bf16 v127, v55, s52, v95
  v_max3_u32 v14, v52, v53, v14
  v_max3_u32 v14, v54, v55, v14
  v_cvt_pk_bf16_f32 v36, v120, v121
  v_cvt_pk_bf16_f32 v37, v122, v123
  v_cvt_pk_bf16_f32 v38, v124, v125
  v_cvt_pk_bf16_f32 v39, v126, v127
  ds_write_b128 v5, v[36:39] offset:1024
  s_waitcnt vmcnt(1)
  s_nop 0
  v_dot2_f32_bf16 v120, v56, s51, v96
  v_dot2_f32_bf16 v121, v56, s52, v97
  v_dot2_f32_bf16 v122, v57, s51, v98
  v_dot2_f32_bf16 v123, v57, s52, v99
  v_dot2_f32_bf16 v124, v58, s51, v100
  v_dot2_f32_bf16 v125, v58, s52, v101
  v_dot2_f32_bf16 v126, v59, s51, v102
  v_dot2_f32_bf16 v127, v59, s52, v103
  v_max3_u32 v14, v56, v57, v14
  v_max3_u32 v14, v58, v59, v14
  v_cvt_pk_bf16_f32 v40, v120, v121
  v_cvt_pk_bf16_f32 v41, v122, v123
  v_cvt_pk_bf16_f32 v42, v124, v125
  v_cvt_pk_bf16_f32 v43, v126, v127
  ds_write_b128 v5, v[40:43] offset:2048
  s_waitcnt vmcnt(0)
  s_nop 0
  v_dot2_f32_bf16 v120, v60, s51, v104
  v_dot2_f32_bf16 v121, v60, s52, v105
  v_dot2_f32_bf16 v122, v61, s51, v106
  v_dot2_f32_bf16 v123, v61, s52, v107
  v_dot2_f32_bf16 v124, v62, s51, v108
  v_dot2_f32_bf16 v125, v62, s52, v109
  v_dot2_f32_bf16 v126, v63, s51, v110
  v_dot2_f32_bf16 v127, v63, s52, v111
  v_max3_u32 v14, v60, v61, v14
  v_max3_u32 v14, v62, v63, v14
  v_cmp_eq_u32 vcc, 0xffbfffbf, v14
  v_cvt_pk_bf16_f32 v44, v120, v121
  v_cvt_pk_bf16_f32 v45, v122, v123
  v_cvt_pk_bf16_f32 v46, v124, v125
  v_cvt_pk_bf16_f32 v47, v126, v127
  ds_write_b128 v5, v[44:47] offset:3072
  s_cbranch_vccnz GA_55_re
  v_smfmac_f32_16x16x64_bf16 v[16:19], v[32:35], a[0:7], v1
  v_smfmac_f32_16x16x64_bf16 v[16:19], v[36:39], a[16:23], v1
  s_waitcnt lgkmcnt(0)
  s_barrier
  ds_read_b128 v[48:51], v4 offset:0
  ds_read_b128 v[52:55], v4 offset:1024
  v_smfmac_f32_16x16x64_bf16 v[16:19], v[40:43], a[32:39], v1
  ds_read_b128 v[56:59], v4 offset:2048
  ds_read_b128 v[60:63], v4 offset:3072
  v_smfmac_f32_16x16x64_bf16 v[16:19], v[44:47], v[64:71], v1
  ds_read_b128 v[64:67], v2 offset:4096
  v_add_u32 v4, 4096, v4
  v_and_b32 v4, 0x23fff, v4
  v_smfmac_f32_16x16x64_bf16 v[20:23], v[32:35], a[8:15], v1
  ds_read_b128 v[68:71], v2 offset:5120
  v_smfmac_f32_16x16x64_bf16 v[20:23], v[36:39], a[24:31], v1
  v_smfmac_f32_16x16x64_bf16 v[20:23], v[40:43], a[40:47], v1
  v_smfmac_f32_16x16x64_bf16 v[20:23], v[44:47], v[72:79], v1
  ds_read_b128 v[72:75], v2 offset:6144
  s_waitcnt lgkmcnt(3)
  v_smfmac_f32_16x16x64_bf16 v[16:19], v[48:51], a[48:55], v1
  ds_read_b128 v[76:79], v2 offset:7168
  ds_read_b128 v[32:35], v4 offset:0
  ds_read_b128 v[36:39], v4 offset:1024
  v_smfmac_f32_16x16x64_bf16 v[16:19], v[52:55], a[64:71], v1
  ds_read_b128 v[40:43], v4 offset:2048
  ds_read_b128 v[44:47], v4 offset:3072
  v_smfmac_f32_16x16x64_bf16 v[16:19], v[56:59], a[80:87], v1
  v_add_u32 v4, 4096, v4
  v_and_b32 v4, 0x23fff, v4
  s_waitcnt lgkmcnt(6)
  v_smfmac_f32_16x16x64_bf16 v[16:19], v[60:63], v[64:71], v1
  ds_read_b128 v[64:67], v2 offset:8192
  v_smfmac_f32_16x16x64_bf16 v[20:23], v[48:51], a[56:63], v1
  ds_read_b128 v[68:71], v2 offset:9216
  v_smfmac_f32_16x16x64_bf16 v[20:23], v[52:55], a[72:79], v1
  v_smfmac_f32_16x16x64_bf16 v[20:23], v[56:59], a[88:95], v1
  s_waitcnt lgkmcnt(6)
  v_smfmac_f32_16x16x64_bf16 v[20:23], v[60:63], v[72:79], v1
  ds_read_b128 v[72:75], v2 offset:10240
  s_waitcnt lgkmcnt(3)
  v_smfmac_f32_16x16x64_bf16 v[16:19], v[32:35], a[96:103], v1
  ds_read_b128 v[76:79], v2 offset:11264
  ds_read_b128 v[48:51], v4 offset:0
  ds_read_b128 v[52:55], v4 offset:1024
  v_smfmac_f32_16x16x64_bf16 v[16:19], v[36:39], a[112:119], v1
  ds_read_b128 v[56:59], v4 offset:2048
  ds_read_b128 v[60:63], v4 offset:3072
  v_smfmac_f32_16x16x64_bf16 v[16:19], v[40:43], a[128:135], v1
  s_waitcnt lgkmcnt(6)
  v_smfmac_f32_16x16x64_bf16 v[16:19], v[44:47], v[64:71], v1
  ds_read_b128 v[64:67], v2 offset:12288
  v_smfmac_f32_16x16x64_bf16 v[20:23], v[32:35], a[104:111], v1
  ds_read_b128 v[68:71], v2 offset:13312
  v_smfmac_f32_16x16x64_bf16 v[20:23], v[36:39], a[120:127], v1
  v_smfmac_f32_16x16x64_bf16 v[20:23], v[40:43], a[136:143], v1
  s_waitcnt lgkmcnt(6)
  v_smfmac_f32_16x16x64_bf16 v[20:23], v[44:47], v[72:79], v1
  ds_read_b128 v[72:75], v2 offset:14336
  s_waitcnt lgkmcnt(3)
  v_smfmac_f32_16x16x64_bf16 v[16:19], v[48:51], a[144:151], v1
  ds_read_b128 v[76:79], v2 offset:15360
  v_smfmac_f32_16x16x64_bf16 v[16:19], v[52:55], a[160:167], v1
  v_smfmac_f32_16x16x64_bf16 v[16:19], v[56:59], a[176:183], v1
  s_waitcnt lgkmcnt(2)
  v_smfmac_f32_16x16x64_bf16 v[16:19], v[60:63], v[64:71], v1
  v_smfmac_f32_16x16x64_bf16 v[20:23], v[48:51], a[152:159], v1
  v_smfmac_f32_16x16x64_bf16 v[20:23], v[52:55], a[168:175], v1
  v_smfmac_f32_16x16x64_bf16 v[20:23], v[56:59], a[184:191], v1
  s_waitcnt lgkmcnt(0)
  v_smfmac_f32_16x16x64_bf16 v[20:23], v[60:63], v[72:79], v1
  s_add_u32 s42, s32, s50
  s_add_u32 s42, s42, 163840
  v_mov_b64 v[24:25], 0
  v_mov_b64 v[26:27], 0
  v_mov_b64 v[28:29], 0
  v_mov_b64 v[30:31], 0
  s_nop 1
  v_permlane32_swap_b32 v16, v20
  v_permlane32_swap_b32 v17, v21
  v_permlane32_swap_b32 v18, v22
  v_permlane32_swap_b32 v19, v23
  v_pk_add_f32 v[16:17], v[16:17], v[20:21]
  v_pk_add_f32 v[18:19], v[18:19], v[22:23]
  v_cvt_pk_bf16_f32 v20, v16, v17
  v_cvt_pk_bf16_f32 v21, v18, v19
  buffer_store_dwordx2 v[20:21], v6, s[8:11], s42 offen sc1
  s_cmp_eq_u32 s31, 63
  s_cbranch_scc1 CV0_end
  v_mov_b32 v22, 0xffbfffbf
  v_mov_b32 v23, 0xffbfffbf
  s_add_u32 s42, s25, s50
  s_add_u32 s42, s42, 163840
  s_add_u32 s43, s25, s35
  s_add_u32 s44, s25, s46
  s_add_u32 s3, s25, s24
  buffer_store_dword v22, v13, s[8:11], s44 offen sc1
  s_add_u32 s44, s25, s47
  s_mov_b64 exec, s[38:39]
  buffer_store_dword v22, off, s[8:11], s44 sc1
  s_mov_b64 exec, -1
  buffer_store_dwordx2 v[22:23], v6, s[8:11], s42 offen sc1
  buffer_store_dword v22, v13, s[8:11], s43 offen sc1
  s_mov_b64 exec, s[20:21]
  buffer_store_dword v22, off, s[8:11], s3 sc1
  s_mov_b64 exec, -1
  ds_read_b128 v[64:67], v8 offset:0
  ds_read_b128 v[68:71], v8 offset:1024
  ds_read_b128 v[72:75], v8 offset:2048
  ds_read_b128 v[76:79], v8 offset:3072
  ds_read_b128 v[80:83], v8 offset:4096
  ds_read_b128 v[84:87], v8 offset:5120
  ds_read_b128 v[88:91], v8 offset:6144
  ds_read_b128 v[92:95], v8 offset:7168
  ds_read_b128 v[96:99], v8 offset:8192
  ds_read_b128 v[100:103], v8 offset:9216
  ds_read_b128 v[104:107], v8 offset:10240
  ds_read_b128 v[108:111], v8 offset:11264
  ds_read_b128 v[112:115], v8 offset:12288
  ds_read_b128 v[116:119], v8 offset:13312
  ds_read_b128 v[120:123], v8 offset:14336
  ds_read_b128 v[124:127], v8 offset:15360
  v_mov_b64 v[16:17], 0
  v_mov_b64 v[18:19], 0
  v_mov_b64 v[20:21], 0
  v_mov_b64 v[22:23], 0
  v_mov_b64 v[24:25], 0
  v_mov_b64 v[26:27], 0
  v_mov_b64 v[28:29], 0
  v_mov_b64 v[30:31], 0
  s_add_u32 s42, s32, s36
  s_add_u32 s43, s42, 4096
  s_add_u32 s44, s32, s53
  s_waitcnt lgkmcnt(0)
  s_cmp_lg_u32 s27, 3
  s_cbranch_scc1 Qf_57_w
  buffer_load_dword v14, v9, s[8:11], s44 offen sc1
  s_nop 15
  buffer_load_dword v32, v9, s[8:11], s44 offen sc1
  s_nop 15
  buffer_load_dword v33, v9, s[8:11], s44 offen sc1
  s_nop 15
Qf_57:
  buffer_load_dword v34, v9, s[8:11], s44 offen sc1
  s_waitcnt vmcnt(3)
  v_cmp_eq_u32 vcc, 0xffbfffbf, v14
  s_cbranch_vccz Qf_57_ok
  buffer_load_dword v14, v9, s[8:11], s44 offen sc1
  s_waitcnt vmcnt(3)
  v_cmp_eq_u32 vcc, 0xffbfffbf, v32
  s_cbranch_vccz Qf_57_ok
  buffer_load_dword v32, v9, s[8:11], s44 offen sc1
  s_waitcnt vmcnt(3)
  v_cmp_eq_u32 vcc, 0xffbfffbf, v33
  s_cbranch_vccz Qf_57_ok
  buffer_load_dword v33, v9, s[8:11], s44 offen sc1
  s_waitcnt vmcnt(3)
  v_cmp_eq_u32 vcc, 0xffbfffbf, v34
  s_cbranch_vccz Qf_57_ok
  s_add_u32 s40, s40, 1
  s_cmp_gt_u32 s40, 65536
  s_cbranch_scc1 L_abort
  s_branch Qf_57
Qf_57_ok:
Qf_57_w:
  s_barrier
  buffer_load_dwordx4 v[32:35], v0, s[8:11], s42 offen offset:0 sc1
  s_nop 8
  buffer_load_dwordx4 v[36:39], v0, s[8:11], s42 offen offset:1024 sc1
  s_nop 8
  buffer_load_dwordx4 v[40:43], v0, s[8:11], s42 offen offset:2048 sc1
  s_nop 8
  buffer_load_dwordx4 v[44:47], v0, s[8:11], s42 offen offset:3072 sc1
  s_nop 8
  buffer_load_dwordx4 v[48:51], v0, s[8:11], s43 offen offset:0 sc1
  s_waitcnt vmcnt(4)
  v_max3_u32 v14, v32, v33, v34
  v_max_u32 v14, v14, v35
  v_cmp_eq_u32 vcc, 0xffbfffbf, v14
  s_cbranch_vccnz CV0_f0
CV0_b0:
  s_add_u32 s44, s26, s24
  s_add_u32 s3, s26, s47
  v_smfmac_f32_16x16x64_bf16 v[16:19], v[32:35], a[192:199], v1
  buffer_load_dwordx4 v[52:55], v0, s[8:11], s43 offen offset:1024 sc1
  v_smfmac_f32_16x16x64_bf16 v[20:23], v[32:35], a[200:207], v1
  s_waitcnt vmcnt(4)
  v_max3_u32 v14, v36, v37, v38
  v_smfmac_f32_16x16x64_bf16 v[24:27], v[32:35], a[208:215], v1
  v_max_u32 v14, v14, v39
  v_cmp_eq_u32 vcc, 0xffbfffbf, v14
  v_smfmac_f32_16x16x64_bf16 v[28:31], v[32:35], a[216:223], v1
  s_cbranch_vccnz CV0_f1
CV0_b1:
  v_smfmac_f32_16x16x64_bf16 v[16:19], v[36:39], a[224:231], v1
  buffer_load_dwordx4 v[56:59], v0, s[8:11], s43 offen offset:2048 sc1
  v_smfmac_f32_16x16x64_bf16 v[20:23], v[36:39], a[232:239], v1
  s_waitcnt vmcnt(4)
  v_max3_u32 v14, v40, v41, v42
  v_smfmac_f32_16x16x64_bf16 v[24:27], v[36:39], a[240:247], v1
  v_max_u32 v14, v14, v43
  v_cmp_eq_u32 vcc, 0xffbfffbf, v14
  v_smfmac_f32_16x16x64_bf16 v[28:31], v[36:39], a[248:255], v1
  s_cbranch_vccnz CV0_f2
CV0_b2:
  v_smfmac_f32_16x16x64_bf16 v[16:19], v[40:43], v[128:135], v1
  buffer_load_dwordx4 v[60:63], v0, s[8:11], s43 offen offset:3072 sc1
  v_smfmac_f32_16x16x64_bf16 v[20:23], v[40:43], v[136:143], v1
  s_waitcnt vmcnt(4)
  v_max3_u32 v14, v44, v45, v46
  v_smfmac_f32_16x16x64_bf16 v[24:27], v[40:43], v[144:151], v1
  v_max_u32 v14, v14, v47
  v_cmp_eq_u32 vcc, 0xffbfffbf, v14
  v_smfmac_f32_16x16x64_bf16 v[28:31], v[40:43], v[152:159], v1
  s_cbranch_vccnz CV0_f3
CV0_b3:
  v_smfmac_f32_16x16x64_bf16 v[16:19], v[44:47], v[64:71], v1
  v_smfmac_f32_16x16x64_bf16 v[20:23], v[44:47], v[72:79], v1
  s_waitcnt vmcnt(3)
  v_max3_u32 v14, v48, v49, v50
  v_smfmac_f32_16x16x64_bf16 v[24:27], v[44:47], v[80:87], v1
  v_max_u32 v14, v14, v51
  v_cmp_eq_u32 vcc, 0xffbfffbf, v14
  v_smfmac_f32_16x16x64_bf16 v[28:31], v[44:47], v[88:95], v1
  s_cbranch_vccnz CV0_f4
CV0_b4:
  v_smfmac_f32_16x16x64_bf16 v[16:19], v[48:51], v[160:167], v1
  v_smfmac_f32_16x16x64_bf16 v[20:23], v[48:51], v[168:175], v1
  s_waitcnt vmcnt(2)
  v_max3_u32 v14, v52, v53, v54
  v_smfmac_f32_16x16x64_bf16 v[24:27], v[48:51], v[176:183], v1
  v_max_u32 v14, v14, v55
  v_cmp_eq_u32 vcc, 0xffbfffbf, v14
  v_smfmac_f32_16x16x64_bf16 v[28:31], v[48:51], v[184:191], v1
  s_cbranch_vccnz CV0_f5
CV0_b5:
  v_smfmac_f32_16x16x64_bf16 v[16:19], v[52:55], v[192:199], v1
  s_mov_b64 exec, 1
  buffer_store_dword v1, off, s[16:19], s3 sc1
  s_mov_b64 exec, -1
  v_smfmac_f32_16x16x64_bf16 v[20:23], v[52:55], v[200:207], v1
  s_waitcnt vmcnt(2)
  v_max3_u32 v14, v56, v57, v58
  v_smfmac_f32_16x16x64_bf16 v[24:27], v[52:55], v[208:215], v1
  v_max_u32 v14, v14, v59
  v_cmp_eq_u32 vcc, 0xffbfffbf, v14
  v_smfmac_f32_16x16x64_bf16 v[28:31], v[52:55], v[216:223], v1
  s_cbranch_vccnz CV0_f6
CV0_b6:
  v_smfmac_f32_16x16x64_bf16 v[16:19], v[56:59], v[224:231], v1
  s_waitcnt vmcnt(1)
  v_max3_u32 v14, v60, v61, v62
  v_smfmac_f32_16x16x64_bf16 v[20:23], v[56:59], v[232:239], v1
  v_max_u32 v14, v14, v63
  v_cmp_eq_u32 vcc, 0xffbfffbf, v14
  v_smfmac_f32_16x16x64_bf16 v[24:27], v[56:59], v[240:247], v1
  s_cbranch_vccnz CV0_f7
CV0_b7:
  v_smfmac_f32_16x16x64_bf16 v[16:19], v[60:63], v[96:103], v1
  v_smfmac_f32_16x16x64_bf16 v[20:23], v[60:63], v[104:111], v1
  s_add_u32 s31, s31, 1
  s_add_u32 s42, s26, s46
  v_smfmac_f32_16x16x64_bf16 v[28:31], v[56:59], v[248:255], v1
  s_add_u32 s43, s26, s35
  v_mov_b32 v15, 0
  v_smfmac_f32_16x16x64_bf16 v[24:27], v[60:63], v[112:119], v1
  v_mov_b32 v15, 0
  v_smfmac_f32_16x16x64_bf16 v[28:31], v[60:63], v[120:127], v1
  v_permlane32_swap_b32 v16, v20
  v_permlane32_swap_b32 v17, v21
  v_permlane32_swap_b32 v18, v22
  v_permlane32_swap_b32 v19, v23
  v_pk_add_f32 v[16:17], v[16:17], v[20:21]
  v_pk_add_f32 v[18:19], v[18:19], v[22:23]
  ds_write2_b32 v11, v16, v17 offset0:0 offset1:40
  ds_write2_b32 v11, v18, v19 offset0:80 offset1:120
  v_permlane32_swap_b32 v24, v28
  v_permlane32_swap_b32 v25, v29
  v_permlane32_swap_b32 v26, v30
  v_permlane32_swap_b32 v27, v31
  v_pk_add_f32 v[24:25], v[24:25], v[28:29]
  v_pk_add_f32 v[26:27], v[26:27], v[30:31]
  ds_write2_b32 v10, v24, v25 offset0:0 offset1:40
  ds_write2_b32 v10, v26, v27 offset0:80 offset1:120
  s_mov_b64 exec, s[20:21]
  buffer_store_dword v1, off, s[8:11], s44 sc1
  s_mov_b64 exec, -1
  s_waitcnt lgkmcnt(0)
  s_barrier
  ds_read_b64 v[36:37], v7 offset:0
  ds_read_b64 v[38:39], v7 offset:1280
  ds_read_b64 v[40:41], v7 offset:2560
  ds_read_b64 v[42:43], v7 offset:3840
  s_waitcnt lgkmcnt(2)
  v_pk_add_f32 v[36:37], v[36:37], v[38:39]
  s_waitcnt lgkmcnt(0)
  v_pk_add_f32 v[40:41], v[40:41], v[42:43]
  v_pk_add_f32 v[36:37], v[36:37], v[40:41]
  v_cvt_pk_bf16_f32 v24, v36, v37
  buffer_store_dword v24, v13, s[8:11], s43 offen sc1
  s_nop 8
  buffer_store_dword v24, v13, s[8:11], s42 offen sc1
  s_mov_b32 s25, s32
  s_mov_b32 s32, s26
  s_add_u32 s26, s26, 262144
  s_and_b32 s26, s26, 0xfffff
  s_or_b32 s26, s26, 85983232
  s_branch CV0_top
CV0_f0:
  s_waitcnt vmcnt(0)
Po_58:
  v_max3_u32 v14, v32, v33, v34
  v_max3_u32 v15, v35, v36, v37
  v_max3_u32 v14, v14, v38, v39
  v_max3_u32 v15, v15, v40, v41
  v_max3_u32 v14, v14, v42, v43
  v_max3_u32 v15, v15, v44, v45
  v_max3_u32 v14, v14, v46, v47
  v_max3_u32 v15, v15, v48, v49
  v_max3_u32 v14, v14, v50, v51
  v_max_u32 v14, v14, v15
  v_cmp_eq_u32 vcc, 0xffbfffbf, v14
  s_cbranch_vccnz Po_58_re
  s_branch CV0_b0
CV0_f1:
  s_waitcnt vmcnt(0)
Po_59:
  v_max3_u32 v14, v36, v37, v38
  v_max3_u32 v15, v39, v40, v41
  v_max3_u32 v14, v14, v42, v43
  v_max3_u32 v15, v15, v44, v45
  v_max3_u32 v14, v14, v46, v47
  v_max3_u32 v15, v15, v48, v49
  v_max3_u32 v14, v14, v50, v51
  v_max3_u32 v15, v15, v52, v53
  v_max3_u32 v14, v14, v54, v55
  v_max_u32 v14, v14, v15
  v_cmp_eq_u32 vcc, 0xffbfffbf, v14
  s_cbranch_vccnz Po_59_re
  s_branch CV0_b1
CV0_f2:
  s_waitcnt vmcnt(0)
Po_60:
  v_max3_u32 v14, v40, v41, v42
  v_max3_u32 v15, v43, v44, v45
  v_max3_u32 v14, v14, v46, v47
  v_max3_u32 v15, v15, v48, v49
  v_max3_u32 v14, v14, v50, v51
  v_max3_u32 v15, v15, v52, v53
  v_max3_u32 v14, v14, v54, v55
  v_max3_u32 v15, v15, v56, v57
  v_max3_u32 v14, v14, v58, v59
  v_max_u32 v14, v14, v15
  v_cmp_eq_u32 vcc, 0xffbfffbf, v14
  s_cbranch_vccnz Po_60_re
  s_branch CV0_b2
CV0_f3:
  s_waitcnt vmcnt(0)
Po_61:
  v_max3_u32 v14, v44, v45, v46
  v_max3_u32 v15, v47, v48, v49
  v_max3_u32 v14, v14, v50, v51
  v_max3_u32 v15, v15, v52, v53
  v_max3_u32 v14, v14, v54, v55
  v_max3_u32 v15, v15, v56, v57
  v_max3_u32 v14, v14, v58, v59
  v_max3_u32 v15, v15, v60, v61
  v_max3_u32 v14, v14, v62, v63
  v_max_u32 v14, v14, v15
  v_cmp_eq_u32 vcc, 0xffbfffbf, v14
  s_cbranch_vccnz Po_61_re
  s_branch CV0_b3
CV0_f4:
  s_waitcnt vmcnt(0)
Po_62:
  v_max3_u32 v14, v48, v49, v50
  v_max3_u32 v15, v51, v52, v53
  v_max3_u32 v14, v14, v54, v55
  v_max3_u32 v15, v15, v56, v57
  v_max3_u32 v14, v14, v58, v59
  v_max3_u32 v15, v15, v60, v61
  v_max3_u32 v14, v14, v62, v63
  v_max_u32 v14, v14, v15
  v_cmp_eq_u32 vcc, 0xffbfffbf, v14
  s_cbranch_vccnz Po_62_re
  s_branch CV0_b4
CV0_f5:
  s_waitcnt vmcnt(0)
Po_63:
  v_max3_u32 v14, v52, v53, v54
  v_max3_u32 v15, v55, v56, v57
  v_max3_u32 v14, v14, v58, v59
  v_max3_u32 v15, v15, v60, v61
  v_max3_u32 v14, v14, v62, v63
  v_max_u32 v14, v14, v15
  v_cmp_eq_u32 vcc, 0xffbfffbf, v14
  s_cbranch_vccnz Po_63_re
  s_branch CV0_b5
CV0_f6:
  s_waitcnt vmcnt(0)
Po_64:
  v_max3_u32 v14, v56, v57, v58
  v_max3_u32 v15, v59, v60, v61
  v_max3_u32 v14, v14, v62, v63
  v_max_u32 v14, v14, v15
  v_cmp_eq_u32 vcc, 0xffbfffbf, v14
  s_cbranch_vccnz Po_64_re
  s_branch CV0_b6
CV0_f7:
  s_waitcnt vmcnt(0)
Po_65:
  v_max3_u32 v14, v60, v61, v62
  v_max_u32 v14, v14, v63
  v_cmp_eq_u32 vcc, 0xffbfffbf, v14
  s_cbranch_vccnz Po_65_re
  s_branch CV0_b7
Pa_56_re:
  s_add_u32 s40, s40, 1
  s_cmp_gt_u32 s40, 65536
  s_cbranch_scc1 L_abort
  s_mov_b64 exec, vcc
  buffer_load_dwordx4 v[96:99], v0, s[8:11], s43 offen offset:0 sc1
  buffer_load_dwordx4 v[100:103], v0, s[8:11], s43 offen offset:1024 sc1
  buffer_load_dwordx4 v[104:107], v0, s[8:11], s43 offen offset:2048 sc1
  buffer_load_dwordx4 v[108:111], v0, s[8:11], s43 offen offset:3072 sc1
  s_mov_b64 exec, -1
  s_waitcnt vmcnt(0)
  s_branch Pa_56
GA_55_re:
  s_add_u32 s40, s40, 1
  s_cmp_gt_u32 s40, 65536
  s_cbranch_scc1 L_abort
  s_mov_b64 exec, vcc
  buffer_load_dwordx4 v[48:51], v0, s[8:11], s42 offen offset:0 sc1
  buffer_load_dwordx4 v[52:55], v0, s[8:11], s42 offen offset:1024 sc1
  buffer_load_dwordx4 v[56:59], v0, s[8:11], s42 offen offset:2048 sc1
  buffer_load_dwordx4 v[60:63], v0, s[8:11], s42 offen offset:3072 sc1
  s_mov_b64 exec, -1
  s_branch GA_55_u
CV0_end:
  s_endpgm
Po_58_re:
  s_add_u32 s40, s40, 1
  s_cmp_gt_u32 s40, 65536
  s_cbranch_scc1 L_abort
  s_mov_b64 exec, vcc
  buffer_load_dwordx4 v[32:35], v0, s[8:11], s42 offen offset:0 sc1
  buffer_load_dwordx4 v[36:39], v0, s[8:11], s42 offen offset:1024 sc1
  buffer_load_dwordx4 v[40:43], v0, s[8:11], s42 offen offset:2048 sc1
  buffer_load_dwordx4 v[44:47], v0, s[8:11], s42 offen offset:3072 sc1
  buffer_load_dwordx4 v[48:51], v0, s[8:11], s43 offen offset:0 sc1
  s_mov_b64 exec, -1
  s_waitcnt vmcnt(0)
  s_branch Po_58
Po_59_re:
  s_add_u32 s40, s40, 1
  s_cmp_gt_u32 s40, 65536
  s_cbranch_scc1 L_abort
  s_mov_b64 exec, vcc
  buffer_load_dwordx4 v[36:39], v0, s[8:11], s42 offen offset:1024 sc1
  buffer_load_dwordx4 v[40:43], v0, s[8:11], s42 offen offset:2048 sc1
  buffer_load_dwordx4 v[44:47], v0, s[8:11], s42 offen offset:3072 sc1
  buffer_load_dwordx4 v[48:51], v0, s[8:11], s43 offen offset:0 sc1
  buffer_load_dwordx4 v[52:55], v0, s[8:11], s43 offen offset:1024 sc1
  s_mov_b64 exec, -1
  s_waitcnt vmcnt(0)
  s_branch Po_59
Po_60_re:
  s_add_u32 s40, s40, 1
  s_cmp_gt_u32 s40, 65536
  s_cbranch_scc1 L_abort
  s_mov_b64 exec, vcc
  buffer_load_dwordx4 v[40:43], v0, s[8:11], s42 offen offset:2048 sc1
  buffer_load_dwordx4 v[44:47], v0, s[8:11], s42 offen offset:3072 sc1
  buffer_load_dwordx4 v[48:51], v0, s[8:11], s43 offen offset:0 sc1
  buffer_load_dwordx4 v[52:55], v0, s[8:11], s43 offen offset:1024 sc1
  buffer_load_dwordx4 v[56:59], v0, s[8:11], s43 offen offset:2048 sc1
  s_mov_b64 exec, -1
  s_waitcnt vmcnt(0)
  s_branch Po_60
Po_61_re:
  s_add_u32 s40, s40, 1
  s_cmp_gt_u32 s40, 65536
  s_cbranch_scc1 L_abort
  s_mov_b64 exec, vcc
  buffer_load_dwordx4 v[44:47], v0, s[8:11], s42 offen offset:3072 sc1
  buffer_load_dwordx4 v[48:51], v0, s[8:11], s43 offen offset:0 sc1
  buffer_load_dwordx4 v[52:55], v0, s[8:11], s43 offen offset:1024 sc1
  buffer_load_dwordx4 v[56:59], v0, s[8:11], s43 offen offset:2048 sc1
  buffer_load_dwordx4 v[60:63], v0, s[8:11], s43 offen offset:3072 sc1
  s_mov_b64 exec, -1
  s_waitcnt vmcnt(0)
  s_branch Po_61
Po_62_re:
  s_add_u32 s40, s40, 1
  s_cmp_gt_u32 s40, 65536
  s_cbranch_scc1 L_abort
  s_mov_b64 exec, vcc
  buffer_load_dwordx4 v[48:51], v0, s[8:11], s43 offen offset:0 sc1
  buffer_load_dwordx4 v[52:55], v0, s[8:11], s43 offen offset:1024 sc1
  buffer_load_dwordx4 v[56:59], v0, s[8:11], s43 offen offset:2048 sc1
  buffer_load_dwordx4 v[60:63], v0, s[8:11], s43 offen offset:3072 sc1
  s_mov_b64 exec, -1
  s_waitcnt vmcnt(0)
  s_branch Po_62
Po_63_re:
  s_add_u32 s40, s40, 1
  s_cmp_gt_u32 s40, 65536
  s_cbranch_scc1 L_abort
  s_mov_b64 exec, vcc
  buffer_load_dwordx4 v[52:55], v0, s[8:11], s43 offen offset:1024 sc1
  buffer_load_dwordx4 v[56:59], v0, s[8:11], s43 offen offset:2048 sc1
  buffer_load_dwordx4 v[60:63], v0, s[8:11], s43 offen offset:3072 sc1
  s_mov_b64 exec, -1
  s_waitcnt vmcnt(0)
  s_branch Po_63
Po_64_re:
  s_add_u32 s40, s40, 1
  s_cmp_gt_u32 s40, 65536
  s_cbranch_scc1 L_abort
  s_mov_b64 exec, vcc
  buffer_load_dwordx4 v[56:59], v0, s[8:11], s43 offen offset:2048 sc1
  buffer_load_dwordx4 v[60:63], v0, s[8:11], s43 offen offset:3072 sc1
  s_mov_b64 exec, -1
  s_waitcnt vmcnt(0)
  s_branch Po_64
Po_65_re:
  s_add_u32 s40, s40, 1
  s_cmp_gt_u32 s40, 65536
  s_cbranch_scc1 L_abort
  s_mov_b64 exec, vcc
  buffer_load_dwordx4 v[60:63], v0, s[8:11], s43 offen offset:3072 sc1
  s_mov_b64 exec, -1
  s_waitcnt vmcnt(0)
  s_branch Po_65
.p2align 6
.type TABLE_0,@object
TABLE_0:
.long 0x41,0x309,0x707,0x4000f45,0x4400ff06,0x0,0x0,0x0,0x0,0x0,0x0,0x0,0x0,0x0,0x0,0x0
.long 0x0,0x0,0x0,0x0,0x0,0x0,0x0,0x0,0x0,0x0,0x0,0x0,0x0,0x0,0x0,0x0
.long 0x1041,0x1309,0x1707,0x4001f45,0x4404ff06,0x0,0x0,0x0,0x0,0x0,0x0,0x0,0x0,0x0,0x0,0x0
.long 0x0,0x0,0x0,0x0,0x0,0x0,0x0,0x0,0x0,0x0,0x0,0x0,0x0,0x0,0x0,0x0
.long 0x2041,0x2309,0x10801,0xc013,0x4813,0xc,0xce00c0d,0x14c04c06,0x302c0fc5,0x0,0x0,0x0,0x0,0x0,0x0,0x0
.long 0x3041,0x3309,0x11801,0xd013,0x5813,0x100c,0xce01c0d,0x14c44c06,0x302c1fc5,0x0,0x0,0x0,0x0,0x0,0x0,0x0
.long 0x4041,0x4309,0x12801,0xe013,0x6813,0x200c,0xce02c0d,0x14c84c06,0x302c2fc5,0x0,0x0,0x0,0x0,0x0,0x0,0x0
.long 0x5041,0x5309,0x13801,0xf013,0x7813,0x300c,0xce03c0d,0x14cc4c06,0x302c3fc5,0x0,0x0,0x0,0x0,0x0,0x0,0x0
.long 0x6041,0x6309,0x2707,0x4002f45,0x4408ff06,0x0,0x0,0x0,0x0,0x0,0x0,0x0,0x0,0x0,0x0,0x0
.long 0x0,0x0,0x0,0x0,0x0,0x0,0x0,0x0,0x0,0x0,0x0,0x0,0x0,0x0,0x0,0x0
.long 0x7041,0x7309,0x3707,0x4003f45,0x440cff06,0x0,0x0,0x0,0x0,0x0,0x0,0x0,0x0,0x0,0x0,0x0
.long 0x0,0x0,0x0,0x0,0x0,0x0,0x0,0x0,0x0,0x0,0x0,0x0,0x0,0x0,0x0,0x0
.long 0x8041,0x8309,0x14801,0xc213,0x4a13,0x10c,0x10f00c0d,0x14c00c06,0x34300fc5,0x0,0x0,0x0,0x0,0x0,0x0,0x0
.long 0x9041,0x9309,0x15801,0xd213,0x5a13,0x110c,0x10f01c0d,0x14c40c06,0x34301fc5,0x0,0x0,0x0,0x0,0x0,0x0,0x0
.long 0xa041,0xa309,0x16801,0xe213,0x6a13,0x210c,0x10f02c0d,0x14c80c06,0x34302fc5,0x0,0x0,0x0,0x0,0x0,0x0,0x0
.long 0xb041,0xb309,0x17801,0xf213,0x7a13,0x310c,0x10f03c0d,0x14cc0c06,0x34303fc5,0x0,0x0,0x0,0x0,0x0,0x0,0x0
.long 0xc041,0xc309,0x4707,0x8040f45,0x4400ef06,0x0,0x0,0x0,0x0,0x0,0x0,0x0,0x0,0x0,0x0,0x0
.long 0x0,0x0,0x0,0x0,0x0,0x0,0x0,0x0,0x0,0x0,0x0,0x0,0x0,0x0,0x0,0x0
.long 0xd041,0xd309,0x5707,0x8041f45,0x4404ef06,0x0,0x0,0x0,0x0,0x0,0x0,0x0,0x0,0x0,0x0,0x0
.long 0x0,0x0,0x0,0x0,0x0,0x0,0x0,0x0,0x0,0x0,0x0,0x0,0x0,0x0,0x0,0x0
.long 0xe041,0xe309,0x18801,0xc413,0x4c13,0x20c,0x4c00d0d,0x14c0cd06,0x0,0x0,0x0,0x0,0x0,0x0,0x0,0x0
.long 0xf041,0xf309,0x19801,0xd413,0x5c13,0x120c,0x4c01d0d,0x14c4cd06,0x0,0x0,0x0,0x0,0x0,0x0,0x0,0x0
.long 0x10041,0x10309,0x1a801,0xe413,0x6c13,0x220c,0x4c02d0d,0x14c8cd06,0x0,0x0,0x0,0x0,0x0,0x0,0x0,0x0
.long 0x11041,0x11309,0x1b801,0xf413,0x7c13,0x320c,0x4c03d0d,0x14cccd06,0x0,0x0,0x0,0x0,0x0,0x0,0x0,0x0
.long 0x12041,0x12309,0x6707,0x8042f45,0x4408ef06,0x0,0x0,0x0,0x0,0x0,0x0,0x0,0x0,0x0,0x0,0x0
.long 0x0,0x0,0x0,0x0,0x0,0x0,0x0,0x0,0x0,0x0,0x0,0x0,0x0,0x0,0x0,0x0
.long 0x13041,0x13309,0x7707,0x8043f45,0x440cef06,0x0,0x0,0x0,0x0,0x0,0x0,0x0,0x0,0x0,0x0,0x0
.long 0x0,0x0,0x0,0x0,0x0,0x0,0x0,0x0,0x0,0x0,0x0,0x0,0x0,0x0,0x0,0x0
.long 0x14041,0x14309,0x1c801,0xc613,0x4e13,0x30c,0x8d00d0d,0x14c08d06,0x0,0x0,0x0,0x0,0x0,0x0,0x0,0x0
.long 0x15041,0x15309,0x1d801,0xd613,0x5e13,0x130c,0x8d01d0d,0x14c48d06,0x0,0x0,0x0,0x0,0x0,0x0,0x0,0x0
.long 0x16041,0x16309,0x1e801,0xe613,0x6e13,0x230c,0x8d02d0d,0x14c88d06,0x0,0x0,0x0,0x0,0x0,0x0,0x0,0x0
.long 0x17041,0x17309,0x1f801,0xf613,0x7e13,0x330c,0x8d03d0d,0x14cc8d06,0x0,0x0,0x0,0x0,0x0,0x0,0x0,0x0
.long 0x18041,0x18309,0x8707,0xc080f45,0x4400df06,0x0,0x0,0x0,0x0,0x0,0x0,0x0,0x0,0x0,0x0,0x0
.long 0x0,0x0,0x0,0x0,0x0,0x0,0x0,0x0,0x0,0x0,0x0,0x0,0x0,0x0,0x0,0x0
.long 0x19041,0x19309,0x9707,0xc081f45,0x4404df06,0x0,0x0,0x0,0x0,0x0,0x0,0x0,0x0,0x0,0x0,0x0
.long 0x0,0x0,0x0,0x0,0x0,0x0,0x0,0x0,0x0,0x0,0x0,0x0,0x0,0x0,0x0,0x0
.long 0x1a041,0x1a309,0x802,0x10013,0x8813,0x40c,0xce00d0d,0x14c04d06,0x0,0x0,0x0,0x0,0x0,0x0,0x0,0x0
.long 0x1b041,0x1b309,0x1802,0x11013,0x9813,0x140c,0xce01d0d,0x14c44d06,0x0,0x0,0x0,0x0,0x0,0x0,0x0,0x0
.long 0x1c041,0x1c309,0x2802,0x12013,0xa813,0x240c,0xce02d0d,0x14c84d06,0x0,0x0,0x0,0x0,0x0,0x0,0x0,0x0
.long 0x1d041,0x1d309,0x3802,0x13013,0xb813,0x340c,0xce03d0d,0x14cc4d06,0x0,0x0,0x0,0x0,0x0,0x0,0x0,0x0
.long 0x1e041,0x1e309,0xa707,0xc082f45,0x4408df06,0x0,0x0,0x0,0x0,0x0,0x0,0x0,0x0,0x0,0x0,0x0
.long 0x0,0x0,0x0,0x0,0x0,0x0,0x0,0x0,0x0,0x0,0x0,0x0,0x0,0x0,0x0,0x0
.long 0x1f041,0x1f309,0xb707,0xc083f45,0x440cdf06,0x0,0x0,0x0,0x0,0x0,0x0,0x0,0x0,0x0,0x0,0x0
.long 0x0,0x0,0x0,0x0,0x0,0x0,0x0,0x0,0x0,0x0,0x0,0x0,0x0,0x0,0x0,0x0
.long 0x42,0x30a,0x4802,0x10213,0x8a13,0x50c,0x10f00d0d,0x14c00d06,0x0,0x0,0x0,0x0,0x0,0x0,0x0,0x0
.long 0x1042,0x130a,0x5802,0x11213,0x9a13,0x150c,0x10f01d0d,0x14c40d06,0x0,0x0,0x0,0x0,0x0,0x0,0x0,0x0
.long 0x2042,0x230a,0x6802,0x12213,0xaa13,0x250c,0x10f02d0d,0x14c80d06,0x0,0x0,0x0,0x0,0x0,0x0,0x0,0x0
.long 0x3042,0x330a,0x7802,0x13213,0xba13,0x350c,0x10f03d0d,0x14cc0d06,0x0,0x0,0x0,0x0,0x0,0x0,0x0,0x0
.long 0x4042,0x430a,0xc707,0x100c0f45,0x4400cf06,0x0,0x0,0x0,0x0,0x0,0x0,0x0,0x0,0x0,0x0,0x0
.long 0x0,0x0,0x0,0x0,0x0,0x0,0x0,0x0,0x0,0x0,0x0,0x0,0x0,0x0,0x0,0x0
.long 0x5042,0x530a,0xd707,0x100c1f45,0x4404cf06,0x0,0x0,0x0,0x0,0x0,0x0,0x0,0x0,0x0,0x0,0x0
.long 0x0,0x0,0x0,0x0,0x0,0x0,0x0,0x0,0x0,0x0,0x0,0x0,0x0,0x0,0x0,0x0
.long 0x6042,0x630a,0x8802,0x10413,0x8c13,0x60c,0x4400e0d,0x2440ee06,0x0,0x0,0x0,0x0,0x0,0x0,0x0,0x0
.long 0x7042,0x730a,0x9802,0x11413,0x9c13,0x160c,0x4401e0d,0x2444ee06,0x0,0x0,0x0,0x0,0x0,0x0,0x0,0x0
.long 0x8042,0x830a,0xa802,0x12413,0xac13,0x260c,0x4402e0d,0x2448ee06,0x0,0x0,0x0,0x0,0x0,0x0,0x0,0x0
.long 0x9042,0x930a,0xb802,0x13413,0xbc13,0x360c,0x4403e0d,0x244cee06,0x0,0x0,0x0,0x0,0x0,0x0,0x0,0x0
.long 0xa042,0xa30a,0xe707,0x100c2f45,0x4408cf06,0x0,0x0,0x0,0x0,0x0,0x0,0x0,0x0,0x0,0x0,0x0
.long 0x0,0x0,0x0,0x0,0x0,0x0,0x0,0x0,0x0,0x0,0x0,0x0,0x0,0x0,0x0,0x0
.long 0xb042,0xb30a,0xf707,0x100c3f45,0x440ccf06,0x0,0x0,0x0,0x0,0x0,0x0,0x0,0x0,0x0,0x0,0x0
.long 0x0,0x0,0x0,0x0,0x0,0x0,0x0,0x0,0x0,0x0,0x0,0x0,0x0,0x0,0x0,0x0
.long 0xc042,0xc30a,0xc802,0x10613,0x8e13,0x70c,0x8480e0d,0x2440ce06,0x0,0x0,0x0,0x0,0x0,0x0,0x0,0x0
.long 0xd042,0xd30a,0xd802,0x11613,0x9e13,0x170c,0x8481e0d,0x2444ce06,0x0,0x0,0x0,0x0,0x0,0x0,0x0,0x0
.long 0xe042,0xe30a,0xe802,0x12613,0xae13,0x270c,0x8482e0d,0x2448ce06,0x0,0x0,0x0,0x0,0x0,0x0,0x0,0x0
.long 0xf042,0xf30a,0xf802,0x13613,0xbe13,0x370c,0x8483e0d,0x244cce06,0x0,0x0,0x0,0x0,0x0,0x0,0x0,0x0
.long 0xc1,0x401,0x10707,0x34300f45,0x44003f06,0x0,0x0,0x0,0x0,0x0,0x0,0x0,0x0,0x0,0x0,0x0
.long 0x0,0x0,0x0,0x0,0x0,0x0,0x0,0x0,0x0,0x0,0x0,0x0,0x0,0x0,0x0,0x0
.long 0x10c1,0x1401,0x11707,0x34301f45,0x44043f06,0x0,0x0,0x0,0x0,0x0,0x0,0x0,0x0,0x0,0x0,0x0
.long 0x0,0x0,0x0,0x0,0x0,0x0,0x0,0x0,0x0,0x0,0x0,0x0,0x0,0x0,0x0,0x0
.long 0x20c1,0x2401,0xa11,0x14013,0xc813,0xe12,0x5c00b0d,0xdc08b06,0x0,0x0,0x0,0x0,0x0,0x0,0x0,0x0
.long 0x30c1,0x3401,0x1a11,0x15013,0xd813,0x1e12,0x5c01b0d,0xdc48b06,0x0,0x0,0x0,0x0,0x0,0x0,0x0,0x0
.long 0x40c1,0x4401,0x2a11,0x16013,0xe813,0x2e12,0x5c02b0d,0xdc88b06,0x0,0x0,0x0,0x0,0x0,0x0,0x0,0x0
.long 0x50c1,0x5401,0x3a11,0x17013,0xf813,0x3e12,0x5c03b0d,0xdcc8b06,0x0,0x0,0x0,0x0,0x0,0x0,0x0,0x0
.long 0x60c1,0x6401,0x12707,0x34302f45,0x44083f06,0x0,0x0,0x0,0x0,0x0,0x0,0x0,0x0,0x0,0x0,0x0
.long 0x0,0x0,0x0,0x0,0x0,0x0,0x0,0x0,0x0,0x0,0x0,0x0,0x0,0x0,0x0,0x0
.long 0x70c1,0x7401,0x13707,0x34303f45,0x440c3f06,0x0,0x0,0x0,0x0,0x0,0x0,0x0,0x0,0x0,0x0,0x0
.long 0x0,0x0,0x0,0x0,0x0,0x0,0x0,0x0,0x0,0x0,0x0,0x0,0x0,0x0,0x0,0x0
.long 0x80c1,0x8401,0x4a11,0x14213,0xca13,0x4e12,0x9e00b0d,0xdc00b06,0x0,0x0,0x0,0x0,0x0,0x0,0x0,0x0
.long 0x90c1,0x9401,0x5a11,0x15213,0xda13,0x5e12,0x9e01b0d,0xdc40b06,0x0,0x0,0x0,0x0,0x0,0x0,0x0,0x0
.long 0xa0c1,0xa401,0x6a11,0x16213,0xea13,0x6e12,0x9e02b0d,0xdc80b06,0x0,0x0,0x0,0x0,0x0,0x0,0x0,0x0
.long 0xb0c1,0xb401,0x7a11,0x17213,0xfa13,0x7e12,0x9e03b0d,0xdcc0b06,0x0,0x0,0x0,0x0,0x0,0x0,0x0,0x0
.long 0xc0c1,0xc401,0x14707,0x38340f45,0x44002f06,0x0,0x0,0x0,0x0,0x0,0x0,0x0,0x0,0x0,0x0,0x0
.long 0x0,0x0,0x0,0x0,0x0,0x0,0x0,0x0,0x0,0x0,0x0,0x0,0x0,0x0,0x0,0x0
.long 0xd0c1,0xd401,0x15707,0x38341f45,0x44042f06,0x0,0x0,0x0,0x0,0x0,0x0,0x0,0x0,0x0,0x0,0x0
.long 0x0,0x0,0x0,0x0,0x0,0x0,0x0,0x0,0x0,0x0,0x0,0x0,0x0,0x0,0x0,0x0
.long 0xe0c1,0xe401,0x8a11,0x14413,0xcc13,0x8e12,0x4c00c0d,0x14c0cc06,0x38340fc5,0x0,0x0,0x0,0x0,0x0,0x0,0x0
.long 0xf0c1,0xf401,0x9a11,0x15413,0xdc13,0x9e12,0x4c01c0d,0x14c4cc06,0x38341fc5,0x0,0x0,0x0,0x0,0x0,0x0,0x0
.long 0x100c1,0x10401,0xaa11,0x16413,0xec13,0xae12,0x4c02c0d,0x14c8cc06,0x38342fc5,0x0,0x0,0x0,0x0,0x0,0x0,0x0
.long 0x110c1,0x11401,0xba11,0x17413,0xfc13,0xbe12,0x4c03c0d,0x14cccc06,0x38343fc5,0x0,0x0,0x0,0x0,0x0,0x0,0x0
.long 0x120c1,0x12401,0x16707,0x38342f45,0x44082f06,0x0,0x0,0x0,0x0,0x0,0x0,0x0,0x0,0x0,0x0,0x0
.long 0x0,0x0,0x0,0x0,0x0,0x0,0x0,0x0,0x0,0x0,0x0,0x0,0x0,0x0,0x0,0x0
.long 0x130c1,0x13401,0x17707,0x38343f45,0x440c2f06,0x0,0x0,0x0,0x0,0x0,0x0,0x0,0x0,0x0,0x0,0x0
.long 0x0,0x0,0x0,0x0,0x0,0x0,0x0,0x0,0x0,0x0,0x0,0x0,0x0,0x0,0x0,0x0
.long 0x140c1,0x14401,0xca11,0x14613,0xce13,0xce12,0x8d00c0d,0x14c08c06,0x3c380fc5,0x0,0x0,0x0,0x0,0x0,0x0,0x0
.long 0x150c1,0x15401,0xda11,0x15613,0xde13,0xde12,0x8d01c0d,0x14c48c06,0x3c381fc5,0x0,0x0,0x0,0x0,0x0,0x0,0x0
.long 0x160c1,0x16401,0xea11,0x16613,0xee13,0xee12,0x8d02c0d,0x14c88c06,0x3c382fc5,0x0,0x0,0x0,0x0,0x0,0x0,0x0
.long 0x170c1,0x17401,0xfa11,0x17613,0xfe13,0xfe12,0x8d03c0d,0x14cc8c06,0x3c383fc5,0x0,0x0,0x0,0x0,0x0,0x0,0x0
.long 0x180c1,0x18401,0x18707,0x3c380f45,0x44001f06,0x0,0x0,0x0,0x0,0x0,0x0,0x0,0x0,0x0,0x0,0x0
.long 0x0,0x0,0x0,0x0,0x0,0x0,0x0,0x0,0x0,0x0,0x0,0x0,0x0,0x0,0x0,0x0
.long 0x190c1,0x19401,0x19707,0x3c381f45,0x44041f06,0x0,0x0,0x0,0x0,0x0,0x0,0x0,0x0,0x0,0x0,0x0
.long 0x0,0x0,0x0,0x0,0x0,0x0,0x0,0x0,0x0,0x0,0x0,0x0,0x0,0x0,0x0,0x0
.long 0x1a0c1,0x1a401,0x10a11,0x18013,0x10813,0x3c0002d,0x8040fc5,0x0,0x0,0x0,0x0,0x0,0x0,0x0,0x0,0x0
.long 0x1b0c1,0x1b401,0x11a11,0x19013,0x11813,0x3c0102d,0x8041fc5,0x0,0x0,0x0,0x0,0x0,0x0,0x0,0x0,0x0
.long 0x1c0c1,0x1c401,0x12a11,0x1a013,0x12813,0x3c0202d,0x8042fc5,0x0,0x0,0x0,0x0,0x0,0x0,0x0,0x0,0x0
.long 0x1d0c1,0x1d401,0x13a11,0x1b013,0x13813,0x3c0302d,0x8043fc5,0x0,0x0,0x0,0x0,0x0,0x0,0x0,0x0,0x0
.long 0x1e0c1,0x1e401,0x1a707,0x3c382f45,0x44081f06,0x0,0x0,0x0,0x0,0x0,0x0,0x0,0x0,0x0,0x0,0x0
.long 0x0,0x0,0x0,0x0,0x0,0x0,0x0,0x0,0x0,0x0,0x0,0x0,0x0,0x0,0x0,0x0
.long 0x1f0c1,0x1f401,0x1b707,0x3c383f45,0x440c1f06,0x0,0x0,0x0,0x0,0x0,0x0,0x0,0x0,0x0,0x0,0x0
.long 0x0,0x0,0x0,0x0,0x0,0x0,0x0,0x0,0x0,0x0,0x0,0x0,0x0,0x0,0x0,0x0
.long 0xc2,0x402,0x14a11,0x18213,0x10a13,0x3c0012d,0xc080fc5,0x0,0x0,0x0,0x0,0x0,0x0,0x0,0x0,0x0
.long 0x10c2,0x1402,0x15a11,0x19213,0x11a13,0x3c0112d,0xc081fc5,0x0,0x0,0x0,0x0,0x0,0x0,0x0,0x0,0x0
.long 0x20c2,0x2402,0x16a11,0x1a213,0x12a13,0x3c0212d,0xc082fc5,0x0,0x0,0x0,0x0,0x0,0x0,0x0,0x0,0x0
.long 0x30c2,0x3402,0x17a11,0x1b213,0x13a13,0x3c0312d,0xc083fc5,0x0,0x0,0x0,0x0,0x0,0x0,0x0,0x0,0x0
.long 0x40c2,0x4402,0x1c707,0x403c0f45,0x44000f06,0x0,0x0,0x0,0x0,0x0,0x0,0x0,0x0,0x0,0x0,0x0
.long 0x0,0x0,0x0,0x0,0x0,0x0,0x0,0x0,0x0,0x0,0x0,0x0,0x0,0x0,0x0,0x0
.long 0x50c2,0x5402,0x1d707,0x403c1f45,0x44040f06,0x0,0x0,0x0,0x0,0x0,0x0,0x0,0x0,0x0,0x0,0x0
.long 0x0,0x0,0x0,0x0,0x0,0x0,0x0,0x0,0x0,0x0,0x0,0x0,0x0,0x0,0x0,0x0
.long 0x60c2,0x6402,0x18a11,0x18413,0x10c13,0x3c0022d,0x100c0fc5,0x0,0x0,0x0,0x0,0x0,0x0,0x0,0x0,0x0
.long 0x70c2,0x7402,0x19a11,0x19413,0x11c13,0x3c0122d,0x100c1fc5,0x0,0x0,0x0,0x0,0x0,0x0,0x0,0x0,0x0
.long 0x80c2,0x8402,0x1aa11,0x1a413,0x12c13,0x3c0222d,0x100c2fc5,0x0,0x0,0x0,0x0,0x0,0x0,0x0,0x0,0x0
.long 0x90c2,0x9402,0x1ba11,0x1b413,0x13c13,0x3c0322d,0x100c3fc5,0x0,0x0,0x0,0x0,0x0,0x0,0x0,0x0,0x0
.long 0xa0c2,0xa402,0x1e707,0x403c2f45,0x44080f06,0x0,0x0,0x0,0x0,0x0,0x0,0x0,0x0,0x0,0x0,0x0
.long 0x0,0x0,0x0,0x0,0x0,0x0,0x0,0x0,0x0,0x0,0x0,0x0,0x0,0x0,0x0,0x0
.long 0xb0c2,0xb402,0x1f707,0x403c3f45,0x440c0f06,0x0,0x0,0x0,0x0,0x0,0x0,0x0,0x0,0x0,0x0,0x0
.long 0x0,0x0,0x0,0x0,0x0,0x0,0x0,0x0,0x0,0x0,0x0,0x0,0x0,0x0,0x0,0x0
.long 0xc0c2,0xc402,0x1ca11,0x18613,0x10e13,0x3c0032d,0x14100fc5,0x0,0x0,0x0,0x0,0x0,0x0,0x0,0x0,0x0
.long 0xd0c2,0xd402,0x1da11,0x19613,0x11e13,0x3c0132d,0x14101fc5,0x0,0x0,0x0,0x0,0x0,0x0,0x0,0x0,0x0
.long 0xe0c2,0xe402,0x1ea11,0x1a613,0x12e13,0x3c0232d,0x14102fc5,0x0,0x0,0x0,0x0,0x0,0x0,0x0,0x0,0x0
.long 0xf0c2,0xf402,0x1fa11,0x1b613,0x13e13,0x3c0332d,0x14103fc5,0x0,0x0,0x0,0x0,0x0,0x0,0x0,0x0,0x0
.long 0x109,0x20707,0x14100f45,0x4400bf06,0x0,0x0,0x0,0x0,0x0,0x0,0x0,0x0,0x0,0x0,0x0,0x0
.long 0x0,0x0,0x0,0x0,0x0,0x0,0x0,0x0,0x0,0x0,0x0,0x0,0x0,0x0,0x0,0x0
.long 0x1109,0x21707,0x14101f45,0x4404bf06,0x0,0x0,0x0,0x0,0x0,0x0,0x0,0x0,0x0,0x0,0x0,0x0
.long 0x0,0x0,0x0,0x0,0x0,0x0,0x0,0x0,0x0,0x0,0x0,0x0,0x0,0x0,0x0,0x0
.long 0x2109,0x601,0xa12,0xc11,0x14813,0x3c0042d,0x18140fc5,0x0,0x0,0x0,0x0,0x0,0x0,0x0,0x0,0x0
.long 0x3109,0x1601,0x1a12,0x1c11,0x15813,0x3c0142d,0x18141fc5,0x0,0x0,0x0,0x0,0x0,0x0,0x0,0x0,0x0
.long 0x4109,0x2601,0x2a12,0x2c11,0x16813,0x3c0242d,0x18142fc5,0x0,0x0,0x0,0x0,0x0,0x0,0x0,0x0,0x0
.long 0x5109,0x3601,0x3a12,0x3c11,0x17813,0x3c0342d,0x18143fc5,0x0,0x0,0x0,0x0,0x0,0x0,0x0,0x0,0x0
.long 0x6109,0x22707,0x14102f45,0x4408bf06,0x0,0x0,0x0,0x0,0x0,0x0,0x0,0x0,0x0,0x0,0x0,0x0
.long 0x0,0x0,0x0,0x0,0x0,0x0,0x0,0x0,0x0,0x0,0x0,0x0,0x0,0x0,0x0,0x0
.long 0x7109,0x23707,0x14103f45,0x440cbf06,0x0,0x0,0x0,0x0,0x0,0x0,0x0,0x0,0x0,0x0,0x0,0x0
.long 0x0,0x0,0x0,0x0,0x0,0x0,0x0,0x0,0x0,0x0,0x0,0x0,0x0,0x0,0x0,0x0
.long 0x8109,0x4601,0x4a12,0x4c11,0x14a13,0x3c0052d,0x1c180fc5,0x0,0x0,0x0,0x0,0x0,0x0,0x0,0x0,0x0
.long 0x9109,0x5601,0x5a12,0x5c11,0x15a13,0x3c0152d,0x1c181fc5,0x0,0x0,0x0,0x0,0x0,0x0,0x0,0x0,0x0
.long 0xa109,0x6601,0x6a12,0x6c11,0x16a13,0x3c0252d,0x1c182fc5,0x0,0x0,0x0,0x0,0x0,0x0,0x0,0x0,0x0
.long 0xb109,0x7601,0x7a12,0x7c11,0x17a13,0x3c0352d,0x1c183fc5,0x0,0x0,0x0,0x0,0x0,0x0,0x0,0x0,0x0
.long 0xc109,0x24707,0x18140f45,0x4400af06,0x0,0x0,0x0,0x0,0x0,0x0,0x0,0x0,0x0,0x0,0x0,0x0
.long 0x0,0x0,0x0,0x0,0x0,0x0,0x0,0x0,0x0,0x0,0x0,0x0,0x0,0x0,0x0,0x0
.long 0xd109,0x25707,0x18141f45,0x4404af06,0x0,0x0,0x0,0x0,0x0,0x0,0x0,0x0,0x0,0x0,0x0,0x0
.long 0x0,0x0,0x0,0x0,0x0,0x0,0x0,0x0,0x0,0x0,0x0,0x0,0x0,0x0,0x0,0x0
.long 0xe109,0x8601,0x8a12,0x8c11,0x14c13,0x3c0062d,0x201c0fc5,0x0,0x0,0x0,0x0,0x0,0x0,0x0,0x0,0x0
.long 0xf109,0x9601,0x9a12,0x9c11,0x15c13,0x3c0162d,0x201c1fc5,0x0,0x0,0x0,0x0,0x0,0x0,0x0,0x0,0x0
.long 0x10109,0xa601,0xaa12,0xac11,0x16c13,0x3c0262d,0x201c2fc5,0x0,0x0,0x0,0x0,0x0,0x0,0x0,0x0,0x0
.long 0x11109,0xb601,0xba12,0xbc11,0x17c13,0x3c0362d,0x201c3fc5,0x0,0x0,0x0,0x0,0x0,0x0,0x0,0x0,0x0
.long 0x12109,0x26707,0x18142f45,0x4408af06,0x0,0x0,0x0,0x0,0x0,0x0,0x0,0x0,0x0,0x0,0x0,0x0
.long 0x0,0x0,0x0,0x0,0x0,0x0,0x0,0x0,0x0,0x0,0x0,0x0,0x0,0x0,0x0,0x0
.long 0x13109,0x27707,0x18143f45,0x440caf06,0x0,0x0,0x0,0x0,0x0,0x0,0x0,0x0,0x0,0x0,0x0,0x0
.long 0x0,0x0,0x0,0x0,0x0,0x0,0x0,0x0,0x0,0x0,0x0,0x0,0x0,0x0,0x0,0x0
.long 0x14109,0xc601,0xca12,0xcc11,0x14e13,0x3c0072d,0x24200fc5,0x0,0x0,0x0,0x0,0x0,0x0,0x0,0x0,0x0
.long 0x15109,0xd601,0xda12,0xdc11,0x15e13,0x3c0172d,0x24201fc5,0x0,0x0,0x0,0x0,0x0,0x0,0x0,0x0,0x0
.long 0x16109,0xe601,0xea12,0xec11,0x16e13,0x3c0272d,0x24202fc5,0x0,0x0,0x0,0x0,0x0,0x0,0x0,0x0,0x0
.long 0x17109,0xf601,0xfa12,0xfc11,0x17e13,0x3c0372d,0x24203fc5,0x0,0x0,0x0,0x0,0x0,0x0,0x0,0x0,0x0
.long 0x18109,0x28707,0x1c180f45,0x44009f06,0x0,0x0,0x0,0x0,0x0,0x0,0x0,0x0,0x0,0x0,0x0,0x0
.long 0x0,0x0,0x0,0x0,0x0,0x0,0x0,0x0,0x0,0x0,0x0,0x0,0x0,0x0,0x0,0x0
.long 0x19109,0x29707,0x1c181f45,0x44049f06,0x0,0x0,0x0,0x0,0x0,0x0,0x0,0x0,0x0,0x0,0x0,0x0
.long 0x0,0x0,0x0,0x0,0x0,0x0,0x0,0x0,0x0,0x0,0x0,0x0,0x0,0x0,0x0,0x0
.long 0x1a109,0x10601,0x13,0x10c11,0x18813,0x82c,0x2c280fc5,0x0,0x0,0x0,0x0,0x0,0x0,0x0,0x0,0x0
.long 0x1b109,0x11601,0x1013,0x11c11,0x19813,0x182c,0x2c281fc5,0x0,0x0,0x0,0x0,0x0,0x0,0x0,0x0,0x0
.long 0x1c109,0x12601,0x2013,0x12c11,0x1a813,0x282c,0x2c282fc5,0x0,0x0,0x0,0x0,0x0,0x0,0x0,0x0,0x0
.long 0x1d109,0x13601,0x3013,0x13c11,0x1b813,0x382c,0x2c283fc5,0x0,0x0,0x0,0x0,0x0,0x0,0x0,0x0,0x0
.long 0x1e109,0x2a707,0x1c182f45,0x44089f06,0x0,0x0,0x0,0x0,0x0,0x0,0x0,0x0,0x0,0x0,0x0,0x0
.long 0x0,0x0,0x0,0x0,0x0,0x0,0x0,0x0,0x0,0x0,0x0,0x0,0x0,0x0,0x0,0x0
.long 0x1f109,0x2b707,0x1c183f45,0x440c9f06,0x0,0x0,0x0,0x0,0x0,0x0,0x0,0x0,0x0,0x0,0x0,0x0
.long 0x0,0x0,0x0,0x0,0x0,0x0,0x0,0x0,0x0,0x0,0x0,0x0,0x0,0x0,0x0,0x0
.long 0x10a,0x14601,0x213,0x14c11,0x18a13,0x90c,0xc500e0d,0x2440ae06,0x0,0x0,0x0,0x0,0x0,0x0,0x0,0x0
.long 0x110a,0x15601,0x1213,0x15c11,0x19a13,0x190c,0xc501e0d,0x2444ae06,0x0,0x0,0x0,0x0,0x0,0x0,0x0,0x0
.long 0x210a,0x16601,0x2213,0x16c11,0x1aa13,0x290c,0xc502e0d,0x2448ae06,0x0,0x0,0x0,0x0,0x0,0x0,0x0,0x0
.long 0x310a,0x17601,0x3213,0x17c11,0x1ba13,0x390c,0xc503e0d,0x244cae06,0x0,0x0,0x0,0x0,0x0,0x0,0x0,0x0
.long 0x410a,0x2c707,0x201c0f45,0x44008f06,0x0,0x0,0x0,0x0,0x0,0x0,0x0,0x0,0x0,0x0,0x0,0x0
.long 0x0,0x0,0x0,0x0,0x0,0x0,0x0,0x0,0x0,0x0,0x0,0x0,0x0,0x0,0x0,0x0
.long 0x510a,0x2d707,0x201c1f45,0x44048f06,0x0,0x0,0x0,0x0,0x0,0x0,0x0,0x0,0x0,0x0,0x0,0x0
.long 0x0,0x0,0x0,0x0,0x0,0x0,0x0,0x0,0x0,0x0,0x0,0x0,0x0,0x0,0x0,0x0
.long 0x610a,0x18601,0x413,0x18c11,0x18c13,0xa0c,0x10580e0d,0x24408e06,0x0,0x0,0x0,0x0,0x0,0x0,0x0,0x0
.long 0x710a,0x19601,0x1413,0x19c11,0x19c13,0x1a0c,0x10581e0d,0x24448e06,0x0,0x0,0x0,0x0,0x0,0x0,0x0,0x0
.long 0x810a,0x1a601,0x2413,0x1ac11,0x1ac13,0x2a0c,0x10582e0d,0x24488e06,0x0,0x0,0x0,0x0,0x0,0x0,0x0,0x0
.long 0x910a,0x1b601,0x3413,0x1bc11,0x1bc13,0x3a0c,0x10583e0d,0x244c8e06,0x0,0x0,0x0,0x0,0x0,0x0,0x0,0x0
.long 0xa10a,0x2e707,0x201c2f45,0x44088f06,0x0,0x0,0x0,0x0,0x0,0x0,0x0,0x0,0x0,0x0,0x0,0x0
.long 0x0,0x0,0x0,0x0,0x0,0x0,0x0,0x0,0x0,0x0,0x0,0x0,0x0,0x0,0x0,0x0
.long 0xb10a,0x2f707,0x201c3f45,0x440c8f06,0x0,0x0,0x0,0x0,0x0,0x0,0x0,0x0,0x0,0x0,0x0,0x0
.long 0x0,0x0,0x0,0x0,0x0,0x0,0x0,0x0,0x0,0x0,0x0,0x0,0x0,0x0,0x0,0x0
.long 0xc10a,0x1c601,0x613,0x1cc11,0x18e13,0xb0c,0x14600e0d,0x24406e06,0x0,0x0,0x0,0x0,0x0,0x0,0x0,0x0
.long 0xd10a,0x1d601,0x1613,0x1dc11,0x19e13,0x1b0c,0x14601e0d,0x24446e06,0x0,0x0,0x0,0x0,0x0,0x0,0x0,0x0
.long 0xe10a,0x1e601,0x2613,0x1ec11,0x1ae13,0x2b0c,0x14602e0d,0x24486e06,0x0,0x0,0x0,0x0,0x0,0x0,0x0,0x0
.long 0xf10a,0x1f601,0x3613,0x1fc11,0x1be13,0x3b0c,0x14603e0d,0x244c6e06,0x0,0x0,0x0,0x0,0x0,0x0,0x0,0x0
.long 0x209,0x30707,0x24200f45,0x44007f06,0x0,0x0,0x0,0x0,0x0,0x0,0x0,0x0,0x0,0x0,0x0,0x0
.long 0x0,0x0,0x0,0x0,0x0,0x0,0x0,0x0,0x0,0x0,0x0,0x0,0x0,0x0,0x0,0x0
.long 0x1209,0x31707,0x24201f45,0x44047f06,0x0,0x0,0x0,0x0,0x0,0x0,0x0,0x0,0x0,0x0,0x0,0x0
.long 0x0,0x0,0x0,0x0,0x0,0x0,0x0,0x0,0x0,0x0,0x0,0x0,0x0,0x0,0x0,0x0
.long 0x2209,0x602,0x4013,0xc12,0xe11,0x3c0080d,0x28240fc5,0x0,0x0,0x0,0x0,0x0,0x0,0x0,0x0,0x0
.long 0x3209,0x1602,0x5013,0x1c12,0x1e11,0x3c0180d,0x28241fc5,0x0,0x0,0x0,0x0,0x0,0x0,0x0,0x0,0x0
.long 0x4209,0x2602,0x6013,0x2c12,0x2e11,0x3c0280d,0x28242fc5,0x0,0x0,0x0,0x0,0x0,0x0,0x0,0x0,0x0
.long 0x5209,0x3602,0x7013,0x3c12,0x3e11,0x3c0380d,0x28243fc5,0x0,0x0,0x0,0x0,0x0,0x0,0x0,0x0,0x0
.long 0x6209,0x32707,0x24202f45,0x44087f06,0x0,0x0,0x0,0x0,0x0,0x0,0x0,0x0,0x0,0x0,0x0,0x0
.long 0x0,0x0,0x0,0x0,0x0,0x0,0x0,0x0,0x0,0x0,0x0,0x0,0x0,0x0,0x0,0x0
.long 0x7209,0x33707,0x24203f45,0x440c7f06,0x0,0x0,0x0,0x0,0x0,0x0,0x0,0x0,0x0,0x0,0x0,0x0
.long 0x0,0x0,0x0,0x0,0x0,0x0,0x0,0x0,0x0,0x0,0x0,0x0,0x0,0x0,0x0,0x0
.long 0x8209,0x4602,0x4213,0x4c12,0x4e11,0x3c0092d,0x0,0x0,0x0,0x0,0x0,0x0,0x0,0x0,0x0,0x0
.long 0x9209,0x5602,0x5213,0x5c12,0x5e11,0x3c0192d,0x0,0x0,0x0,0x0,0x0,0x0,0x0,0x0,0x0,0x0
.long 0xa209,0x6602,0x6213,0x6c12,0x6e11,0x3c0292d,0x0,0x0,0x0,0x0,0x0,0x0,0x0,0x0,0x0,0x0
.long 0xb209,0x7602,0x7213,0x7c12,0x7e11,0x3c0392d,0x0,0x0,0x0,0x0,0x0,0x0,0x0,0x0,0x0,0x0
.long 0xc209,0x34707,0x28240f45,0x44006f06,0x0,0x0,0x0,0x0,0x0,0x0,0x0,0x0,0x0,0x0,0x0,0x0
.long 0x0,0x0,0x0,0x0,0x0,0x0,0x0,0x0,0x0,0x0,0x0,0x0,0x0,0x0,0x0,0x0
.long 0xd209,0x35707,0x28241f45,0x44046f06,0x0,0x0,0x0,0x0,0x0,0x0,0x0,0x0,0x0,0x0,0x0,0x0
.long 0x0,0x0,0x0,0x0,0x0,0x0,0x0,0x0,0x0,0x0,0x0,0x0,0x0,0x0,0x0,0x0
.long 0xe209,0x8602,0x4413,0x8c12,0x8e11,0x5c00a0d,0xdc08a06,0x403c0fc5,0x0,0x0,0x0,0x0,0x0,0x0,0x0,0x0
.long 0xf209,0x9602,0x5413,0x9c12,0x9e11,0x5c01a0d,0xdc48a06,0x403c1fc5,0x0,0x0,0x0,0x0,0x0,0x0,0x0,0x0
.long 0x10209,0xa602,0x6413,0xac12,0xae11,0x5c02a0d,0xdc88a06,0x403c2fc5,0x0,0x0,0x0,0x0,0x0,0x0,0x0,0x0
.long 0x11209,0xb602,0x7413,0xbc12,0xbe11,0x5c03a0d,0xdcc8a06,0x403c3fc5,0x0,0x0,0x0,0x0,0x0,0x0,0x0,0x0
.long 0x12209,0x36707,0x28242f45,0x44086f06,0x0,0x0,0x0,0x0,0x0,0x0,0x0,0x0,0x0,0x0,0x0,0x0
.long 0x0,0x0,0x0,0x0,0x0,0x0,0x0,0x0,0x0,0x0,0x0,0x0,0x0,0x0,0x0,0x0
.long 0x13209,0x37707,0x28243f45,0x440c6f06,0x0,0x0,0x0,0x0,0x0,0x0,0x0,0x0,0x0,0x0,0x0,0x0
.long 0x0,0x0,0x0,0x0,0x0,0x0,0x0,0x0,0x0,0x0,0x0,0x0,0x0,0x0,0x0,0x0
.long 0x14209,0xc602,0x4613,0xcc12,0xce11,0x9e00a0d,0xdc00a06,0x0,0x0,0x0,0x0,0x0,0x0,0x0,0x0,0x0
.long 0x15209,0xd602,0x5613,0xdc12,0xde11,0x9e01a0d,0xdc40a06,0x0,0x0,0x0,0x0,0x0,0x0,0x0,0x0,0x0
.long 0x16209,0xe602,0x6613,0xec12,0xee11,0x9e02a0d,0xdc80a06,0x0,0x0,0x0,0x0,0x0,0x0,0x0,0x0,0x0
.long 0x17209,0xf602,0x7613,0xfc12,0xfe11,0x9e03a0d,0xdcc0a06,0x0,0x0,0x0,0x0,0x0,0x0,0x0,0x0,0x0
.long 0x18209,0x38707,0x2c280f45,0x44005f06,0x0,0x0,0x0,0x0,0x0,0x0,0x0,0x0,0x0,0x0,0x0,0x0
.long 0x0,0x0,0x0,0x0,0x0,0x0,0x0,0x0,0x0,0x0,0x0,0x0,0x0,0x0,0x0,0x0
.long 0x19209,0x39707,0x2c281f45,0x44045f06,0x0,0x0,0x0,0x0,0x0,0x0,0x0,0x0,0x0,0x0,0x0,0x0
.long 0x0,0x0,0x0,0x0,0x0,0x0,0x0,0x0,0x0,0x0,0x0,0x0,0x0,0x0,0x0,0x0
.long 0x1a209,0x801,0x8013,0x813,0x10e11,0xc0c,0x18680e0d,0x24404e06,0x0,0x0,0x0,0x0,0x0,0x0,0x0,0x0
.long 0x1b209,0x1801,0x9013,0x1813,0x11e11,0x1c0c,0x18681e0d,0x24444e06,0x0,0x0,0x0,0x0,0x0,0x0,0x0,0x0
.long 0x1c209,0x2801,0xa013,0x2813,0x12e11,0x2c0c,0x18682e0d,0x24484e06,0x0,0x0,0x0,0x0,0x0,0x0,0x0,0x0
.long 0x1d209,0x3801,0xb013,0x3813,0x13e11,0x3c0c,0x18683e0d,0x244c4e06,0x0,0x0,0x0,0x0,0x0,0x0,0x0,0x0
.long 0x1e209,0x3a707,0x2c282f45,0x44085f06,0x0,0x0,0x0,0x0,0x0,0x0,0x0,0x0,0x0,0x0,0x0,0x0
.long 0x0,0x0,0x0,0x0,0x0,0x0,0x0,0x0,0x0,0x0,0x0,0x0,0x0,0x0,0x0,0x0
.long 0x1f209,0x3b707,0x2c283f45,0x440c5f06,0x0,0x0,0x0,0x0,0x0,0x0,0x0,0x0,0x0,0x0,0x0,0x0
.long 0x0,0x0,0x0,0x0,0x0,0x0,0x0,0x0,0x0,0x0,0x0,0x0,0x0,0x0,0x0,0x0
.long 0x20a,0x4801,0x8213,0xa13,0x14e11,0xd0c,0x1c700e0d,0x24402e06,0x0,0x0,0x0,0x0,0x0,0x0,0x0,0x0
.long 0x120a,0x5801,0x9213,0x1a13,0x15e11,0x1d0c,0x1c701e0d,0x24442e06,0x0,0x0,0x0,0x0,0x0,0x0,0x0,0x0
.long 0x220a,0x6801,0xa213,0x2a13,0x16e11,0x2d0c,0x1c702e0d,0x24482e06,0x0,0x0,0x0,0x0,0x0,0x0,0x0,0x0
.long 0x320a,0x7801,0xb213,0x3a13,0x17e11,0x3d0c,0x1c703e0d,0x244c2e06,0x0,0x0,0x0,0x0,0x0,0x0,0x0,0x0
.long 0x420a,0x3c707,0x302c0f45,0x44004f06,0x0,0x0,0x0,0x0,0x0,0x0,0x0,0x0,0x0,0x0,0x0,0x0
.long 0x0,0x0,0x0,0x0,0x0,0x0,0x0,0x0,0x0,0x0,0x0,0x0,0x0,0x0,0x0,0x0
.long 0x520a,0x3d707,0x302c1f45,0x44044f06,0x0,0x0,0x0,0x0,0x0,0x0,0x0,0x0,0x0,0x0,0x0,0x0
.long 0x0,0x0,0x0,0x0,0x0,0x0,0x0,0x0,0x0,0x0,0x0,0x0,0x0,0x0,0x0,0x0
.long 0x620a,0x8801,0x8413,0xc13,0x18e11,0xe0c,0x20780e0d,0x24400e06,0x0,0x0,0x0,0x0,0x0,0x0,0x0,0x0
.long 0x720a,0x9801,0x9413,0x1c13,0x19e11,0x1e0c,0x20781e0d,0x24440e06,0x0,0x0,0x0,0x0,0x0,0x0,0x0,0x0
.long 0x820a,0xa801,0xa413,0x2c13,0x1ae11,0x2e0c,0x20782e0d,0x24480e06,0x0,0x0,0x0,0x0,0x0,0x0,0x0,0x0
.long 0x920a,0xb801,0xb413,0x3c13,0x1be11,0x3e0c,0x20783e0d,0x244c0e06,0x0,0x0,0x0,0x0,0x0,0x0,0x0,0x0
.long 0xa20a,0x3e707,0x302c2f45,0x44084f06,0x0,0x0,0x0,0x0,0x0,0x0,0x0,0x0,0x0,0x0,0x0,0x0
.long 0x0,0x0,0x0,0x0,0x0,0x0,0x0,0x0,0x0,0x0,0x0,0x0,0x0,0x0,0x0,0x0
.long 0xb20a,0x3f707,0x302c3f45,0x440c4f06,0x0,0x0,0x0,0x0,0x0,0x0,0x0,0x0,0x0,0x0,0x0,0x0
.long 0x0,0x0,0x0,0x0,0x0,0x0,0x0,0x0,0x0,0x0,0x0,0x0,0x0,0x0,0x0,0x0
.long 0xc20a,0xc801,0x8613,0xe13,0x1ce11,0xf0c,0x4000fc5,0x0,0x0,0x0,0x0,0x0,0x0,0x0,0x0,0x0
.long 0xd20a,0xd801,0x9613,0x1e13,0x1de11,0x1f0c,0x4001fc5,0x0,0x0,0x0,0x0,0x0,0x0,0x0,0x0,0x0
.long 0xe20a,0xe801,0xa613,0x2e13,0x1ee11,0x2f0c,0x4002fc5,0x0,0x0,0x0,0x0,0x0,0x0,0x0,0x0,0x0
.long 0xf20a,0xf801,0xb613,0x3e13,0x1fe11,0x3f0c,0x4003fc5,0x0,0x0,0x0,0x0,0x0,0x0,0x0,0x0,0x0
.size TABLE_0, 16384
.section .rodata,"a"
.p2align 6
.amdhsa_kernel parallel_sum__memory_aug_recurrent_mem_tr__glu_gated_swiglu__prompt_kernel
  .amdhsa_next_free_vgpr 512
  .amdhsa_next_free_sgpr 102
  .amdhsa_accum_offset 256
  .amdhsa_group_segment_fixed_size 0
  .amdhsa_kernarg_size 112
  .amdhsa_user_sgpr_count 2
  .amdhsa_user_sgpr_kernarg_segment_ptr 1
  .amdhsa_system_sgpr_workgroup_id_x 1
.end_amdhsa_kernel
```
